```python
import torch

def _softmax(x, axis=-1):
    return torch.softmax(x, dim=axis)

def _gelu(x):
    return torch.nn.functional.gelu(x, approximate='tanh')

def _silu(x):
    return torch.nn.functional.silu(x)

def _sigmoid(x):
    return torch.sigmoid(x)

def _layernorm(x, axis=-1, eps=1e-05):
    m = x.mean(dim=axis, keepdim=True)
    v = x.var(dim=axis, keepdim=True, unbiased=False)
    return (x - m) / torch.sqrt(v + eps)

def _scatter_add(tgt, idx, src, axis=0):
    return tgt.clone().index_add_(axis, idx, src)

def _segment_sum(src, seg, n):
    out = torch.zeros((n,) + src.shape[1:], dtype=src.dtype)
    return out.index_add_(0, seg, src)

def _pad(x, pw):
    flat = tuple((v for pair in reversed(pw) for v in pair))
    return torch.nn.functional.pad(x, flat)
kernel_name = 'adaLN_cond__compressed_kv_cla__mixer_token_mlp__prompt'

def setup_inputs():

    _w = lambda a: (lambda t: t.to(torch.bfloat16) if t.is_floating_point() else t)(torch.as_tensor(a))

    def _A_setup():
        B, H, Sq, Sk, D, M = (1, 32, 2048, 2048, 128, 576)
        Dc = 4 * D
        return {'x': _w((lambda *s: torch.randn(*s, dtype=torch.bfloat16) * 0.05)(B, Sq, M)), 'c_kv': _w((lambda *s: torch.randn(*s, dtype=torch.bfloat16) * 0.8)(B, Sk, Dc)), 'w_q': _w((lambda *s: torch.randn(*s, dtype=torch.bfloat16) * 1.6)(M, H, D) * M ** (-0.5)), 'w_uk': _w((lambda *s: torch.randn(*s, dtype=torch.bfloat16) * 1.6)(Dc, H, D) * Dc ** (-0.5)), 'w_uv': _w((lambda *s: torch.randn(*s, dtype=torch.bfloat16) * 0.8)(Dc, H, D) * Dc ** (-0.5)), 'w_o': _w((lambda *s: torch.randn(*s, dtype=torch.bfloat16) * 0.8)(H, D, M) * (H * D) ** (-0.5))}
    _A_in = _A_setup()

    def _B_setup():
        B, S, D, F = (1, 2048, 576, 4608)
        return {'x': _w((lambda *s: torch.randn(*s, dtype=torch.bfloat16) * 0.05)(B, S, D)), 'w1': _w((lambda *s: torch.randn(*s, dtype=torch.bfloat16) * 0.8)(S, F) * S ** (-0.5)), 'b1': _w((lambda *s: torch.randn(*s, dtype=torch.bfloat16) * 12.8)(F) * 0.02), 'w2': _w((lambda *s: torch.randn(*s, dtype=torch.bfloat16) * 0.4)(F, S) * F ** (-0.5)), 'b2': _w((lambda *s: torch.randn(*s, dtype=torch.bfloat16) * 3.2)(S) * 0.02)}
    _B_in = _B_setup()
    return {'A_x': _A_in['x'], 'A_c_kv': _A_in['c_kv'], 'A_w_q': _A_in['w_q'], 'A_w_uk': _A_in['w_uk'], 'A_w_uv': _A_in['w_uv'], 'A_w_o': _A_in['w_o'], 'B_x': _B_in['x'], 'B_w1': _B_in['w1'], 'B_b1': _B_in['b1'], 'B_w2': _B_in['w2'], 'B_b2': _B_in['b2'], 'c': _w((lambda *s: torch.randn(*s, dtype=torch.bfloat16) * 0.1)(1, 576) * 8.0), 'w_mod': _w((lambda *s: torch.randn(*s, dtype=torch.bfloat16) * 0.1)(576, 6 * 576) * 576 ** (-0.5) * 8.0)}

def reference(A_x, A_c_kv, A_w_q, A_w_uk, A_w_uv, A_w_o, B_x, B_w1, B_b1, B_w2, B_b2, c, w_mod):

    def _A_ref(x, c_kv, w_q, w_uk, w_uv, w_o):
        B, Sq, M = (x.shape[0], x.shape[1], x.shape[2])
        Sk = c_kv.shape[1]
        H, D = (w_q.shape[1], w_q.shape[2])
        q = torch.einsum('bqm,mhd->bhqd', x, w_q)
        k = torch.einsum('bkc,chd->bhkd', c_kv, w_uk)
        v = torch.einsum('bkc,chd->bhkd', c_kv, w_uv)
        scores = torch.einsum('bhqd,bhkd->bhqk', q, k) * D ** (-0.5)
        off = Sk - Sq
        qi = torch.arange(Sq)[:, None]
        kj = torch.arange(Sk)[None, :]
        cmask = kj <= qi + off
        scores = torch.where(cmask[None, None], scores, -1000000000.0)
        p = _softmax(scores, axis=-1)
        ctx = torch.einsum('bhqk,bhkd->bhqd', p, v)
        return torch.einsum('bhqd,hdm->bqm', ctx, w_o)

    def _B_ref(x, w1, b1, w2, b2):
        B, S, D = x.shape
        h = _layernorm(x, axis=-1)
        u = torch.einsum('bsd,sf->bdf', h, w1) + b1
        u = _gelu(u)
        y = torch.einsum('bdf,fs->bds', u, w2) + b2
        return (lambda x, *d: x.permute(*d))(y, 0, 2, 1)
    x = A_x
    mod = (_silu(c) @ w_mod).reshape(c.shape[0], 6, 1, -1)
    sa, ca, ga, sb, cb, gb = (mod[:, 0].clone(), mod[:, 1].clone(), mod[:, 2].clone(), mod[:, 3].clone(), mod[:, 4].clone(), mod[:, 5].clone())
    h = _layernorm(x, axis=-1) * (1 + ca) + sa
    x = x + ga * _A_ref(h, A_c_kv, A_w_q, A_w_uk, A_w_uv, A_w_o)
    h = _layernorm(x, axis=-1) * (1 + cb) + sb
    x = x + gb * _B_ref(h, B_w1, B_b1, B_w2, B_b2)
    return x
```

```asm
; @launch kernel=front_kernel grid=(256,1,1) block=(512,1,1) lds=163840
.amdgcn_target "amdgcn-amd-amdhsa--gfx950"
.text
.globl front_kernel
.p2align 8
.type front_kernel,@function
front_kernel:
  s_cmp_ge_u32 s2, 256
  s_cbranch_scc1 L_end_front_kernel
  s_load_dwordx2 s[12:13], s[0:1], 8
  s_mov_b32 s14, 0x200000
  s_mov_b32 s15, 0x00020000
  s_load_dwordx2 s[8:9], s[0:1], 24
  s_mov_b32 s10, 0x400000
  s_mov_b32 s11, 0x00020000
  s_load_dwordx2 s[4:5], s[0:1], 120
  s_mov_b32 s6, 0x10000000
  s_mov_b32 s7, 0x00020000
  s_load_dwordx2 s[44:45], s[0:1], 96
  s_mov_b32 s46, 0x3cc000
  s_mov_b32 s47, 0x00020000
  s_load_dwordx2 s[48:49], s[0:1], 88
  s_mov_b32 s50, 0x480
  s_mov_b32 s51, 0x00020000
  s_load_dwordx2 s[56:57], s[0:1], 0
  s_mov_b32 s58, 0x240000
  s_mov_b32 s59, 0x00020000
  s_load_dwordx2 s[16:17], s[0:1], 32
  s_mov_b32 s18, 0x400000
  s_mov_b32 s19, 0x00020000
  s_load_dwordx2 s[40:41], s[0:1], 16
  s_mov_b32 s42, 0x480000
  s_mov_b32 s43, 0x00020000
  s_load_dwordx2 s[52:53], s[0:1], 112
  s_mov_b32 s54, 0x100
  s_mov_b32 s55, 0x00020000
  s_load_dwordx2 s[60:61], s[0:1], 40
  s_mov_b32 s62, 0x480000
  s_mov_b32 s63, 0x00020000
  s_load_dwordx2 s[88:89], s[0:1], 56
  s_mov_b32 s90, 0x1200000
  s_mov_b32 s91, 0x00020000
  s_load_dwordx2 s[92:93], s[0:1], 72
  s_mov_b32 s94, 0x1200000
  s_mov_b32 s95, 0x00020000
  v_lshrrev_b32 v12, 6, v0
  v_and_b32 v1, 63, v0
  v_readfirstlane_b32 s20, v12
  s_and_b32 s38, s2, 7
  s_lshr_b32 s39, s2, 3
  s_lshr_b32 s23, s39, 2
  s_and_b32 s39, s39, 3
  s_lshl_b32 s38, s38, 2
  s_add_u32 s33, s38, s39
  s_lshl_b32 s24, s33, 19
  s_and_b32 s21, s20, 3
  s_lshr_b32 s22, s20, 2
  s_sub_u32 s101, 15, s23
  s_mov_b32 s100, 0
  s_lshl_b32 s25, s23, 18
  s_lshl_b32 s26, s33, 8
  s_lshl_b32 s28, s20, 10
  s_bfe_u32 s31, s20, 0x10001
  v_lshrrev_b32 v12, 3, v1
  v_bfe_u32 v13, v12, 2, 1
  v_xor_b32 v13, s31, v13
  v_bfe_u32 v11, v12, 1, 1
  v_lshl_add_u32 v13, v13, 1, v11
  v_bfe_u32 v11, v1, 1, 2
  v_xor_b32 v13, v13, v11
  v_and_b32 v11, 1, v1
  v_lshlrev_b32 v11, 4, v11
  v_lshl_add_u32 v13, v13, 5, v11
  s_mov_b32 s30, 8192
  v_mad_u32_u24 v49, v12, s30, v13
  s_lshr_b32 s30, s20, 1
  s_lshl_b32 s30, s30, 16
  s_and_b32 s31, s20, 1
  s_lshl_b32 s31, s31, 7
  s_add_u32 s30, s30, s31
  v_add_u32 v49, s30, v49
  v_and_b32 v13, 3, v1
  v_lshlrev_b32 v13, 4, v13
  s_lshl_b32 s30, s20, 3
  v_lshrrev_b32 v12, 3, v1
  v_add_u32 v12, s30, v12
  v_bfe_u32 v11, v12, 1, 3
  v_and_b32 v15, 7, v1
  v_xor_b32 v11, v11, v15
  v_lshlrev_b32 v11, 4, v11
  v_lshl_add_u32 v48, v12, 10, v11
  s_cmp_lt_u32 s2, 108
  s_cselect_b32 s34, 4, 0
  s_cmp_lt_u32 s20, s34
  s_cselect_b32 s35, 1, 0
  s_cbranch_scc0 L_m0_front_kernel
  s_lshl_b32 s30, s21, 4
  v_lshrrev_b32 v120, 2, v1
  v_add_u32 v120, s30, v120
  s_movk_i32 s30, 6912
  v_mad_u32_u24 v122, v120, s30, v13
  v_lshlrev_b32 v123, 1, v120
  s_mul_i32 s32, s2, 1821
  s_lshr_b32 s32, s32, 16
  s_mul_i32 s36, s32, 36
  s_sub_u32 s36, s2, s36
  s_lshl_b32 s31, s36, 6
  s_mul_i32 s30, s32, 1327104
  s_add_u32 s31, s31, s30
  s_mul_i32 s34, s32, 384
  s_mul_i32 s32, s32, 4608
  s_lshl_b32 s36, s36, 7
  s_add_u32 s32, s32, s36
  s_waitcnt lgkmcnt(0)
  s_add_u32 s30, s31, 0
  buffer_load_dwordx4 v[64:67], v122, s[44:47], s30 offen
  s_add_u32 s30, s31, 442368
  buffer_load_dwordx4 v[68:71], v122, s[44:47], s30 offen
  s_add_u32 s30, s31, 884736
  buffer_load_dwordx4 v[72:75], v122, s[44:47], s30 offen
  buffer_load_ushort v100, v123, s[48:51], s34 offen offset:0
  buffer_load_ushort v101, v123, s[48:51], s34 offen offset:128
  buffer_load_ushort v102, v123, s[48:51], s34 offen offset:256
L_m0_front_kernel:
  s_waitcnt lgkmcnt(0)
  s_add_u32 m0, s28, 49152
  s_add_u32 s30, s26, 0
  buffer_load_dwordx4 v49, s[8:11], s30 offen lds
  s_add_u32 m0, s28, 57344
  s_add_u32 s30, s26, 262144
  buffer_load_dwordx4 v49, s[8:11], s30 offen lds
  s_add_u32 m0, s28, 16384
  s_add_u32 s30, s25, 0
  buffer_load_dwordx4 v48, s[12:15], s30 offen lds
  s_add_u32 m0, s28, 24576
  s_add_u32 s30, s25, 65536
  buffer_load_dwordx4 v48, s[12:15], s30 offen lds
  s_add_u32 m0, s28, 32768
  s_add_u32 s30, s25, 131072
  buffer_load_dwordx4 v48, s[12:15], s30 offen lds
  s_add_u32 m0, s28, 40960
  s_add_u32 s30, s25, 196608
  buffer_load_dwordx4 v48, s[12:15], s30 offen lds
  s_mul_i32 s29, s2, 9216
  s_lshl_b32 s30, s21, 1
  v_lshrrev_b32 v120, 5, v1
  v_add_u32 v120, s30, v120
  v_and_b32 v121, 31, v1
  s_movk_i32 s30, 1152
  v_mul_u32_u24 v3, s30, v120
  v_lshl_add_u32 v2, v121, 4, v3
  v_lshl_add_u32 v3, v121, 2, v3
  v_add_u32 v3, 1024, v3
  v_lshlrev_b32 v4, 5, v121
  v_lshlrev_b32 v5, 3, v121
  v_add_u32 v5, 2048, v5
  s_lshl_b32 s30, s35, 2
  s_add_u32 s30, s30, s20
  s_cmp_eq_u32 s30, 7
  s_cselect_b32 s27, s35, 0
  s_add_u32 m0, s28, 98304
  s_add_u32 s30, s26, 524288
  buffer_load_dwordx4 v49, s[8:11], s30 offen lds
  s_add_u32 m0, s28, 106496
  s_add_u32 s30, s26, 786432
  buffer_load_dwordx4 v49, s[8:11], s30 offen lds
  s_add_u32 m0, s28, 65536
  s_add_u32 s30, s25, 128
  buffer_load_dwordx4 v48, s[12:15], s30 offen lds
  s_add_u32 m0, s28, 73728
  s_add_u32 s30, s25, 65664
  buffer_load_dwordx4 v48, s[12:15], s30 offen lds
  s_add_u32 m0, s28, 81920
  s_add_u32 s30, s25, 131200
  buffer_load_dwordx4 v48, s[12:15], s30 offen lds
  s_add_u32 m0, s28, 90112
  s_add_u32 s30, s25, 196736
  buffer_load_dwordx4 v48, s[12:15], s30 offen lds
  s_movk_i32 s30, 1152
  v_mad_u32_u24 v51, v12, s30, v11
  s_mul_i32 s36, s23, 147456
  s_add_u32 s36, s36, 65536
  s_mul_i32 s37, s101, 147456
  s_add_u32 s37, s37, 65536
  s_lshl_b32 s30, s20, 4
  v_lshrrev_b32 v12, 2, v1
  v_add_u32 v12, s30, v12
  v_and_b32 v15, 32, v1
  v_xor_b32 v15, v15, v13
  v_lshl_add_u32 v50, v12, 13, v15
  v_lshlrev_b32 v6, 4, v1
  v_mov_b32 v58, 0
  v_lshlrev_b32 v59, 7, v1
  v_lshrrev_b32 v12, 1, v1
  v_and_b32 v13, 1, v1
  v_lshlrev_b32 v13, 7, v13
  v_lshl_add_u32 v12, v12, 13, v13
  s_lshl_b32 s30, s23, 3
  s_add_u32 s30, s30, s20
  s_lshl_b32 s30, s30, 16
  s_add_u32 s30, s30, s26
  s_lshl_b32 s31, s2, 3
  s_add_u32 s31, s31, s20
  s_lshl_b32 s31, s31, 10
  s_mov_b64 exec, 0xffff
  buffer_load_dword v62, v12, s[8:11], s30 offen
  s_mov_b64 exec, 0xff
  buffer_load_dword v62, v59, s[12:15], s31 offen
  s_mov_b64 exec, -1
  s_getpc_b64 s[30:31]
L_pc_front_kernel:
  s_sub_u32 s30, s30, L_pc_front_kernel-front_kernel
  s_subb_u32 s31, s31, 0
  s_lshr_b32 s38, s2, 3
  s_lshl_b32 s38, s38, 3
  s_add_u32 s38, s38, s20
  s_lshl_b32 s38, s38, 9
  v_add_u32 v12, s38, v59
  v_cmp_gt_u32 vcc, L_text_end-front_kernel-4, v12
  s_nop 0
  s_and_b64 exec, vcc, 15
  s_cbranch_execz L_cpf_front_kernel
  global_load_dword v62, v12, s[30:31]
L_cpf_front_kernel:
  s_mov_b64 exec, -1
  s_lshl_b32 s30, s20, 12
  s_add_u32 s30, s30, 16384
  v_and_b32 v12, 15, v1
  v_bfe_u32 v13, v1, 1, 3
  v_lshrrev_b32 v11, 4, v1
  v_lshlrev_b32 v12, 7, v12
  v_add_u32 v12, s30, v12
  v_add_u32 v15, 0, v11
  v_xor_b32 v15, v15, v13
  v_lshl_add_u32 v52, v15, 4, v12
  v_add_u32 v15, 4, v11
  v_xor_b32 v15, v15, v13
  v_lshl_add_u32 v53, v15, 4, v12
  v_bfe_u32 v12, v1, 2, 2
  v_lshl_add_u32 v12, v11, 3, v12
  v_lshlrev_b32 v12, 6, v12
  v_and_b32 v13, 3, v1
  v_lshl_add_u32 v12, v13, 3, v12
  v_and_b32 v13, 1, v11
  v_lshl_add_u32 v12, v13, 5, v12
  v_add_u32 v54, 114688, v12
  v_xor_b32 v55, 32, v54
  v_lshrrev_b32 v12, 4, v1
  v_bfe_u32 v13, v1, 2, 2
  v_lshl_add_u32 v13, v12, 3, v13
  v_lshrrev_b32 v12, 1, v13
  v_xor_b32 v12, v12, v13
  v_bfe_u32 v12, v12, 2, 1
  v_bfe_u32 v11, v13, 1, 1
  v_lshl_add_u32 v12, v12, 1, v11
  v_lshrrev_b32 v11, 3, v13
  v_mul_u32_u24 v11, 2048, v11
  v_and_b32 v13, 7, v13
  v_lshl_add_u32 v11, v13, 7, v11
  v_and_b32 v13, 3, v1
  v_lshl_add_u32 v11, v13, 3, v11
  v_xor_b32 v13, 0, v12
  v_lshl_add_u32 v7, v13, 5, v11
  v_xor_b32 v13, 1, v12
  v_lshl_add_u32 v8, v13, 5, v11
  v_xor_b32 v13, 2, v12
  v_lshl_add_u32 v9, v13, 5, v11
  v_xor_b32 v13, 3, v12
  v_lshl_add_u32 v10, v13, 5, v11
  v_add_u32 v7, 49152, v7
  v_add_u32 v8, 49152, v8
  v_add_u32 v9, 49152, v9
  v_add_u32 v10, 49152, v10
  s_and_b32 s96, s2, 1
  s_lshl_b32 s96, s96, 7
  s_lshr_b32 s97, s2, 4
  s_lshl_b32 s97, s97, 7
  s_add_u32 s97, s97, 32768
  s_lshl_b32 s98, s33, 7
  s_add_u32 s98, s98, 34816
  s_lshl_b32 s99, s23, 7
  s_add_u32 s99, s99, 32768
  s_lshl_b32 s34, s101, 7
  s_add_u32 s34, s34, 32768
  s_lshl_b32 s46, s23, 3
  s_add_u32 s46, s46, s20
  s_lshl_b32 s46, s46, 13
  s_add_u32 s46, s46, s24
  s_cmp_eq_u32 s22, 0
  s_cbranch_scc1 L_x0_front_kernel
  buffer_load_dwordx4 v[144:147], v2, s[56:59], s29 offen
  buffer_load_dwordx4 v[148:151], v2, s[56:59], s29 offen offset:512
  buffer_load_dword v152, v3, s[56:59], s29 offen
L_x0_front_kernel:
  s_cmp_ge_u32 s2, 108
  s_cbranch_scc1 L_m2_front_kernel
  s_cmp_eq_u32 s35, 0
  s_cbranch_scc1 L_m1_front_kernel
  s_mov_b32 s30, 0xbfb8aa3b
  s_waitcnt vmcnt(14)
  v_lshlrev_b32 v100, 16, v100
  v_mul_f32 v120, s30, v100
  v_exp_f32 v120, v120
  s_nop 0
  v_add_f32 v120, 1.0, v120
  v_rcp_f32 v120, v120
  s_nop 0
  v_mul_f32 v100, v100, v120
  v_cvt_pk_bf16_f32 v100, v100, v100
  v_lshlrev_b32 v100, 16, v100
  v_lshlrev_b32 v101, 16, v101
  v_mul_f32 v120, s30, v101
  v_exp_f32 v120, v120
  s_nop 0
  v_add_f32 v120, 1.0, v120
  v_rcp_f32 v120, v120
  s_nop 0
  v_mul_f32 v101, v101, v120
  v_cvt_pk_bf16_f32 v101, v101, v101
  v_lshlrev_b32 v101, 16, v101
  v_lshlrev_b32 v102, 16, v102
  v_mul_f32 v120, s30, v102
  v_exp_f32 v120, v120
  s_nop 0
  v_add_f32 v120, 1.0, v120
  v_rcp_f32 v120, v120
  s_nop 0
  v_mul_f32 v102, v102, v120
  v_cvt_pk_bf16_f32 v102, v102, v102
  v_lshlrev_b32 v102, 16, v102
  v_lshlrev_b32 v120, 16, v64
  v_and_b32 v121, 0xffff0000, v64
  v_mul_f32 v112, v120, v100
  v_mul_f32 v113, v121, v100
  v_lshlrev_b32 v120, 16, v65
  v_and_b32 v121, 0xffff0000, v65
  v_mul_f32 v114, v120, v100
  v_mul_f32 v115, v121, v100
  v_lshlrev_b32 v120, 16, v66
  v_and_b32 v121, 0xffff0000, v66
  v_mul_f32 v116, v120, v100
  v_mul_f32 v117, v121, v100
  v_lshlrev_b32 v120, 16, v67
  v_and_b32 v121, 0xffff0000, v67
  v_mul_f32 v118, v120, v100
  v_mul_f32 v119, v121, v100
  v_lshlrev_b32 v120, 16, v68
  v_and_b32 v121, 0xffff0000, v68
  v_fmac_f32 v112, v120, v101
  v_fmac_f32 v113, v121, v101
  v_lshlrev_b32 v120, 16, v69
  v_and_b32 v121, 0xffff0000, v69
  v_fmac_f32 v114, v120, v101
  v_fmac_f32 v115, v121, v101
  v_lshlrev_b32 v120, 16, v70
  v_and_b32 v121, 0xffff0000, v70
  v_fmac_f32 v116, v120, v101
  v_fmac_f32 v117, v121, v101
  v_lshlrev_b32 v120, 16, v71
  v_and_b32 v121, 0xffff0000, v71
  v_fmac_f32 v118, v120, v101
  v_fmac_f32 v119, v121, v101
  v_lshlrev_b32 v120, 16, v72
  v_and_b32 v121, 0xffff0000, v72
  v_fmac_f32 v112, v120, v102
  v_fmac_f32 v113, v121, v102
  v_lshlrev_b32 v120, 16, v73
  v_and_b32 v121, 0xffff0000, v73
  v_fmac_f32 v114, v120, v102
  v_fmac_f32 v115, v121, v102
  v_lshlrev_b32 v120, 16, v74
  v_and_b32 v121, 0xffff0000, v74
  v_fmac_f32 v116, v120, v102
  v_fmac_f32 v117, v121, v102
  v_lshlrev_b32 v120, 16, v75
  v_and_b32 v121, 0xffff0000, v75
  v_fmac_f32 v118, v120, v102
  v_fmac_f32 v119, v121, v102
  v_add_f32_dpp v112, v112, v112 row_ror:4 row_mask:0xf bank_mask:0xf
  v_add_f32_dpp v113, v113, v113 row_ror:4 row_mask:0xf bank_mask:0xf
  v_add_f32_dpp v114, v114, v114 row_ror:4 row_mask:0xf bank_mask:0xf
  v_add_f32_dpp v115, v115, v115 row_ror:4 row_mask:0xf bank_mask:0xf
  v_add_f32_dpp v116, v116, v116 row_ror:4 row_mask:0xf bank_mask:0xf
  v_add_f32_dpp v117, v117, v117 row_ror:4 row_mask:0xf bank_mask:0xf
  v_add_f32_dpp v118, v118, v118 row_ror:4 row_mask:0xf bank_mask:0xf
  v_add_f32_dpp v119, v119, v119 row_ror:4 row_mask:0xf bank_mask:0xf
  v_add_f32_dpp v112, v112, v112 row_ror:8 row_mask:0xf bank_mask:0xf
  v_add_f32_dpp v113, v113, v113 row_ror:8 row_mask:0xf bank_mask:0xf
  v_add_f32_dpp v114, v114, v114 row_ror:8 row_mask:0xf bank_mask:0xf
  v_add_f32_dpp v115, v115, v115 row_ror:8 row_mask:0xf bank_mask:0xf
  v_add_f32_dpp v116, v116, v116 row_ror:8 row_mask:0xf bank_mask:0xf
  v_add_f32_dpp v117, v117, v117 row_ror:8 row_mask:0xf bank_mask:0xf
  v_add_f32_dpp v118, v118, v118 row_ror:8 row_mask:0xf bank_mask:0xf
  v_add_f32_dpp v119, v119, v119 row_ror:8 row_mask:0xf bank_mask:0xf
  v_lshrrev_b32 v120, 4, v1
  v_lshlrev_b32 v120, 7, v120
  v_and_b32 v121, 3, v1
  v_lshl_add_u32 v120, v121, 5, v120
  s_lshl_b32 s30, s21, 9
  v_add_u32 v120, s30, v120
  ds_write_b128 v120, v[112:115]
  ds_write_b128 v120, v[116:119] offset:16
  s_waitcnt lgkmcnt(0)
L_m1_front_kernel:
  s_barrier
  s_cmp_eq_u32 s27, 0
  s_cbranch_scc1 L_m2_front_kernel
  v_and_b32 v120, 31, v1
  v_lshlrev_b32 v120, 2, v120
  v_lshrrev_b32 v121, 5, v1
  v_lshl_add_u32 v121, v121, 10, v120
  ds_read_b32 v64, v121 offset:0
  ds_read_b32 v65, v121 offset:128
  ds_read_b32 v66, v121 offset:256
  ds_read_b32 v67, v121 offset:384
  ds_read_b32 v68, v121 offset:512
  ds_read_b32 v69, v121 offset:640
  ds_read_b32 v70, v121 offset:768
  ds_read_b32 v71, v121 offset:896
  s_waitcnt lgkmcnt(0)
  v_add_f32 v64, v64, v65
  v_add_f32 v64, v64, v66
  v_add_f32 v64, v64, v67
  v_add_f32 v64, v64, v68
  v_add_f32 v64, v64, v69
  v_add_f32 v64, v64, v70
  v_add_f32 v64, v64, v71
  v_mov_b32 v65, v64
  s_nop 1
  v_permlane32_swap_b32 v65, v64
  v_add_f32 v64, v64, v65
  s_add_u32 s30, s32, 16384
  buffer_store_dword v64, v120, s[4:7], s30 offen sc1
  s_lshl_b32 s30, s2, 8
  s_add_u32 s30, s30, 32768
  s_nop 0
  v_lshlrev_b32 v121, 2, v1
  buffer_store_dword v58, v121, s[4:7], s30 offen sc1
L_m2_front_kernel:
  s_lshl_b32 s30, s35, 1
  s_add_u32 s30, s30, s22
  s_cmp_lg_u32 s30, 1
  s_cbranch_scc1 L_wea1_front_kernel
  s_waitcnt vmcnt(11)
  s_branch L_wea_front_kernel
L_wea1_front_kernel:
  s_cmp_lg_u32 s30, 2
  s_cbranch_scc1 L_wea2_front_kernel
  s_waitcnt vmcnt(8)
  s_branch L_wea_front_kernel
L_wea2_front_kernel:
  s_cmp_lg_u32 s30, 3
  s_cbranch_scc1 L_wea3_front_kernel
  s_waitcnt vmcnt(11)
  s_branch L_wea_front_kernel
L_wea3_front_kernel:
  s_waitcnt vmcnt(8)
L_wea_front_kernel:
  s_barrier
  s_lshl_b32 s30, s20, 12
  v_add_u32 v56, s30, v6
  ds_read_b128 v[64:67], v52 offset:0
  ds_read_b128 v[72:75], v53 offset:0
  ds_read_b128 v[68:71], v52 offset:2048
  ds_read_b128 v[76:79], v53 offset:2048
  ds_read_b64_tr_b16 v[16:17], v7 offset:0
  ds_read_b64_tr_b16 v[18:19], v9 offset:512
  ds_read_b64_tr_b16 v[20:21], v7 offset:8192
  ds_read_b64_tr_b16 v[22:23], v9 offset:8704
  ds_read_b64_tr_b16 v[24:25], v8 offset:0
  ds_read_b64_tr_b16 v[26:27], v10 offset:512
  ds_read_b64_tr_b16 v[28:29], v8 offset:8192
  ds_read_b64_tr_b16 v[30:31], v10 offset:8704
  s_waitcnt lgkmcnt(8)
  ds_read_b64_tr_b16 v[32:33], v9 offset:0
  ds_read_b64_tr_b16 v[34:35], v7 offset:512
  ds_read_b64_tr_b16 v[36:37], v9 offset:8192
  ds_read_b64_tr_b16 v[38:39], v7 offset:8704
  s_waitcnt lgkmcnt(8)
  v_mfma_f32_16x16x32_bf16 v[192:195], v[16:19], v[64:67], 0
  ds_read_b64_tr_b16 v[40:41], v10 offset:0
  v_mfma_f32_16x16x32_bf16 v[192:195], v[20:23], v[72:75], v[192:195]
  ds_read_b64_tr_b16 v[42:43], v8 offset:512
  v_mfma_f32_16x16x32_bf16 v[196:199], v[16:19], v[68:71], 0
  ds_read_b64_tr_b16 v[44:45], v10 offset:8192
  v_mfma_f32_16x16x32_bf16 v[196:199], v[20:23], v[76:79], v[196:199]
  ds_read_b64_tr_b16 v[46:47], v8 offset:8704
  s_add_u32 m0, s28, 147456
  s_add_u32 s30, s26, 1048576
  buffer_load_dwordx4 v49, s[8:11], s30 offen lds
  s_waitcnt lgkmcnt(8)
  v_mfma_f32_16x16x32_bf16 v[200:203], v[24:27], v[64:67], 0
  ds_read_b64_tr_b16 v[16:17], v7 offset:1024
  v_mfma_f32_16x16x32_bf16 v[200:203], v[28:31], v[72:75], v[200:203]
  ds_read_b64_tr_b16 v[18:19], v9 offset:1536
  v_mfma_f32_16x16x32_bf16 v[204:207], v[24:27], v[68:71], 0
  ds_read_b64_tr_b16 v[20:21], v7 offset:9216
  v_mfma_f32_16x16x32_bf16 v[204:207], v[28:31], v[76:79], v[204:207]
  ds_read_b64_tr_b16 v[22:23], v9 offset:9728
  s_add_u32 m0, s28, 155648
  s_add_u32 s30, s26, 1310720
  buffer_load_dwordx4 v49, s[8:11], s30 offen lds
  s_waitcnt lgkmcnt(8)
  v_mfma_f32_16x16x32_bf16 v[208:211], v[32:35], v[64:67], 0
  ds_read_b64_tr_b16 v[24:25], v8 offset:1024
  v_mfma_f32_16x16x32_bf16 v[208:211], v[36:39], v[72:75], v[208:211]
  ds_read_b64_tr_b16 v[26:27], v10 offset:1536
  v_mfma_f32_16x16x32_bf16 v[212:215], v[32:35], v[68:71], 0
  ds_read_b64_tr_b16 v[28:29], v8 offset:9216
  v_mfma_f32_16x16x32_bf16 v[212:215], v[36:39], v[76:79], v[212:215]
  ds_read_b64_tr_b16 v[30:31], v10 offset:9728
  s_add_u32 m0, s28, 114688
  s_add_u32 s30, s25, 256
  buffer_load_dwordx4 v48, s[12:15], s30 offen lds
  s_waitcnt lgkmcnt(8)
  v_mfma_f32_16x16x32_bf16 v[216:219], v[40:43], v[64:67], 0
  ds_read_b64_tr_b16 v[32:33], v9 offset:1024
  v_mfma_f32_16x16x32_bf16 v[216:219], v[44:47], v[72:75], v[216:219]
  ds_read_b64_tr_b16 v[34:35], v7 offset:1536
  v_mfma_f32_16x16x32_bf16 v[220:223], v[40:43], v[68:71], 0
  ds_read_b64_tr_b16 v[36:37], v9 offset:9216
  v_mfma_f32_16x16x32_bf16 v[220:223], v[44:47], v[76:79], v[220:223]
  ds_read_b64_tr_b16 v[38:39], v7 offset:9728
  s_add_u32 m0, s28, 122880
  s_add_u32 s30, s25, 65792
  buffer_load_dwordx4 v48, s[12:15], s30 offen lds
  s_waitcnt lgkmcnt(8)
  v_mfma_f32_16x16x32_bf16 v[224:227], v[16:19], v[64:67], 0
  ds_read_b64_tr_b16 v[40:41], v10 offset:1024
  v_mfma_f32_16x16x32_bf16 v[224:227], v[20:23], v[72:75], v[224:227]
  ds_read_b64_tr_b16 v[42:43], v8 offset:1536
  v_mfma_f32_16x16x32_bf16 v[228:231], v[16:19], v[68:71], 0
  ds_read_b64_tr_b16 v[44:45], v10 offset:9216
  v_mfma_f32_16x16x32_bf16 v[228:231], v[20:23], v[76:79], v[228:231]
  ds_read_b64_tr_b16 v[46:47], v8 offset:9728
  s_add_u32 m0, s28, 131072
  s_add_u32 s30, s25, 131328
  buffer_load_dwordx4 v48, s[12:15], s30 offen lds
  s_add_u32 m0, s28, 139264
  s_add_u32 s30, s25, 196864
  buffer_load_dwordx4 v48, s[12:15], s30 offen lds
  s_waitcnt lgkmcnt(8)
  v_mfma_f32_16x16x32_bf16 v[232:235], v[24:27], v[64:67], 0
  v_add_u32 v52, 49152, v52
  v_add_u32 v53, 49152, v53
  v_mfma_f32_16x16x32_bf16 v[232:235], v[28:31], v[72:75], v[232:235]
  v_add_u32 v7, 49152, v7
  v_add_u32 v8, 49152, v8
  v_mfma_f32_16x16x32_bf16 v[236:239], v[24:27], v[68:71], 0
  v_add_u32 v9, 49152, v9
  v_add_u32 v10, 49152, v10
  v_mfma_f32_16x16x32_bf16 v[236:239], v[28:31], v[76:79], v[236:239]
  s_waitcnt lgkmcnt(0)
  s_cmp_lg_u32 s27, 1
  s_cbranch_scc1 L_o0_front_kernel
  s_waitcnt vmcnt(0)
  v_mov_b32 v61, 1
  s_mov_b64 exec, 3
  buffer_atomic_add v61, v59, s[52:55], 0 offen sc1
  s_mov_b64 exec, -1
L_o0_front_kernel:
  s_lshl_b32 s30, s35, 1
  s_add_u32 s30, s30, s22
  s_cmp_lg_u32 s30, 1
  s_cbranch_scc1 L_web1_front_kernel
  s_waitcnt vmcnt(11)
  s_branch L_web_front_kernel
L_web1_front_kernel:
  s_cmp_lg_u32 s30, 2
  s_cbranch_scc1 L_web2_front_kernel
  s_waitcnt vmcnt(8)
  s_branch L_web_front_kernel
L_web2_front_kernel:
  s_cmp_lg_u32 s30, 3
  s_cbranch_scc1 L_web3_front_kernel
  s_waitcnt vmcnt(11)
  s_branch L_web_front_kernel
L_web3_front_kernel:
  s_waitcnt vmcnt(8)
L_web_front_kernel:
  s_barrier
  v_mfma_f32_16x16x32_bf16 v[240:243], v[32:35], v[64:67], 0
  ds_read_b128 v[80:83], v52 offset:0
  ds_read_b128 v[88:91], v53 offset:0
  ds_read_b128 v[84:87], v52 offset:2048
  v_mfma_f32_16x16x32_bf16 v[240:243], v[36:39], v[72:75], v[240:243]
  ds_read_b128 v[92:95], v53 offset:2048
  ds_read_b64_tr_b16 v[16:17], v7 offset:0
  ds_read_b64_tr_b16 v[18:19], v9 offset:512
  v_mfma_f32_16x16x32_bf16 v[244:247], v[32:35], v[68:71], 0
  ds_read_b64_tr_b16 v[20:21], v7 offset:8192
  ds_read_b64_tr_b16 v[22:23], v9 offset:8704
  ds_read_b64_tr_b16 v[24:25], v8 offset:0
  v_mfma_f32_16x16x32_bf16 v[244:247], v[36:39], v[76:79], v[244:247]
  ds_read_b64_tr_b16 v[26:27], v10 offset:512
  ds_read_b64_tr_b16 v[28:29], v8 offset:8192
  ds_read_b64_tr_b16 v[30:31], v10 offset:8704
  s_waitcnt lgkmcnt(8)
  v_mfma_f32_16x16x32_bf16 v[248:251], v[40:43], v[64:67], 0
  ds_read_b64_tr_b16 v[32:33], v9 offset:0
  v_mfma_f32_16x16x32_bf16 v[248:251], v[44:47], v[72:75], v[248:251]
  ds_read_b64_tr_b16 v[34:35], v7 offset:512
  v_mfma_f32_16x16x32_bf16 v[252:255], v[40:43], v[68:71], 0
  ds_read_b64_tr_b16 v[36:37], v9 offset:8192
  v_mfma_f32_16x16x32_bf16 v[252:255], v[44:47], v[76:79], v[252:255]
  ds_read_b64_tr_b16 v[38:39], v7 offset:8704
  s_waitcnt lgkmcnt(8)
  v_mfma_f32_16x16x32_bf16 v[192:195], v[16:19], v[80:83], v[192:195]
  ds_read_b64_tr_b16 v[40:41], v10 offset:0
  v_mfma_f32_16x16x32_bf16 v[192:195], v[20:23], v[88:91], v[192:195]
  ds_read_b64_tr_b16 v[42:43], v8 offset:512
  v_mfma_f32_16x16x32_bf16 v[196:199], v[16:19], v[84:87], v[196:199]
  ds_read_b64_tr_b16 v[44:45], v10 offset:8192
  v_mfma_f32_16x16x32_bf16 v[196:199], v[20:23], v[92:95], v[196:199]
  ds_read_b64_tr_b16 v[46:47], v8 offset:8704
  s_add_u32 m0, s28, 49152
  s_add_u32 s30, s26, 1572864
  buffer_load_dwordx4 v49, s[8:11], s30 offen lds
  s_waitcnt lgkmcnt(8)
  v_mfma_f32_16x16x32_bf16 v[200:203], v[24:27], v[80:83], v[200:203]
  ds_read_b64_tr_b16 v[16:17], v7 offset:1024
  v_mfma_f32_16x16x32_bf16 v[200:203], v[28:31], v[88:91], v[200:203]
  ds_read_b64_tr_b16 v[18:19], v9 offset:1536
  v_mfma_f32_16x16x32_bf16 v[204:207], v[24:27], v[84:87], v[204:207]
  ds_read_b64_tr_b16 v[20:21], v7 offset:9216
  v_mfma_f32_16x16x32_bf16 v[204:207], v[28:31], v[92:95], v[204:207]
  ds_read_b64_tr_b16 v[22:23], v9 offset:9728
  s_add_u32 m0, s28, 57344
  s_add_u32 s30, s26, 1835008
  buffer_load_dwordx4 v49, s[8:11], s30 offen lds
  s_waitcnt lgkmcnt(8)
  v_mfma_f32_16x16x32_bf16 v[208:211], v[32:35], v[80:83], v[208:211]
  ds_read_b64_tr_b16 v[24:25], v8 offset:1024
  v_mfma_f32_16x16x32_bf16 v[208:211], v[36:39], v[88:91], v[208:211]
  ds_read_b64_tr_b16 v[26:27], v10 offset:1536
  v_mfma_f32_16x16x32_bf16 v[212:215], v[32:35], v[84:87], v[212:215]
  ds_read_b64_tr_b16 v[28:29], v8 offset:9216
  v_mfma_f32_16x16x32_bf16 v[212:215], v[36:39], v[92:95], v[212:215]
  ds_read_b64_tr_b16 v[30:31], v10 offset:9728
  s_add_u32 m0, s28, 16384
  s_add_u32 s30, s25, 384
  buffer_load_dwordx4 v48, s[12:15], s30 offen lds
  s_waitcnt lgkmcnt(8)
  v_mfma_f32_16x16x32_bf16 v[216:219], v[40:43], v[80:83], v[216:219]
  ds_read_b64_tr_b16 v[32:33], v9 offset:1024
  v_mfma_f32_16x16x32_bf16 v[216:219], v[44:47], v[88:91], v[216:219]
  ds_read_b64_tr_b16 v[34:35], v7 offset:1536
  v_mfma_f32_16x16x32_bf16 v[220:223], v[40:43], v[84:87], v[220:223]
  ds_read_b64_tr_b16 v[36:37], v9 offset:9216
  v_mfma_f32_16x16x32_bf16 v[220:223], v[44:47], v[92:95], v[220:223]
  ds_read_b64_tr_b16 v[38:39], v7 offset:9728
  s_add_u32 m0, s28, 24576
  s_add_u32 s30, s25, 65920
  buffer_load_dwordx4 v48, s[12:15], s30 offen lds
  s_waitcnt lgkmcnt(8)
  v_mfma_f32_16x16x32_bf16 v[224:227], v[16:19], v[80:83], v[224:227]
  ds_read_b64_tr_b16 v[40:41], v10 offset:1024
  v_mfma_f32_16x16x32_bf16 v[224:227], v[20:23], v[88:91], v[224:227]
  ds_read_b64_tr_b16 v[42:43], v8 offset:1536
  v_mfma_f32_16x16x32_bf16 v[228:231], v[16:19], v[84:87], v[228:231]
  ds_read_b64_tr_b16 v[44:45], v10 offset:9216
  v_mfma_f32_16x16x32_bf16 v[228:231], v[20:23], v[92:95], v[228:231]
  ds_read_b64_tr_b16 v[46:47], v8 offset:9728
  s_add_u32 m0, s28, 32768
  s_add_u32 s30, s25, 131456
  buffer_load_dwordx4 v48, s[12:15], s30 offen lds
  s_add_u32 m0, s28, 40960
  s_add_u32 s30, s25, 196992
  buffer_load_dwordx4 v48, s[12:15], s30 offen lds
  s_cmp_lg_u32 s20, 7
  s_cbranch_scc1 L_o1_front_kernel
  v_lshrrev_b32 v11, 1, v1
  v_and_b32 v13, 1, v1
  v_lshlrev_b32 v13, 7, v13
  v_lshl_add_u32 v11, v11, 13, v13
  s_mul_i32 s30, s23, 524288
  s_add_u32 s30, s30, s26
  buffer_load_dword v62, v11, s[16:19], s30 offen
  s_add_u32 s30, s30, 262144
  buffer_load_dword v62, v11, s[16:19], s30 offen
  s_add_u32 s30, s30, 262144
  s_mov_b64 exec, -1
L_o1_front_kernel:
  s_waitcnt lgkmcnt(8)
  v_mfma_f32_16x16x32_bf16 v[232:235], v[24:27], v[80:83], v[232:235]
  v_add_u32 v52, 49152, v52
  v_add_u32 v53, 49152, v53
  v_mfma_f32_16x16x32_bf16 v[232:235], v[28:31], v[88:91], v[232:235]
  v_add_u32 v7, 49152, v7
  v_add_u32 v8, 49152, v8
  v_mfma_f32_16x16x32_bf16 v[236:239], v[24:27], v[84:87], v[236:239]
  v_add_u32 v9, 49152, v9
  v_add_u32 v10, 49152, v10
  v_mfma_f32_16x16x32_bf16 v[236:239], v[28:31], v[92:95], v[236:239]
  s_waitcnt lgkmcnt(0)
  s_waitcnt vmcnt(6)
  s_barrier
  v_mfma_f32_16x16x32_bf16 v[240:243], v[32:35], v[80:83], v[240:243]
  ds_read_b128 v[96:99], v52 offset:0
  ds_read_b128 v[104:107], v53 offset:0
  ds_read_b128 v[100:103], v52 offset:2048
  v_mfma_f32_16x16x32_bf16 v[240:243], v[36:39], v[88:91], v[240:243]
  ds_read_b128 v[108:111], v53 offset:2048
  ds_read_b64_tr_b16 v[16:17], v7 offset:0
  ds_read_b64_tr_b16 v[18:19], v9 offset:512
  v_mfma_f32_16x16x32_bf16 v[244:247], v[32:35], v[84:87], v[244:247]
  ds_read_b64_tr_b16 v[20:21], v7 offset:8192
  ds_read_b64_tr_b16 v[22:23], v9 offset:8704
  ds_read_b64_tr_b16 v[24:25], v8 offset:0
  v_mfma_f32_16x16x32_bf16 v[244:247], v[36:39], v[92:95], v[244:247]
  ds_read_b64_tr_b16 v[26:27], v10 offset:512
  ds_read_b64_tr_b16 v[28:29], v8 offset:8192
  ds_read_b64_tr_b16 v[30:31], v10 offset:8704
  s_waitcnt lgkmcnt(8)
  v_mfma_f32_16x16x32_bf16 v[248:251], v[40:43], v[80:83], v[248:251]
  ds_read_b64_tr_b16 v[32:33], v9 offset:0
  v_mfma_f32_16x16x32_bf16 v[248:251], v[44:47], v[88:91], v[248:251]
  ds_read_b64_tr_b16 v[34:35], v7 offset:512
  v_mfma_f32_16x16x32_bf16 v[252:255], v[40:43], v[84:87], v[252:255]
  ds_read_b64_tr_b16 v[36:37], v9 offset:8192
  v_mfma_f32_16x16x32_bf16 v[252:255], v[44:47], v[92:95], v[252:255]
  ds_read_b64_tr_b16 v[38:39], v7 offset:8704
  s_waitcnt lgkmcnt(8)
  v_mfma_f32_16x16x32_bf16 v[192:195], v[16:19], v[96:99], v[192:195]
  ds_read_b64_tr_b16 v[40:41], v10 offset:0
  v_mfma_f32_16x16x32_bf16 v[192:195], v[20:23], v[104:107], v[192:195]
  ds_read_b64_tr_b16 v[42:43], v8 offset:512
  v_mfma_f32_16x16x32_bf16 v[196:199], v[16:19], v[100:103], v[196:199]
  ds_read_b64_tr_b16 v[44:45], v10 offset:8192
  v_mfma_f32_16x16x32_bf16 v[196:199], v[20:23], v[108:111], v[196:199]
  ds_read_b64_tr_b16 v[46:47], v8 offset:8704
  s_add_u32 m0, s28, 98304
  s_add_u32 s30, s26, 2097152
  buffer_load_dwordx4 v49, s[8:11], s30 offen lds
  s_waitcnt lgkmcnt(8)
  v_mfma_f32_16x16x32_bf16 v[200:203], v[24:27], v[96:99], v[200:203]
  ds_read_b64_tr_b16 v[16:17], v7 offset:1024
  v_mfma_f32_16x16x32_bf16 v[200:203], v[28:31], v[104:107], v[200:203]
  ds_read_b64_tr_b16 v[18:19], v9 offset:1536
  v_mfma_f32_16x16x32_bf16 v[204:207], v[24:27], v[100:103], v[204:207]
  ds_read_b64_tr_b16 v[20:21], v7 offset:9216
  v_mfma_f32_16x16x32_bf16 v[204:207], v[28:31], v[108:111], v[204:207]
  ds_read_b64_tr_b16 v[22:23], v9 offset:9728
  s_add_u32 m0, s28, 106496
  s_add_u32 s30, s26, 2359296
  buffer_load_dwordx4 v49, s[8:11], s30 offen lds
  s_cmp_lg_u32 s22, 1
  s_cbranch_scc1 L_o2_front_kernel
  s_mov_b32 s38, 0x3ae38e39
  s_mov_b32 s39, 0x3727c5ac
  v_lshlrev_b32 v160, 16, v144
  v_and_b32 v161, 0xffff0000, v144
  v_lshlrev_b32 v162, 16, v145
  v_and_b32 v163, 0xffff0000, v145
  v_lshlrev_b32 v164, 16, v146
  v_and_b32 v165, 0xffff0000, v146
  v_lshlrev_b32 v166, 16, v147
  v_and_b32 v167, 0xffff0000, v147
  v_lshlrev_b32 v168, 16, v148
  v_and_b32 v169, 0xffff0000, v148
  v_lshlrev_b32 v170, 16, v149
  v_and_b32 v171, 0xffff0000, v149
  v_lshlrev_b32 v172, 16, v150
  v_and_b32 v173, 0xffff0000, v150
  v_lshlrev_b32 v174, 16, v151
  v_and_b32 v175, 0xffff0000, v151
  v_lshlrev_b32 v176, 16, v152
  v_and_b32 v177, 0xffff0000, v152
  v_add_f32 v12, v160, v161
  v_add_f32 v13, v162, v163
  v_add_f32 v12, v12, v164
  v_add_f32 v13, v13, v165
  v_add_f32 v12, v12, v166
  v_add_f32 v13, v13, v167
  v_add_f32 v12, v12, v168
  v_add_f32 v13, v13, v169
  v_add_f32 v12, v12, v170
  v_add_f32 v13, v13, v171
  v_add_f32 v12, v12, v172
  v_add_f32 v13, v13, v173
  v_add_f32 v12, v12, v174
  v_add_f32 v13, v13, v175
  v_add_f32 v12, v12, v176
  v_add_f32 v13, v13, v177
  v_add_f32 v12, v12, v13
  s_nop 1
  v_add_f32_dpp v12, v12, v12 row_ror:8 row_mask:0xf bank_mask:0xf
  s_nop 1
  v_add_f32_dpp v12, v12, v12 row_ror:4 row_mask:0xf bank_mask:0xf
  s_nop 1
  v_add_f32_dpp v12, v12, v12 row_ror:2 row_mask:0xf bank_mask:0xf
  s_nop 1
  v_add_f32_dpp v12, v12, v12 row_ror:1 row_mask:0xf bank_mask:0xf
  v_mov_b32 v13, v12
  s_nop 1
  v_permlane16_swap_b32 v13, v12
  v_add_f32 v12, v12, v13
  v_mul_f32 v12, s38, v12
  v_sub_f32 v160, v160, v12
  v_sub_f32 v161, v161, v12
  v_sub_f32 v162, v162, v12
  v_sub_f32 v163, v163, v12
  v_sub_f32 v164, v164, v12
  v_sub_f32 v165, v165, v12
  v_sub_f32 v166, v166, v12
  v_sub_f32 v167, v167, v12
  v_sub_f32 v168, v168, v12
  v_sub_f32 v169, v169, v12
  v_sub_f32 v170, v170, v12
  v_sub_f32 v171, v171, v12
  v_sub_f32 v172, v172, v12
  v_sub_f32 v173, v173, v12
  v_sub_f32 v174, v174, v12
  v_sub_f32 v175, v175, v12
  v_sub_f32 v176, v176, v12
  v_sub_f32 v177, v177, v12
  v_mul_f32 v12, v160, v160
  v_mul_f32 v13, v161, v161
  v_fmac_f32 v12, v162, v162
  v_fmac_f32 v13, v163, v163
  v_fmac_f32 v12, v164, v164
  v_fmac_f32 v13, v165, v165
  v_fmac_f32 v12, v166, v166
  v_fmac_f32 v13, v167, v167
  v_fmac_f32 v12, v168, v168
  v_fmac_f32 v13, v169, v169
  v_fmac_f32 v12, v170, v170
  v_fmac_f32 v13, v171, v171
  v_fmac_f32 v12, v172, v172
  v_fmac_f32 v13, v173, v173
  v_fmac_f32 v12, v174, v174
  v_fmac_f32 v13, v175, v175
  v_fmac_f32 v12, v176, v176
  v_fmac_f32 v13, v177, v177
  v_add_f32 v12, v12, v13
  s_nop 1
  v_add_f32_dpp v12, v12, v12 row_ror:8 row_mask:0xf bank_mask:0xf
  s_nop 1
  v_add_f32_dpp v12, v12, v12 row_ror:4 row_mask:0xf bank_mask:0xf
  s_nop 1
  v_add_f32_dpp v12, v12, v12 row_ror:2 row_mask:0xf bank_mask:0xf
  s_nop 1
  v_add_f32_dpp v12, v12, v12 row_ror:1 row_mask:0xf bank_mask:0xf
  v_mov_b32 v13, v12
  s_nop 1
  v_permlane16_swap_b32 v13, v12
  v_add_f32 v12, v12, v13
  v_mov_b32 v13, s39
  v_fmac_f32 v13, s38, v12
  v_rsq_f32 v13, v13
  s_nop 0
  v_mul_f32 v160, v160, v13
  v_mul_f32 v161, v161, v13
  v_mul_f32 v162, v162, v13
  v_mul_f32 v163, v163, v13
  v_mul_f32 v164, v164, v13
  v_mul_f32 v165, v165, v13
  v_mul_f32 v166, v166, v13
  v_mul_f32 v167, v167, v13
  v_mul_f32 v168, v168, v13
  v_mul_f32 v169, v169, v13
  v_mul_f32 v170, v170, v13
  v_mul_f32 v171, v171, v13
  v_mul_f32 v172, v172, v13
  v_mul_f32 v173, v173, v13
  v_mul_f32 v174, v174, v13
  v_mul_f32 v175, v175, v13
  v_mul_f32 v176, v176, v13
  v_mul_f32 v177, v177, v13
  v_cvt_pk_bf16_f32 v182, v160, v161
  v_cvt_pk_bf16_f32 v183, v162, v163
  v_cvt_pk_bf16_f32 v184, v164, v165
  v_cvt_pk_bf16_f32 v185, v166, v167
  v_cvt_pk_bf16_f32 v186, v168, v169
  v_cvt_pk_bf16_f32 v187, v170, v171
  v_cvt_pk_bf16_f32 v188, v172, v173
  v_cvt_pk_bf16_f32 v189, v174, v175
  v_cvt_pk_bf16_f32 v190, v176, v177
L_o2_front_kernel:
  s_waitcnt lgkmcnt(8)
  v_mfma_f32_16x16x32_bf16 v[208:211], v[32:35], v[96:99], v[208:211]
  ds_read_b64_tr_b16 v[24:25], v8 offset:1024
  v_mfma_f32_16x16x32_bf16 v[208:211], v[36:39], v[104:107], v[208:211]
  ds_read_b64_tr_b16 v[26:27], v10 offset:1536
  v_mfma_f32_16x16x32_bf16 v[212:215], v[32:35], v[100:103], v[212:215]
  ds_read_b64_tr_b16 v[28:29], v8 offset:9216
  v_mfma_f32_16x16x32_bf16 v[212:215], v[36:39], v[108:111], v[212:215]
  ds_read_b64_tr_b16 v[30:31], v10 offset:9728
  s_add_u32 m0, s28, 65536
  s_add_u32 s30, s25, 512
  buffer_load_dwordx4 v48, s[12:15], s30 offen lds
  s_waitcnt lgkmcnt(8)
  v_mfma_f32_16x16x32_bf16 v[216:219], v[40:43], v[96:99], v[216:219]
  ds_read_b64_tr_b16 v[32:33], v9 offset:1024
  v_mfma_f32_16x16x32_bf16 v[216:219], v[44:47], v[104:107], v[216:219]
  ds_read_b64_tr_b16 v[34:35], v7 offset:1536
  v_mfma_f32_16x16x32_bf16 v[220:223], v[40:43], v[100:103], v[220:223]
  ds_read_b64_tr_b16 v[36:37], v9 offset:9216
  v_mfma_f32_16x16x32_bf16 v[220:223], v[44:47], v[108:111], v[220:223]
  ds_read_b64_tr_b16 v[38:39], v7 offset:9728
  s_add_u32 m0, s28, 73728
  s_add_u32 s30, s25, 66048
  buffer_load_dwordx4 v48, s[12:15], s30 offen lds
  s_waitcnt lgkmcnt(8)
  v_mfma_f32_16x16x32_bf16 v[224:227], v[16:19], v[96:99], v[224:227]
  ds_read_b64_tr_b16 v[40:41], v10 offset:1024
  v_mfma_f32_16x16x32_bf16 v[224:227], v[20:23], v[104:107], v[224:227]
  ds_read_b64_tr_b16 v[42:43], v8 offset:1536
  v_mfma_f32_16x16x32_bf16 v[228:231], v[16:19], v[100:103], v[228:231]
  ds_read_b64_tr_b16 v[44:45], v10 offset:9216
  v_mfma_f32_16x16x32_bf16 v[228:231], v[20:23], v[108:111], v[228:231]
  ds_read_b64_tr_b16 v[46:47], v8 offset:9728
  s_add_u32 m0, s28, 81920
  s_add_u32 s30, s25, 131584
  buffer_load_dwordx4 v48, s[12:15], s30 offen lds
  s_add_u32 m0, s28, 90112
  s_add_u32 s30, s25, 197120
  buffer_load_dwordx4 v48, s[12:15], s30 offen lds
  s_waitcnt lgkmcnt(8)
  v_mfma_f32_16x16x32_bf16 v[232:235], v[24:27], v[96:99], v[232:235]
  v_add_u32 v52, 4294868992, v52
  v_add_u32 v53, 4294868992, v53
  v_mfma_f32_16x16x32_bf16 v[232:235], v[28:31], v[104:107], v[232:235]
  v_add_u32 v7, 4294868992, v7
  v_add_u32 v8, 4294868992, v8
  v_mfma_f32_16x16x32_bf16 v[236:239], v[24:27], v[100:103], v[236:239]
  v_add_u32 v9, 4294868992, v9
  v_add_u32 v10, 4294868992, v10
  v_mfma_f32_16x16x32_bf16 v[236:239], v[28:31], v[108:111], v[236:239]
  s_waitcnt lgkmcnt(0)
  s_waitcnt vmcnt(6)
  s_barrier
  s_cmp_lg_u32 s20, 6
  s_cbranch_scc1 L_o3_front_kernel
  buffer_load_dword v60, v58, s[52:55], s96 offen sc1
L_o3_front_kernel:
  v_mfma_f32_16x16x32_bf16 v[240:243], v[32:35], v[96:99], v[240:243]
  ds_read_b128 v[112:115], v52 offset:0
  ds_read_b128 v[120:123], v53 offset:0
  ds_read_b128 v[116:119], v52 offset:2048
  v_mfma_f32_16x16x32_bf16 v[240:243], v[36:39], v[104:107], v[240:243]
  ds_read_b128 v[124:127], v53 offset:2048
  ds_read_b64_tr_b16 v[16:17], v7 offset:0
  ds_read_b64_tr_b16 v[18:19], v9 offset:512
  v_mfma_f32_16x16x32_bf16 v[244:247], v[32:35], v[100:103], v[244:247]
  ds_read_b64_tr_b16 v[20:21], v7 offset:8192
  ds_read_b64_tr_b16 v[22:23], v9 offset:8704
  ds_read_b64_tr_b16 v[24:25], v8 offset:0
  v_mfma_f32_16x16x32_bf16 v[244:247], v[36:39], v[108:111], v[244:247]
  ds_read_b64_tr_b16 v[26:27], v10 offset:512
  ds_read_b64_tr_b16 v[28:29], v8 offset:8192
  ds_read_b64_tr_b16 v[30:31], v10 offset:8704
  s_waitcnt lgkmcnt(8)
  v_mfma_f32_16x16x32_bf16 v[248:251], v[40:43], v[96:99], v[248:251]
  ds_read_b64_tr_b16 v[32:33], v9 offset:0
  v_mfma_f32_16x16x32_bf16 v[248:251], v[44:47], v[104:107], v[248:251]
  ds_read_b64_tr_b16 v[34:35], v7 offset:512
  v_mfma_f32_16x16x32_bf16 v[252:255], v[40:43], v[100:103], v[252:255]
  ds_read_b64_tr_b16 v[36:37], v9 offset:8192
  v_mfma_f32_16x16x32_bf16 v[252:255], v[44:47], v[108:111], v[252:255]
  ds_read_b64_tr_b16 v[38:39], v7 offset:8704
  s_waitcnt lgkmcnt(8)
  v_mfma_f32_16x16x32_bf16 v[192:195], v[16:19], v[112:115], v[192:195]
  ds_read_b64_tr_b16 v[40:41], v10 offset:0
  v_mfma_f32_16x16x32_bf16 v[192:195], v[20:23], v[120:123], v[192:195]
  ds_read_b64_tr_b16 v[42:43], v8 offset:512
  v_mfma_f32_16x16x32_bf16 v[196:199], v[16:19], v[116:119], v[196:199]
  ds_read_b64_tr_b16 v[44:45], v10 offset:8192
  v_mfma_f32_16x16x32_bf16 v[196:199], v[20:23], v[124:127], v[196:199]
  ds_read_b64_tr_b16 v[46:47], v8 offset:8704
  s_add_u32 m0, s28, 147456
  s_add_u32 s30, s26, 2621440
  buffer_load_dwordx4 v49, s[8:11], s30 offen lds
  s_waitcnt lgkmcnt(8)
  v_mfma_f32_16x16x32_bf16 v[200:203], v[24:27], v[112:115], v[200:203]
  ds_read_b64_tr_b16 v[16:17], v7 offset:1024
  v_mfma_f32_16x16x32_bf16 v[200:203], v[28:31], v[120:123], v[200:203]
  ds_read_b64_tr_b16 v[18:19], v9 offset:1536
  v_mfma_f32_16x16x32_bf16 v[204:207], v[24:27], v[116:119], v[204:207]
  ds_read_b64_tr_b16 v[20:21], v7 offset:9216
  v_mfma_f32_16x16x32_bf16 v[204:207], v[28:31], v[124:127], v[204:207]
  ds_read_b64_tr_b16 v[22:23], v9 offset:9728
  s_add_u32 m0, s28, 155648
  s_add_u32 s30, s26, 2883584
  buffer_load_dwordx4 v49, s[8:11], s30 offen lds
  s_waitcnt lgkmcnt(8)
  v_mfma_f32_16x16x32_bf16 v[208:211], v[32:35], v[112:115], v[208:211]
  ds_read_b64_tr_b16 v[24:25], v8 offset:1024
  v_mfma_f32_16x16x32_bf16 v[208:211], v[36:39], v[120:123], v[208:211]
  ds_read_b64_tr_b16 v[26:27], v10 offset:1536
  v_mfma_f32_16x16x32_bf16 v[212:215], v[32:35], v[116:119], v[212:215]
  ds_read_b64_tr_b16 v[28:29], v8 offset:9216
  v_mfma_f32_16x16x32_bf16 v[212:215], v[36:39], v[124:127], v[212:215]
  ds_read_b64_tr_b16 v[30:31], v10 offset:9728
  s_add_u32 m0, s28, 114688
  s_add_u32 s30, s25, 640
  buffer_load_dwordx4 v48, s[12:15], s30 offen lds
  s_waitcnt lgkmcnt(8)
  v_mfma_f32_16x16x32_bf16 v[216:219], v[40:43], v[112:115], v[216:219]
  ds_read_b64_tr_b16 v[32:33], v9 offset:1024
  v_mfma_f32_16x16x32_bf16 v[216:219], v[44:47], v[120:123], v[216:219]
  ds_read_b64_tr_b16 v[34:35], v7 offset:1536
  v_mfma_f32_16x16x32_bf16 v[220:223], v[40:43], v[116:119], v[220:223]
  ds_read_b64_tr_b16 v[36:37], v9 offset:9216
  v_mfma_f32_16x16x32_bf16 v[220:223], v[44:47], v[124:127], v[220:223]
  ds_read_b64_tr_b16 v[38:39], v7 offset:9728
  s_add_u32 m0, s28, 122880
  s_add_u32 s30, s25, 66176
  buffer_load_dwordx4 v48, s[12:15], s30 offen lds
  s_waitcnt lgkmcnt(8)
  v_mfma_f32_16x16x32_bf16 v[224:227], v[16:19], v[112:115], v[224:227]
  ds_read_b64_tr_b16 v[40:41], v10 offset:1024
  v_mfma_f32_16x16x32_bf16 v[224:227], v[20:23], v[120:123], v[224:227]
  ds_read_b64_tr_b16 v[42:43], v8 offset:1536
  v_mfma_f32_16x16x32_bf16 v[228:231], v[16:19], v[116:119], v[228:231]
  ds_read_b64_tr_b16 v[44:45], v10 offset:9216
  v_mfma_f32_16x16x32_bf16 v[228:231], v[20:23], v[124:127], v[228:231]
  ds_read_b64_tr_b16 v[46:47], v8 offset:9728
  s_add_u32 m0, s28, 131072
  s_add_u32 s30, s25, 131712
  buffer_load_dwordx4 v48, s[12:15], s30 offen lds
  s_add_u32 m0, s28, 139264
  s_add_u32 s30, s25, 197248
  buffer_load_dwordx4 v48, s[12:15], s30 offen lds
  s_waitcnt lgkmcnt(8)
  v_mfma_f32_16x16x32_bf16 v[232:235], v[24:27], v[112:115], v[232:235]
  v_add_u32 v52, 49152, v52
  v_add_u32 v53, 49152, v53
  v_mfma_f32_16x16x32_bf16 v[232:235], v[28:31], v[120:123], v[232:235]
  v_add_u32 v7, 49152, v7
  v_add_u32 v8, 49152, v8
  v_mfma_f32_16x16x32_bf16 v[236:239], v[24:27], v[116:119], v[236:239]
  v_add_u32 v9, 49152, v9
  v_add_u32 v10, 49152, v10
  v_mfma_f32_16x16x32_bf16 v[236:239], v[28:31], v[124:127], v[236:239]
  s_waitcnt lgkmcnt(0)
  s_cmp_lg_u32 s20, 6
  s_cbranch_scc1 L_o4_front_kernel
  s_waitcnt vmcnt(6)
L_chkm_front_kernel:
  v_readfirstlane_b32 s30, v60
  s_nop 0
  s_cmp_ge_u32 s30, 108
  s_cbranch_scc0 L_spinm_front_kernel
  s_branch L_okm_front_kernel
L_spinm_front_kernel:
  s_add_u32 s100, s100, 1
  s_cmp_gt_u32 s100, 0x20000
  s_cbranch_scc1 L_end_front_kernel
  s_sleep 2
  buffer_load_dword v60, v58, s[52:55], s96 offen sc1
  s_waitcnt vmcnt(0)
  s_branch L_chkm_front_kernel
L_okm_front_kernel:
L_o4_front_kernel:
  s_waitcnt vmcnt(6)
  s_barrier
  s_cmp_ge_u32 s20, 3
  s_cbranch_scc1 L_o5_front_kernel
  s_lshl_b32 s30, s20, 10
  s_add_u32 s30, s30, 16384
  s_add_u32 s31, s30, 0
  buffer_load_dwordx4 v[144:147], v6, s[4:7], s31 offen
  s_add_u32 s31, s30, 2304
  buffer_load_dwordx4 v[156:159], v6, s[4:7], s31 offen
  s_add_u32 s31, s30, 4608
  buffer_load_dwordx4 v[148:151], v6, s[4:7], s31 offen
  s_add_u32 s31, s30, 6912
  buffer_load_dwordx4 v[160:163], v6, s[4:7], s31 offen
  s_add_u32 s31, s30, 9216
  buffer_load_dwordx4 v[152:155], v6, s[4:7], s31 offen
  s_add_u32 s31, s30, 11520
  buffer_load_dwordx4 v[164:167], v6, s[4:7], s31 offen
L_o5_front_kernel:
  v_mfma_f32_16x16x32_bf16 v[240:243], v[32:35], v[112:115], v[240:243]
  ds_read_b128 v[128:131], v52 offset:0
  ds_read_b128 v[136:139], v53 offset:0
  ds_read_b128 v[132:135], v52 offset:2048
  v_mfma_f32_16x16x32_bf16 v[240:243], v[36:39], v[120:123], v[240:243]
  ds_read_b128 v[140:143], v53 offset:2048
  ds_read_b64_tr_b16 v[16:17], v7 offset:0
  ds_read_b64_tr_b16 v[18:19], v9 offset:512
  v_mfma_f32_16x16x32_bf16 v[244:247], v[32:35], v[116:119], v[244:247]
  ds_read_b64_tr_b16 v[20:21], v7 offset:8192
  ds_read_b64_tr_b16 v[22:23], v9 offset:8704
  ds_read_b64_tr_b16 v[24:25], v8 offset:0
  v_mfma_f32_16x16x32_bf16 v[244:247], v[36:39], v[124:127], v[244:247]
  ds_read_b64_tr_b16 v[26:27], v10 offset:512
  ds_read_b64_tr_b16 v[28:29], v8 offset:8192
  ds_read_b64_tr_b16 v[30:31], v10 offset:8704
  s_waitcnt lgkmcnt(8)
  v_mfma_f32_16x16x32_bf16 v[248:251], v[40:43], v[112:115], v[248:251]
  ds_read_b64_tr_b16 v[32:33], v9 offset:0
  v_mfma_f32_16x16x32_bf16 v[248:251], v[44:47], v[120:123], v[248:251]
  ds_read_b64_tr_b16 v[34:35], v7 offset:512
  v_mfma_f32_16x16x32_bf16 v[252:255], v[40:43], v[116:119], v[252:255]
  ds_read_b64_tr_b16 v[36:37], v9 offset:8192
  v_mfma_f32_16x16x32_bf16 v[252:255], v[44:47], v[124:127], v[252:255]
  ds_read_b64_tr_b16 v[38:39], v7 offset:8704
  s_waitcnt lgkmcnt(8)
  v_mfma_f32_16x16x32_bf16 v[192:195], v[16:19], v[128:131], v[192:195]
  ds_read_b64_tr_b16 v[40:41], v10 offset:0
  v_mfma_f32_16x16x32_bf16 v[192:195], v[20:23], v[136:139], v[192:195]
  ds_read_b64_tr_b16 v[42:43], v8 offset:512
  v_mfma_f32_16x16x32_bf16 v[196:199], v[16:19], v[132:135], v[196:199]
  ds_read_b64_tr_b16 v[44:45], v10 offset:8192
  v_mfma_f32_16x16x32_bf16 v[196:199], v[20:23], v[140:143], v[196:199]
  ds_read_b64_tr_b16 v[46:47], v8 offset:8704
  s_add_u32 m0, s28, 49152
  s_add_u32 s30, s26, 3145728
  buffer_load_dwordx4 v49, s[8:11], s30 offen lds
  s_waitcnt lgkmcnt(8)
  v_mfma_f32_16x16x32_bf16 v[200:203], v[24:27], v[128:131], v[200:203]
  ds_read_b64_tr_b16 v[16:17], v7 offset:1024
  v_mfma_f32_16x16x32_bf16 v[200:203], v[28:31], v[136:139], v[200:203]
  ds_read_b64_tr_b16 v[18:19], v9 offset:1536
  v_mfma_f32_16x16x32_bf16 v[204:207], v[24:27], v[132:135], v[204:207]
  ds_read_b64_tr_b16 v[20:21], v7 offset:9216
  v_mfma_f32_16x16x32_bf16 v[204:207], v[28:31], v[140:143], v[204:207]
  ds_read_b64_tr_b16 v[22:23], v9 offset:9728
  s_add_u32 m0, s28, 57344
  s_add_u32 s30, s26, 3407872
  buffer_load_dwordx4 v49, s[8:11], s30 offen lds
  s_waitcnt lgkmcnt(8)
  v_mfma_f32_16x16x32_bf16 v[208:211], v[32:35], v[128:131], v[208:211]
  ds_read_b64_tr_b16 v[24:25], v8 offset:1024
  v_mfma_f32_16x16x32_bf16 v[208:211], v[36:39], v[136:139], v[208:211]
  ds_read_b64_tr_b16 v[26:27], v10 offset:1536
  v_mfma_f32_16x16x32_bf16 v[212:215], v[32:35], v[132:135], v[212:215]
  ds_read_b64_tr_b16 v[28:29], v8 offset:9216
  v_mfma_f32_16x16x32_bf16 v[212:215], v[36:39], v[140:143], v[212:215]
  ds_read_b64_tr_b16 v[30:31], v10 offset:9728
  s_add_u32 m0, s28, 16384
  s_add_u32 s30, s25, 768
  buffer_load_dwordx4 v48, s[12:15], s30 offen lds
  s_waitcnt lgkmcnt(8)
  v_mfma_f32_16x16x32_bf16 v[216:219], v[40:43], v[128:131], v[216:219]
  ds_read_b64_tr_b16 v[32:33], v9 offset:1024
  v_mfma_f32_16x16x32_bf16 v[216:219], v[44:47], v[136:139], v[216:219]
  ds_read_b64_tr_b16 v[34:35], v7 offset:1536
  v_mfma_f32_16x16x32_bf16 v[220:223], v[40:43], v[132:135], v[220:223]
  ds_read_b64_tr_b16 v[36:37], v9 offset:9216
  v_mfma_f32_16x16x32_bf16 v[220:223], v[44:47], v[140:143], v[220:223]
  ds_read_b64_tr_b16 v[38:39], v7 offset:9728
  s_add_u32 m0, s28, 24576
  s_add_u32 s30, s25, 66304
  buffer_load_dwordx4 v48, s[12:15], s30 offen lds
  s_cmp_ge_u32 s20, 3
  s_cbranch_scc1 L_o6_front_kernel
  s_waitcnt vmcnt(4)
  v_add_f32 v144, v144, v148
  v_add_f32 v144, v144, v152
  v_add_f32 v145, v145, v149
  v_add_f32 v145, v145, v153
  v_add_f32 v146, v146, v150
  v_add_f32 v146, v146, v154
  v_add_f32 v147, v147, v151
  v_add_f32 v147, v147, v155
  v_add_f32 v156, v156, v160
  v_add_f32 v156, v156, v164
  v_add_f32 v157, v157, v161
  v_add_f32 v157, v157, v165
  v_add_f32 v158, v158, v162
  v_add_f32 v158, v158, v166
  v_add_f32 v159, v159, v163
  v_add_f32 v159, v159, v167
  v_cvt_pk_bf16_f32 v156, v156, v156
  v_lshlrev_b32 v156, 16, v156
  v_add_f32 v156, 1.0, v156
  v_cvt_pk_bf16_f32 v148, v156, v144
  v_cvt_pk_bf16_f32 v157, v157, v157
  v_lshlrev_b32 v157, 16, v157
  v_add_f32 v157, 1.0, v157
  v_cvt_pk_bf16_f32 v149, v157, v145
  v_cvt_pk_bf16_f32 v158, v158, v158
  v_lshlrev_b32 v158, 16, v158
  v_add_f32 v158, 1.0, v158
  v_cvt_pk_bf16_f32 v150, v158, v146
  v_cvt_pk_bf16_f32 v159, v159, v159
  v_lshlrev_b32 v159, 16, v159
  v_add_f32 v159, 1.0, v159
  v_cvt_pk_bf16_f32 v151, v159, v147
  s_lshl_b32 s30, s20, 10
  s_add_u32 s30, s30, 4096
  v_add_u32 v12, s30, v6
  ds_write_b128 v12, v[148:151]
L_o6_front_kernel:
  s_waitcnt lgkmcnt(8)
  v_mfma_f32_16x16x32_bf16 v[224:227], v[16:19], v[128:131], v[224:227]
  ds_read_b64_tr_b16 v[40:41], v10 offset:1024
  v_mfma_f32_16x16x32_bf16 v[224:227], v[20:23], v[136:139], v[224:227]
  ds_read_b64_tr_b16 v[42:43], v8 offset:1536
  v_mfma_f32_16x16x32_bf16 v[228:231], v[16:19], v[132:135], v[228:231]
  ds_read_b64_tr_b16 v[44:45], v10 offset:9216
  v_mfma_f32_16x16x32_bf16 v[228:231], v[20:23], v[140:143], v[228:231]
  ds_read_b64_tr_b16 v[46:47], v8 offset:9728
  s_add_u32 m0, s28, 32768
  s_add_u32 s30, s25, 131840
  buffer_load_dwordx4 v48, s[12:15], s30 offen lds
  s_add_u32 m0, s28, 40960
  s_add_u32 s30, s25, 197376
  buffer_load_dwordx4 v48, s[12:15], s30 offen lds
  s_cmp_lg_u32 s20, 7
  s_cbranch_scc1 L_o7_front_kernel
  v_lshrrev_b32 v11, 1, v1
  v_and_b32 v13, 1, v1
  v_lshlrev_b32 v13, 7, v13
  v_lshl_add_u32 v11, v11, 13, v13
  s_mul_i32 s30, s23, 589824
  s_add_u32 s30, s30, s26
  buffer_load_dword v62, v11, s[40:43], s30 offen
  s_add_u32 s30, s30, 262144
  buffer_load_dword v62, v11, s[40:43], s30 offen
  s_add_u32 s30, s30, 262144
  s_mov_b64 exec, 0xffff
  buffer_load_dword v62, v11, s[40:43], s30 offen
  s_add_u32 s30, s30, 262144
  s_mov_b64 exec, -1
L_o7_front_kernel:
  s_waitcnt lgkmcnt(8)
  v_mfma_f32_16x16x32_bf16 v[232:235], v[24:27], v[128:131], v[232:235]
  v_add_u32 v52, 49152, v52
  v_add_u32 v53, 49152, v53
  v_mfma_f32_16x16x32_bf16 v[232:235], v[28:31], v[136:139], v[232:235]
  v_add_u32 v7, 49152, v7
  v_add_u32 v8, 49152, v8
  v_mfma_f32_16x16x32_bf16 v[236:239], v[24:27], v[132:135], v[236:239]
  v_add_u32 v9, 49152, v9
  v_add_u32 v10, 49152, v10
  v_mfma_f32_16x16x32_bf16 v[236:239], v[28:31], v[140:143], v[236:239]
  s_waitcnt lgkmcnt(0)
  s_waitcnt vmcnt(6)
  s_barrier
  v_mfma_f32_16x16x32_bf16 v[240:243], v[32:35], v[128:131], v[240:243]
  ds_read_b128 v[144:147], v52 offset:0
  ds_read_b128 v[152:155], v53 offset:0
  ds_read_b128 v[148:151], v52 offset:2048
  v_mfma_f32_16x16x32_bf16 v[240:243], v[36:39], v[136:139], v[240:243]
  ds_read_b128 v[156:159], v53 offset:2048
  ds_read_b64_tr_b16 v[16:17], v7 offset:0
  ds_read_b64_tr_b16 v[18:19], v9 offset:512
  v_mfma_f32_16x16x32_bf16 v[244:247], v[32:35], v[132:135], v[244:247]
  ds_read_b64_tr_b16 v[20:21], v7 offset:8192
  ds_read_b64_tr_b16 v[22:23], v9 offset:8704
  ds_read_b64_tr_b16 v[24:25], v8 offset:0
  v_mfma_f32_16x16x32_bf16 v[244:247], v[36:39], v[140:143], v[244:247]
  ds_read_b64_tr_b16 v[26:27], v10 offset:512
  ds_read_b64_tr_b16 v[28:29], v8 offset:8192
  ds_read_b64_tr_b16 v[30:31], v10 offset:8704
  s_waitcnt lgkmcnt(8)
  v_mfma_f32_16x16x32_bf16 v[248:251], v[40:43], v[128:131], v[248:251]
  ds_read_b64_tr_b16 v[32:33], v9 offset:0
  v_mfma_f32_16x16x32_bf16 v[248:251], v[44:47], v[136:139], v[248:251]
  ds_read_b64_tr_b16 v[34:35], v7 offset:512
  v_mfma_f32_16x16x32_bf16 v[252:255], v[40:43], v[132:135], v[252:255]
  ds_read_b64_tr_b16 v[36:37], v9 offset:8192
  v_mfma_f32_16x16x32_bf16 v[252:255], v[44:47], v[140:143], v[252:255]
  ds_read_b64_tr_b16 v[38:39], v7 offset:8704
  s_waitcnt lgkmcnt(8)
  v_mfma_f32_16x16x32_bf16 v[192:195], v[16:19], v[144:147], v[192:195]
  ds_read_b64_tr_b16 v[40:41], v10 offset:0
  v_mfma_f32_16x16x32_bf16 v[192:195], v[20:23], v[152:155], v[192:195]
  ds_read_b64_tr_b16 v[42:43], v8 offset:512
  v_mfma_f32_16x16x32_bf16 v[196:199], v[16:19], v[148:151], v[196:199]
  ds_read_b64_tr_b16 v[44:45], v10 offset:8192
  v_mfma_f32_16x16x32_bf16 v[196:199], v[20:23], v[156:159], v[196:199]
  ds_read_b64_tr_b16 v[46:47], v8 offset:8704
  s_add_u32 m0, s28, 98304
  s_add_u32 s30, s26, 3670016
  buffer_load_dwordx4 v49, s[8:11], s30 offen lds
  s_waitcnt lgkmcnt(8)
  v_mfma_f32_16x16x32_bf16 v[200:203], v[24:27], v[144:147], v[200:203]
  ds_read_b64_tr_b16 v[16:17], v7 offset:1024
  v_mfma_f32_16x16x32_bf16 v[200:203], v[28:31], v[152:155], v[200:203]
  ds_read_b64_tr_b16 v[18:19], v9 offset:1536
  v_mfma_f32_16x16x32_bf16 v[204:207], v[24:27], v[148:151], v[204:207]
  ds_read_b64_tr_b16 v[20:21], v7 offset:9216
  v_mfma_f32_16x16x32_bf16 v[204:207], v[28:31], v[156:159], v[204:207]
  ds_read_b64_tr_b16 v[22:23], v9 offset:9728
  s_add_u32 m0, s28, 106496
  s_add_u32 s30, s26, 3932160
  buffer_load_dwordx4 v49, s[8:11], s30 offen lds
  s_waitcnt lgkmcnt(8)
  v_mfma_f32_16x16x32_bf16 v[208:211], v[32:35], v[144:147], v[208:211]
  ds_read_b64_tr_b16 v[24:25], v8 offset:1024
  v_mfma_f32_16x16x32_bf16 v[208:211], v[36:39], v[152:155], v[208:211]
  ds_read_b64_tr_b16 v[26:27], v10 offset:1536
  v_mfma_f32_16x16x32_bf16 v[212:215], v[32:35], v[148:151], v[212:215]
  ds_read_b64_tr_b16 v[28:29], v8 offset:9216
  v_mfma_f32_16x16x32_bf16 v[212:215], v[36:39], v[156:159], v[212:215]
  ds_read_b64_tr_b16 v[30:31], v10 offset:9728
  s_add_u32 m0, s28, 65536
  s_add_u32 s30, s25, 896
  buffer_load_dwordx4 v48, s[12:15], s30 offen lds
  s_waitcnt lgkmcnt(8)
  v_mfma_f32_16x16x32_bf16 v[216:219], v[40:43], v[144:147], v[216:219]
  ds_read_b64_tr_b16 v[32:33], v9 offset:1024
  v_mfma_f32_16x16x32_bf16 v[216:219], v[44:47], v[152:155], v[216:219]
  ds_read_b64_tr_b16 v[34:35], v7 offset:1536
  v_mfma_f32_16x16x32_bf16 v[220:223], v[40:43], v[148:151], v[220:223]
  ds_read_b64_tr_b16 v[36:37], v9 offset:9216
  v_mfma_f32_16x16x32_bf16 v[220:223], v[44:47], v[156:159], v[220:223]
  ds_read_b64_tr_b16 v[38:39], v7 offset:9728
  s_add_u32 m0, s28, 73728
  s_add_u32 s30, s25, 66432
  buffer_load_dwordx4 v48, s[12:15], s30 offen lds
  s_cmp_lg_u32 s22, 1
  s_cbranch_scc1 L_o8_front_kernel
  ds_read_b128 v[164:167], v4 offset:4096
  ds_read_b128 v[168:171], v4 offset:4112
  ds_read_b128 v[172:175], v4 offset:5120
  ds_read_b128 v[176:179], v4 offset:5136
  ds_read_b64 v[180:181], v5 offset:4096
  s_waitcnt lgkmcnt(0)
  s_mov_b32 s31, 0x3e0293ee
  v_lshlrev_b32 v12, 16, v182
  v_lshlrev_b32 v13, 16, v164
  v_and_b32 v164, 0xffff0000, v164
  v_fmac_f32 v164, v12, v13
  v_mul_f32 v164, s31, v164
  v_and_b32 v12, 0xffff0000, v182
  v_lshlrev_b32 v13, 16, v165
  v_and_b32 v165, 0xffff0000, v165
  v_fmac_f32 v165, v12, v13
  v_mul_f32 v165, s31, v165
  v_lshlrev_b32 v12, 16, v183
  v_lshlrev_b32 v13, 16, v166
  v_and_b32 v166, 0xffff0000, v166
  v_fmac_f32 v166, v12, v13
  v_mul_f32 v166, s31, v166
  v_and_b32 v12, 0xffff0000, v183
  v_lshlrev_b32 v13, 16, v167
  v_and_b32 v167, 0xffff0000, v167
  v_fmac_f32 v167, v12, v13
  v_mul_f32 v167, s31, v167
  v_lshlrev_b32 v12, 16, v184
  v_lshlrev_b32 v13, 16, v168
  v_and_b32 v168, 0xffff0000, v168
  v_fmac_f32 v168, v12, v13
  v_mul_f32 v168, s31, v168
  v_and_b32 v12, 0xffff0000, v184
  v_lshlrev_b32 v13, 16, v169
  v_and_b32 v169, 0xffff0000, v169
  v_fmac_f32 v169, v12, v13
  v_mul_f32 v169, s31, v169
  v_lshlrev_b32 v12, 16, v185
  v_lshlrev_b32 v13, 16, v170
  v_and_b32 v170, 0xffff0000, v170
  v_fmac_f32 v170, v12, v13
  v_mul_f32 v170, s31, v170
  v_and_b32 v12, 0xffff0000, v185
  v_lshlrev_b32 v13, 16, v171
  v_and_b32 v171, 0xffff0000, v171
  v_fmac_f32 v171, v12, v13
  v_mul_f32 v171, s31, v171
  v_lshlrev_b32 v12, 16, v186
  v_lshlrev_b32 v13, 16, v172
  v_and_b32 v172, 0xffff0000, v172
  v_fmac_f32 v172, v12, v13
  v_mul_f32 v172, s31, v172
  v_and_b32 v12, 0xffff0000, v186
  v_lshlrev_b32 v13, 16, v173
  v_and_b32 v173, 0xffff0000, v173
  v_fmac_f32 v173, v12, v13
  v_mul_f32 v173, s31, v173
  v_lshlrev_b32 v12, 16, v187
  v_lshlrev_b32 v13, 16, v174
  v_and_b32 v174, 0xffff0000, v174
  v_fmac_f32 v174, v12, v13
  v_mul_f32 v174, s31, v174
  v_and_b32 v12, 0xffff0000, v187
  v_lshlrev_b32 v13, 16, v175
  v_and_b32 v175, 0xffff0000, v175
  v_fmac_f32 v175, v12, v13
  v_mul_f32 v175, s31, v175
  v_lshlrev_b32 v12, 16, v188
  v_lshlrev_b32 v13, 16, v176
  v_and_b32 v176, 0xffff0000, v176
  v_fmac_f32 v176, v12, v13
  v_mul_f32 v176, s31, v176
  v_and_b32 v12, 0xffff0000, v188
  v_lshlrev_b32 v13, 16, v177
  v_and_b32 v177, 0xffff0000, v177
  v_fmac_f32 v177, v12, v13
  v_mul_f32 v177, s31, v177
  v_lshlrev_b32 v12, 16, v189
  v_lshlrev_b32 v13, 16, v178
  v_and_b32 v178, 0xffff0000, v178
  v_fmac_f32 v178, v12, v13
  v_mul_f32 v178, s31, v178
  v_and_b32 v12, 0xffff0000, v189
  v_lshlrev_b32 v13, 16, v179
  v_and_b32 v179, 0xffff0000, v179
  v_fmac_f32 v179, v12, v13
  v_mul_f32 v179, s31, v179
  v_lshlrev_b32 v12, 16, v190
  v_lshlrev_b32 v13, 16, v180
  v_and_b32 v180, 0xffff0000, v180
  v_fmac_f32 v180, v12, v13
  v_mul_f32 v180, s31, v180
  v_and_b32 v12, 0xffff0000, v190
  v_lshlrev_b32 v13, 16, v181
  v_and_b32 v181, 0xffff0000, v181
  v_fmac_f32 v181, v12, v13
  v_mul_f32 v181, s31, v181
  s_add_u32 s30, s29, 65536
  v_cvt_pk_bf16_f32 v182, v164, v165
  v_cvt_pk_bf16_f32 v183, v166, v167
  v_cvt_pk_bf16_f32 v184, v168, v169
  v_cvt_pk_bf16_f32 v185, v170, v171
  v_cvt_pk_bf16_f32 v186, v172, v173
  v_cvt_pk_bf16_f32 v187, v174, v175
  v_cvt_pk_bf16_f32 v188, v176, v177
  v_cvt_pk_bf16_f32 v189, v178, v179
  v_cvt_pk_bf16_f32 v190, v180, v181
  buffer_store_dwordx4 v[182:185], v2, s[4:7], s30 offen sc1
  buffer_store_dwordx4 v[186:189], v2, s[4:7], s30 offen offset:512 sc1
  buffer_store_dword v190, v3, s[4:7], s30 offen sc1
L_o8_front_kernel:
  s_waitcnt lgkmcnt(8)
  v_mfma_f32_16x16x32_bf16 v[224:227], v[16:19], v[144:147], v[224:227]
  ds_read_b64_tr_b16 v[40:41], v10 offset:1024
  v_mfma_f32_16x16x32_bf16 v[224:227], v[20:23], v[152:155], v[224:227]
  ds_read_b64_tr_b16 v[42:43], v8 offset:1536
  v_mfma_f32_16x16x32_bf16 v[228:231], v[16:19], v[148:151], v[228:231]
  ds_read_b64_tr_b16 v[44:45], v10 offset:9216
  v_mfma_f32_16x16x32_bf16 v[228:231], v[20:23], v[156:159], v[228:231]
  ds_read_b64_tr_b16 v[46:47], v8 offset:9728
  s_add_u32 m0, s28, 81920
  s_add_u32 s30, s25, 131968
  buffer_load_dwordx4 v48, s[12:15], s30 offen lds
  s_add_u32 m0, s28, 90112
  s_add_u32 s30, s25, 197504
  buffer_load_dwordx4 v48, s[12:15], s30 offen lds
  s_waitcnt lgkmcnt(8)
  v_mfma_f32_16x16x32_bf16 v[232:235], v[24:27], v[144:147], v[232:235]
  v_add_u32 v52, 4294868992, v52
  v_add_u32 v53, 4294868992, v53
  v_mfma_f32_16x16x32_bf16 v[232:235], v[28:31], v[152:155], v[232:235]
  v_add_u32 v7, 4294868992, v7
  v_add_u32 v8, 4294868992, v8
  v_mfma_f32_16x16x32_bf16 v[236:239], v[24:27], v[148:151], v[236:239]
  v_add_u32 v9, 4294868992, v9
  v_add_u32 v10, 4294868992, v10
  v_mfma_f32_16x16x32_bf16 v[236:239], v[28:31], v[156:159], v[236:239]
  s_waitcnt lgkmcnt(0)
  s_waitcnt vmcnt(6)
  s_barrier
  v_mfma_f32_16x16x32_bf16 v[240:243], v[32:35], v[144:147], v[240:243]
  ds_read_b128 v[160:163], v52 offset:0
  ds_read_b128 v[168:171], v53 offset:0
  ds_read_b128 v[164:167], v52 offset:2048
  v_mfma_f32_16x16x32_bf16 v[240:243], v[36:39], v[152:155], v[240:243]
  ds_read_b128 v[172:175], v53 offset:2048
  ds_read_b64_tr_b16 v[16:17], v7 offset:0
  ds_read_b64_tr_b16 v[18:19], v9 offset:512
  v_mfma_f32_16x16x32_bf16 v[244:247], v[32:35], v[148:151], v[244:247]
  ds_read_b64_tr_b16 v[20:21], v7 offset:8192
  ds_read_b64_tr_b16 v[22:23], v9 offset:8704
  ds_read_b64_tr_b16 v[24:25], v8 offset:0
  v_mfma_f32_16x16x32_bf16 v[244:247], v[36:39], v[156:159], v[244:247]
  ds_read_b64_tr_b16 v[26:27], v10 offset:512
  ds_read_b64_tr_b16 v[28:29], v8 offset:8192
  ds_read_b64_tr_b16 v[30:31], v10 offset:8704
  s_waitcnt lgkmcnt(8)
  v_mfma_f32_16x16x32_bf16 v[248:251], v[40:43], v[144:147], v[248:251]
  ds_read_b64_tr_b16 v[32:33], v9 offset:0
  v_mfma_f32_16x16x32_bf16 v[248:251], v[44:47], v[152:155], v[248:251]
  ds_read_b64_tr_b16 v[34:35], v7 offset:512
  v_mfma_f32_16x16x32_bf16 v[252:255], v[40:43], v[148:151], v[252:255]
  ds_read_b64_tr_b16 v[36:37], v9 offset:8192
  v_mfma_f32_16x16x32_bf16 v[252:255], v[44:47], v[156:159], v[252:255]
  ds_read_b64_tr_b16 v[38:39], v7 offset:8704
  s_waitcnt lgkmcnt(8)
  v_mfma_f32_16x16x32_bf16 v[192:195], v[16:19], v[160:163], v[192:195]
  ds_read_b64_tr_b16 v[40:41], v10 offset:0
  v_mfma_f32_16x16x32_bf16 v[192:195], v[20:23], v[168:171], v[192:195]
  ds_read_b64_tr_b16 v[42:43], v8 offset:512
  v_mfma_f32_16x16x32_bf16 v[196:199], v[16:19], v[164:167], v[196:199]
  ds_read_b64_tr_b16 v[44:45], v10 offset:8192
  v_mfma_f32_16x16x32_bf16 v[196:199], v[20:23], v[172:175], v[196:199]
  ds_read_b64_tr_b16 v[46:47], v8 offset:8704
  s_add_u32 m0, s28, 114688
  s_add_u32 s30, s26, 0
  buffer_load_dwordx4 v50, s[16:19], s30 offen lds
  s_waitcnt lgkmcnt(8)
  v_mfma_f32_16x16x32_bf16 v[200:203], v[24:27], v[160:163], v[200:203]
  ds_read_b64_tr_b16 v[16:17], v7 offset:1024
  v_mfma_f32_16x16x32_bf16 v[200:203], v[28:31], v[168:171], v[200:203]
  ds_read_b64_tr_b16 v[18:19], v9 offset:1536
  v_mfma_f32_16x16x32_bf16 v[204:207], v[24:27], v[164:167], v[204:207]
  ds_read_b64_tr_b16 v[20:21], v7 offset:9216
  v_mfma_f32_16x16x32_bf16 v[204:207], v[28:31], v[172:175], v[204:207]
  ds_read_b64_tr_b16 v[22:23], v9 offset:9728
  s_add_u32 m0, s28, 122880
  s_add_u32 s30, s26, 1048576
  buffer_load_dwordx4 v50, s[16:19], s30 offen lds
  s_waitcnt lgkmcnt(8)
  v_mfma_f32_16x16x32_bf16 v[208:211], v[32:35], v[160:163], v[208:211]
  ds_read_b64_tr_b16 v[24:25], v8 offset:1024
  v_mfma_f32_16x16x32_bf16 v[208:211], v[36:39], v[168:171], v[208:211]
  ds_read_b64_tr_b16 v[26:27], v10 offset:1536
  v_mfma_f32_16x16x32_bf16 v[212:215], v[32:35], v[164:167], v[212:215]
  ds_read_b64_tr_b16 v[28:29], v8 offset:9216
  v_mfma_f32_16x16x32_bf16 v[212:215], v[36:39], v[172:175], v[212:215]
  ds_read_b64_tr_b16 v[30:31], v10 offset:9728
  s_add_u32 m0, s28, 131072
  s_add_u32 s30, s26, 2097152
  buffer_load_dwordx4 v50, s[16:19], s30 offen lds
  s_waitcnt lgkmcnt(8)
  v_mfma_f32_16x16x32_bf16 v[216:219], v[40:43], v[160:163], v[216:219]
  ds_read_b64_tr_b16 v[32:33], v9 offset:1024
  v_mfma_f32_16x16x32_bf16 v[216:219], v[44:47], v[168:171], v[216:219]
  ds_read_b64_tr_b16 v[34:35], v7 offset:1536
  v_mfma_f32_16x16x32_bf16 v[220:223], v[40:43], v[164:167], v[220:223]
  ds_read_b64_tr_b16 v[36:37], v9 offset:9216
  v_mfma_f32_16x16x32_bf16 v[220:223], v[44:47], v[172:175], v[220:223]
  ds_read_b64_tr_b16 v[38:39], v7 offset:9728
  s_add_u32 m0, s28, 139264
  s_add_u32 s30, s26, 3145728
  buffer_load_dwordx4 v50, s[16:19], s30 offen lds
  s_waitcnt lgkmcnt(8)
  v_mfma_f32_16x16x32_bf16 v[224:227], v[16:19], v[160:163], v[224:227]
  ds_read_b64_tr_b16 v[40:41], v10 offset:1024
  v_mfma_f32_16x16x32_bf16 v[224:227], v[20:23], v[168:171], v[224:227]
  ds_read_b64_tr_b16 v[42:43], v8 offset:1536
  v_mfma_f32_16x16x32_bf16 v[228:231], v[16:19], v[164:167], v[228:231]
  ds_read_b64_tr_b16 v[44:45], v10 offset:9216
  v_mfma_f32_16x16x32_bf16 v[228:231], v[20:23], v[172:175], v[228:231]
  ds_read_b64_tr_b16 v[46:47], v8 offset:9728
  s_waitcnt lgkmcnt(8)
  v_mfma_f32_16x16x32_bf16 v[232:235], v[24:27], v[160:163], v[232:235]
  v_add_u32 v52, 49152, v52
  v_add_u32 v53, 49152, v53
  v_mfma_f32_16x16x32_bf16 v[232:235], v[28:31], v[168:171], v[232:235]
  v_add_u32 v7, 49152, v7
  v_add_u32 v8, 49152, v8
  v_mfma_f32_16x16x32_bf16 v[236:239], v[24:27], v[164:167], v[236:239]
  v_add_u32 v9, 49152, v9
  v_add_u32 v10, 49152, v10
  v_mfma_f32_16x16x32_bf16 v[236:239], v[28:31], v[172:175], v[236:239]
  s_waitcnt lgkmcnt(0)
  s_waitcnt vmcnt(0)
  s_barrier
  s_cmp_lg_u32 s20, 1
  s_cbranch_scc1 L_o9_front_kernel
  v_mov_b32 v61, 1
  s_mov_b64 exec, 1
  buffer_atomic_add v61, v58, s[4:7], s97 offen sc1
  s_mov_b64 exec, -1
L_o9_front_kernel:
  v_mfma_f32_16x16x32_bf16 v[240:243], v[32:35], v[160:163], v[240:243]
  ds_read_b128 v[176:179], v52 offset:0
  ds_read_b128 v[184:187], v53 offset:0
  ds_read_b128 v[180:183], v52 offset:2048
  v_mfma_f32_16x16x32_bf16 v[240:243], v[36:39], v[168:171], v[240:243]
  ds_read_b128 v[188:191], v53 offset:2048
  ds_read_b64_tr_b16 v[16:17], v7 offset:0
  ds_read_b64_tr_b16 v[18:19], v9 offset:512
  v_mfma_f32_16x16x32_bf16 v[244:247], v[32:35], v[164:167], v[244:247]
  ds_read_b64_tr_b16 v[20:21], v7 offset:8192
  ds_read_b64_tr_b16 v[22:23], v9 offset:8704
  ds_read_b64_tr_b16 v[24:25], v8 offset:0
  v_mfma_f32_16x16x32_bf16 v[244:247], v[36:39], v[172:175], v[244:247]
  ds_read_b64_tr_b16 v[26:27], v10 offset:512
  ds_read_b64_tr_b16 v[28:29], v8 offset:8192
  ds_read_b64_tr_b16 v[30:31], v10 offset:8704
  s_waitcnt lgkmcnt(8)
  v_mfma_f32_16x16x32_bf16 v[248:251], v[40:43], v[160:163], v[248:251]
  ds_read_b64_tr_b16 v[32:33], v9 offset:0
  v_mfma_f32_16x16x32_bf16 v[248:251], v[44:47], v[168:171], v[248:251]
  ds_read_b64_tr_b16 v[34:35], v7 offset:512
  v_mfma_f32_16x16x32_bf16 v[252:255], v[40:43], v[164:167], v[252:255]
  ds_read_b64_tr_b16 v[36:37], v9 offset:8192
  v_mfma_f32_16x16x32_bf16 v[252:255], v[44:47], v[172:175], v[252:255]
  ds_read_b64_tr_b16 v[38:39], v7 offset:8704
  s_waitcnt lgkmcnt(8)
  v_mfma_f32_16x16x32_bf16 v[192:195], v[16:19], v[176:179], v[192:195]
  ds_read_b64_tr_b16 v[40:41], v10 offset:0
  v_mfma_f32_16x16x32_bf16 v[192:195], v[20:23], v[184:187], v[192:195]
  ds_read_b64_tr_b16 v[42:43], v8 offset:512
  v_mfma_f32_16x16x32_bf16 v[196:199], v[16:19], v[180:183], v[196:199]
  ds_read_b64_tr_b16 v[44:45], v10 offset:8192
  v_mfma_f32_16x16x32_bf16 v[196:199], v[20:23], v[188:191], v[196:199]
  ds_read_b64_tr_b16 v[46:47], v8 offset:8704
  s_add_u32 m0, s28, 16384
  s_add_u32 s30, s26, 64
  buffer_load_dwordx4 v50, s[16:19], s30 offen lds
  s_waitcnt lgkmcnt(8)
  v_mfma_f32_16x16x32_bf16 v[200:203], v[24:27], v[176:179], v[200:203]
  ds_read_b64_tr_b16 v[16:17], v7 offset:1024
  v_mfma_f32_16x16x32_bf16 v[200:203], v[28:31], v[184:187], v[200:203]
  ds_read_b64_tr_b16 v[18:19], v9 offset:1536
  v_mfma_f32_16x16x32_bf16 v[204:207], v[24:27], v[180:183], v[204:207]
  ds_read_b64_tr_b16 v[20:21], v7 offset:9216
  v_mfma_f32_16x16x32_bf16 v[204:207], v[28:31], v[188:191], v[204:207]
  ds_read_b64_tr_b16 v[22:23], v9 offset:9728
  s_add_u32 m0, s28, 24576
  s_add_u32 s30, s26, 1048640
  buffer_load_dwordx4 v50, s[16:19], s30 offen lds
  s_waitcnt lgkmcnt(8)
  v_mfma_f32_16x16x32_bf16 v[208:211], v[32:35], v[176:179], v[208:211]
  ds_read_b64_tr_b16 v[24:25], v8 offset:1024
  v_mfma_f32_16x16x32_bf16 v[208:211], v[36:39], v[184:187], v[208:211]
  ds_read_b64_tr_b16 v[26:27], v10 offset:1536
  v_mfma_f32_16x16x32_bf16 v[212:215], v[32:35], v[180:183], v[212:215]
  ds_read_b64_tr_b16 v[28:29], v8 offset:9216
  v_mfma_f32_16x16x32_bf16 v[212:215], v[36:39], v[188:191], v[212:215]
  ds_read_b64_tr_b16 v[30:31], v10 offset:9728
  s_add_u32 m0, s28, 32768
  s_add_u32 s30, s26, 2097216
  buffer_load_dwordx4 v50, s[16:19], s30 offen lds
  s_waitcnt lgkmcnt(8)
  v_mfma_f32_16x16x32_bf16 v[216:219], v[40:43], v[176:179], v[216:219]
  ds_read_b64_tr_b16 v[32:33], v9 offset:1024
  v_mfma_f32_16x16x32_bf16 v[216:219], v[44:47], v[184:187], v[216:219]
  ds_read_b64_tr_b16 v[34:35], v7 offset:1536
  v_mfma_f32_16x16x32_bf16 v[220:223], v[40:43], v[180:183], v[220:223]
  ds_read_b64_tr_b16 v[36:37], v9 offset:9216
  v_mfma_f32_16x16x32_bf16 v[220:223], v[44:47], v[188:191], v[220:223]
  ds_read_b64_tr_b16 v[38:39], v7 offset:9728
  s_add_u32 m0, s28, 40960
  s_add_u32 s30, s26, 3145792
  buffer_load_dwordx4 v50, s[16:19], s30 offen lds
  s_waitcnt lgkmcnt(8)
  v_mfma_f32_16x16x32_bf16 v[224:227], v[16:19], v[176:179], v[224:227]
  ds_read_b64_tr_b16 v[40:41], v10 offset:1024
  v_mfma_f32_16x16x32_bf16 v[224:227], v[20:23], v[184:187], v[224:227]
  ds_read_b64_tr_b16 v[42:43], v8 offset:1536
  v_mfma_f32_16x16x32_bf16 v[228:231], v[16:19], v[180:183], v[228:231]
  ds_read_b64_tr_b16 v[44:45], v10 offset:9216
  v_mfma_f32_16x16x32_bf16 v[228:231], v[20:23], v[188:191], v[228:231]
  ds_read_b64_tr_b16 v[46:47], v8 offset:9728
  s_cmp_lg_u32 s20, 7
  s_cbranch_scc1 L_o10_front_kernel
  s_mul_i32 s30, s2, 18432
  buffer_load_dword v62, v59, s[60:63], s30 offen
  s_add_u32 s30, s30, 8192
  buffer_load_dword v62, v59, s[60:63], s30 offen
  s_add_u32 s30, s30, 8192
  s_mov_b64 exec, 0xffff
  buffer_load_dword v62, v59, s[60:63], s30 offen
  s_add_u32 s30, s30, 8192
  s_mov_b64 exec, -1
L_o10_front_kernel:
  s_cmp_lg_u32 s20, 5
  s_cbranch_scc1 L_o11_front_kernel
  s_cmp_lg_u32 s2, 200
  s_cbranch_scc1 L_o11_front_kernel
  s_load_dwordx2 s[48:49], s[0:1], 64
  s_mov_b32 s50, 0x2400
  s_mov_b32 s51, 0x00020000
  s_load_dwordx2 s[56:57], s[0:1], 80
  s_mov_b32 s58, 0x1000
  s_mov_b32 s59, 0x00020000
  s_waitcnt lgkmcnt(0)
  buffer_load_dword v62, v59, s[48:51], 0 offen
  s_movk_i32 s30, 8192
  buffer_load_dword v62, v59, s[48:51], s30 offen
  buffer_load_dword v62, v59, s[56:59], 0 offen
L_o11_front_kernel:
  s_waitcnt lgkmcnt(8)
  v_mfma_f32_16x16x32_bf16 v[232:235], v[24:27], v[176:179], v[232:235]
  v_mfma_f32_16x16x32_bf16 v[232:235], v[28:31], v[184:187], v[232:235]
  v_mfma_f32_16x16x32_bf16 v[236:239], v[24:27], v[180:183], v[236:239]
  v_mfma_f32_16x16x32_bf16 v[236:239], v[28:31], v[188:191], v[236:239]
  s_waitcnt lgkmcnt(0)
  s_waitcnt vmcnt(4)
  s_barrier
  v_mfma_f32_16x16x32_bf16 v[240:243], v[32:35], v[176:179], v[240:243]
  ds_read_b64_tr_b16 v[16:17], v54 offset:0
  ds_read_b64_tr_b16 v[18:19], v54 offset:256
  ds_read_b64_tr_b16 v[20:21], v54 offset:2048
  v_mfma_f32_16x16x32_bf16 v[240:243], v[36:39], v[184:187], v[240:243]
  ds_read_b64_tr_b16 v[22:23], v54 offset:2304
  ds_read_b64_tr_b16 v[24:25], v55 offset:0
  ds_read_b64_tr_b16 v[26:27], v55 offset:256
  v_mfma_f32_16x16x32_bf16 v[244:247], v[32:35], v[180:183], v[244:247]
  ds_read_b64_tr_b16 v[28:29], v55 offset:2048
  ds_read_b64_tr_b16 v[30:31], v55 offset:2304
  v_mfma_f32_16x16x32_bf16 v[244:247], v[36:39], v[188:191], v[244:247]
  v_mfma_f32_16x16x32_bf16 v[248:251], v[40:43], v[176:179], v[248:251]
  ds_read_b64_tr_b16 v[32:33], v54 offset:4096
  v_mfma_f32_16x16x32_bf16 v[248:251], v[44:47], v[184:187], v[248:251]
  ds_read_b64_tr_b16 v[34:35], v54 offset:4352
  v_mfma_f32_16x16x32_bf16 v[252:255], v[40:43], v[180:183], v[252:255]
  ds_read_b64_tr_b16 v[36:37], v54 offset:6144
  v_mfma_f32_16x16x32_bf16 v[252:255], v[44:47], v[188:191], v[252:255]
  ds_read_b64_tr_b16 v[38:39], v54 offset:6400
  v_cvt_pk_bf16_f32 v12, v228, v229
  v_cvt_pk_bf16_f32 v13, v230, v231
  v_cvt_pk_bf16_f32 v224, v224, v225
  v_cvt_pk_bf16_f32 v225, v226, v227
  v_cvt_pk_bf16_f32 v226, v232, v233
  v_cvt_pk_bf16_f32 v227, v234, v235
  v_mov_b32 v228, v12
  v_mov_b32 v229, v13
  v_cvt_pk_bf16_f32 v230, v236, v237
  v_cvt_pk_bf16_f32 v231, v238, v239
  v_cvt_pk_bf16_f32 v12, v244, v245
  v_cvt_pk_bf16_f32 v13, v246, v247
  v_cvt_pk_bf16_f32 v232, v240, v241
  v_cvt_pk_bf16_f32 v233, v242, v243
  v_cvt_pk_bf16_f32 v234, v248, v249
  v_cvt_pk_bf16_f32 v235, v250, v251
  v_mov_b32 v236, v12
  v_mov_b32 v237, v13
  v_cvt_pk_bf16_f32 v238, v252, v253
  v_cvt_pk_bf16_f32 v239, v254, v255
  s_lshl_b32 s30, s22, 14
  s_sub_u32 s38, 0, s30
  s_lshl_b32 s39, s22, 10
  s_add_u32 s31, s38, 4294918144
  v_add_u32 v52, s31, v52
  v_add_u32 v53, s31, v53
  s_add_u32 s31, s39, 4294918144
  v_add_u32 v7, s31, v7
  v_add_u32 v8, s31, v8
  v_add_u32 v9, s31, v9
  v_add_u32 v10, s31, v10
  s_waitcnt lgkmcnt(8)
  v_mfma_f32_16x16x32_bf16 v[240:243], v[64:67], v[16:19], 0
  ds_read_b64_tr_b16 v[40:41], v55 offset:4096
  v_mfma_f32_16x16x32_bf16 v[240:243], v[72:75], v[20:23], v[240:243]
  ds_read_b64_tr_b16 v[42:43], v55 offset:4352
  v_mfma_f32_16x16x32_bf16 v[244:247], v[68:71], v[16:19], 0
  ds_read_b64_tr_b16 v[44:45], v55 offset:6144
  v_mfma_f32_16x16x32_bf16 v[244:247], v[76:79], v[20:23], v[244:247]
  ds_read_b64_tr_b16 v[46:47], v55 offset:6400
  s_add_u32 m0, s28, 65536
  s_add_u32 s30, s26, 128
  buffer_load_dwordx4 v50, s[16:19], s30 offen lds
  s_waitcnt lgkmcnt(8)
  v_mfma_f32_16x16x32_bf16 v[248:251], v[64:67], v[24:27], 0
  ds_read_b64_tr_b16 v[16:17], v54 offset:8192
  v_mfma_f32_16x16x32_bf16 v[248:251], v[72:75], v[28:31], v[248:251]
  ds_read_b64_tr_b16 v[18:19], v54 offset:8448
  v_mfma_f32_16x16x32_bf16 v[252:255], v[68:71], v[24:27], 0
  ds_read_b64_tr_b16 v[20:21], v54 offset:10240
  v_mfma_f32_16x16x32_bf16 v[252:255], v[76:79], v[28:31], v[252:255]
  ds_read_b64_tr_b16 v[22:23], v54 offset:10496
  s_add_u32 m0, s28, 73728
  s_add_u32 s30, s26, 1048704
  buffer_load_dwordx4 v50, s[16:19], s30 offen lds
  v_cvt_pk_bf16_f32 v12, v196, v197
  v_cvt_pk_bf16_f32 v13, v198, v199
  v_cvt_pk_bf16_f32 v192, v192, v193
  v_cvt_pk_bf16_f32 v193, v194, v195
  v_cvt_pk_bf16_f32 v194, v200, v201
  v_cvt_pk_bf16_f32 v195, v202, v203
  v_mov_b32 v196, v12
  v_mov_b32 v197, v13
  v_cvt_pk_bf16_f32 v198, v204, v205
  v_cvt_pk_bf16_f32 v199, v206, v207
  s_waitcnt lgkmcnt(8)
  v_mfma_f32_16x16x32_bf16 v[240:243], v[80:83], v[32:35], v[240:243]
  ds_read_b64_tr_b16 v[24:25], v55 offset:8192
  v_mfma_f32_16x16x32_bf16 v[240:243], v[88:91], v[36:39], v[240:243]
  ds_read_b64_tr_b16 v[26:27], v55 offset:8448
  v_mfma_f32_16x16x32_bf16 v[244:247], v[84:87], v[32:35], v[244:247]
  ds_read_b64_tr_b16 v[28:29], v55 offset:10240
  v_mfma_f32_16x16x32_bf16 v[244:247], v[92:95], v[36:39], v[244:247]
  ds_read_b64_tr_b16 v[30:31], v55 offset:10496
  s_add_u32 m0, s28, 81920
  s_add_u32 s30, s26, 2097280
  buffer_load_dwordx4 v50, s[16:19], s30 offen lds
  v_cvt_pk_bf16_f32 v12, v212, v213
  v_cvt_pk_bf16_f32 v13, v214, v215
  v_cvt_pk_bf16_f32 v200, v208, v209
  v_cvt_pk_bf16_f32 v201, v210, v211
  v_cvt_pk_bf16_f32 v202, v216, v217
  v_cvt_pk_bf16_f32 v203, v218, v219
  v_mov_b32 v204, v12
  v_mov_b32 v205, v13
  v_cvt_pk_bf16_f32 v206, v220, v221
  v_cvt_pk_bf16_f32 v207, v222, v223
  s_waitcnt lgkmcnt(8)
  v_mfma_f32_16x16x32_bf16 v[248:251], v[80:83], v[40:43], v[248:251]
  ds_read_b64_tr_b16 v[32:33], v54 offset:12288
  v_mfma_f32_16x16x32_bf16 v[248:251], v[88:91], v[44:47], v[248:251]
  ds_read_b64_tr_b16 v[34:35], v54 offset:12544
  v_mfma_f32_16x16x32_bf16 v[252:255], v[84:87], v[40:43], v[252:255]
  ds_read_b64_tr_b16 v[36:37], v54 offset:14336
  v_mfma_f32_16x16x32_bf16 v[252:255], v[92:95], v[44:47], v[252:255]
  ds_read_b64_tr_b16 v[38:39], v54 offset:14592
  s_add_u32 m0, s28, 90112
  s_add_u32 s30, s26, 3145856
  buffer_load_dwordx4 v50, s[16:19], s30 offen lds
  s_waitcnt lgkmcnt(8)
  v_mfma_f32_16x16x32_bf16 v[240:243], v[96:99], v[16:19], v[240:243]
  ds_read_b64_tr_b16 v[40:41], v55 offset:12288
  v_mfma_f32_16x16x32_bf16 v[240:243], v[104:107], v[20:23], v[240:243]
  ds_read_b64_tr_b16 v[42:43], v55 offset:12544
  v_mfma_f32_16x16x32_bf16 v[244:247], v[100:103], v[16:19], v[244:247]
  ds_read_b64_tr_b16 v[44:45], v55 offset:14336
  v_mfma_f32_16x16x32_bf16 v[244:247], v[108:111], v[20:23], v[244:247]
  ds_read_b64_tr_b16 v[46:47], v55 offset:14592
  s_add_u32 s30, s46, 33554432
  buffer_store_dwordx4 v[192:195], v6, s[4:7], s30 offen sc1
  s_waitcnt lgkmcnt(8)
  v_mfma_f32_16x16x32_bf16 v[248:251], v[96:99], v[24:27], v[248:251]
  ds_read_b64_tr_b16 v[16:17], v54 offset:16384
  v_mfma_f32_16x16x32_bf16 v[248:251], v[104:107], v[28:31], v[248:251]
  ds_read_b64_tr_b16 v[18:19], v54 offset:16640
  v_mfma_f32_16x16x32_bf16 v[252:255], v[100:103], v[24:27], v[252:255]
  ds_read_b64_tr_b16 v[20:21], v54 offset:18432
  v_mfma_f32_16x16x32_bf16 v[252:255], v[108:111], v[28:31], v[252:255]
  ds_read_b64_tr_b16 v[22:23], v54 offset:18688
  s_cmp_lg_u32 s20, 7
  s_cbranch_scc1 L_o12_front_kernel
  s_mul_i32 s30, s2, 81
  s_movk_i32 s31, 1821
  v_add_u32 v12, s30, v1
  v_lshrrev_b32 v13, 2, v12
  v_mul_u32_u24 v13, 7282, v13
  v_lshrrev_b32 v13, 16, v13
  v_mul_u32_u24 v13, 18, v13
  v_add_u32 v12, v12, v13
  v_lshlrev_b32 v12, 7, v12
  buffer_load_dword v62, v12, s[44:47], 0 offen offset:2304
  v_add_u32 v12, s30, v1
  v_add_u32 v12, 64, v12
  v_lshrrev_b32 v13, 2, v12
  v_mul_u32_u24 v13, 7282, v13
  v_lshrrev_b32 v13, 16, v13
  v_mul_u32_u24 v13, 18, v13
  v_add_u32 v12, v12, v13
  v_lshlrev_b32 v12, 7, v12
  s_mov_b64 exec, 0x1ffff
  buffer_load_dword v62, v12, s[44:47], 0 offen offset:2304
  s_mov_b64 exec, -1
L_o12_front_kernel:
  s_waitcnt lgkmcnt(8)
  v_mfma_f32_16x16x32_bf16 v[240:243], v[112:115], v[32:35], v[240:243]
  ds_read_b64_tr_b16 v[24:25], v55 offset:16384
  v_mfma_f32_16x16x32_bf16 v[240:243], v[120:123], v[36:39], v[240:243]
  ds_read_b64_tr_b16 v[26:27], v55 offset:16640
  v_mfma_f32_16x16x32_bf16 v[244:247], v[116:119], v[32:35], v[244:247]
  ds_read_b64_tr_b16 v[28:29], v55 offset:18432
  v_mfma_f32_16x16x32_bf16 v[244:247], v[124:127], v[36:39], v[244:247]
  ds_read_b64_tr_b16 v[30:31], v55 offset:18688
  s_waitcnt lgkmcnt(8)
  v_mfma_f32_16x16x32_bf16 v[248:251], v[112:115], v[40:43], v[248:251]
  ds_read_b64_tr_b16 v[32:33], v54 offset:20480
  v_mfma_f32_16x16x32_bf16 v[248:251], v[120:123], v[44:47], v[248:251]
  ds_read_b64_tr_b16 v[34:35], v54 offset:20736
  v_mfma_f32_16x16x32_bf16 v[252:255], v[116:119], v[40:43], v[252:255]
  ds_read_b64_tr_b16 v[36:37], v54 offset:22528
  v_mfma_f32_16x16x32_bf16 v[252:255], v[124:127], v[44:47], v[252:255]
  ds_read_b64_tr_b16 v[38:39], v54 offset:22784
  s_waitcnt lgkmcnt(8)
  v_mfma_f32_16x16x32_bf16 v[240:243], v[128:131], v[16:19], v[240:243]
  ds_read_b64_tr_b16 v[40:41], v55 offset:20480
  v_mfma_f32_16x16x32_bf16 v[240:243], v[136:139], v[20:23], v[240:243]
  ds_read_b64_tr_b16 v[42:43], v55 offset:20736
  v_mfma_f32_16x16x32_bf16 v[244:247], v[132:135], v[16:19], v[244:247]
  ds_read_b64_tr_b16 v[44:45], v55 offset:22528
  v_mfma_f32_16x16x32_bf16 v[244:247], v[140:143], v[20:23], v[244:247]
  ds_read_b64_tr_b16 v[46:47], v55 offset:22784
  s_add_u32 s30, s46, 33558528
  buffer_store_dwordx4 v[196:199], v6, s[4:7], s30 offen sc1
  s_waitcnt lgkmcnt(8)
  v_mfma_f32_16x16x32_bf16 v[248:251], v[128:131], v[24:27], v[248:251]
  ds_read_b64_tr_b16 v[16:17], v54 offset:24576
  v_mfma_f32_16x16x32_bf16 v[248:251], v[136:139], v[28:31], v[248:251]
  ds_read_b64_tr_b16 v[18:19], v54 offset:24832
  v_mfma_f32_16x16x32_bf16 v[252:255], v[132:135], v[24:27], v[252:255]
  ds_read_b64_tr_b16 v[20:21], v54 offset:26624
  v_mfma_f32_16x16x32_bf16 v[252:255], v[140:143], v[28:31], v[252:255]
  ds_read_b64_tr_b16 v[22:23], v54 offset:26880
  s_waitcnt lgkmcnt(8)
  v_mfma_f32_16x16x32_bf16 v[240:243], v[144:147], v[32:35], v[240:243]
  ds_read_b64_tr_b16 v[24:25], v55 offset:24576
  v_mfma_f32_16x16x32_bf16 v[240:243], v[152:155], v[36:39], v[240:243]
  ds_read_b64_tr_b16 v[26:27], v55 offset:24832
  v_mfma_f32_16x16x32_bf16 v[244:247], v[148:151], v[32:35], v[244:247]
  ds_read_b64_tr_b16 v[28:29], v55 offset:26624
  v_mfma_f32_16x16x32_bf16 v[244:247], v[156:159], v[36:39], v[244:247]
  ds_read_b64_tr_b16 v[30:31], v55 offset:26880
  s_waitcnt lgkmcnt(8)
  v_mfma_f32_16x16x32_bf16 v[248:251], v[144:147], v[40:43], v[248:251]
  ds_read_b64_tr_b16 v[32:33], v54 offset:28672
  v_mfma_f32_16x16x32_bf16 v[248:251], v[152:155], v[44:47], v[248:251]
  ds_read_b64_tr_b16 v[34:35], v54 offset:28928
  v_mfma_f32_16x16x32_bf16 v[252:255], v[148:151], v[40:43], v[252:255]
  ds_read_b64_tr_b16 v[36:37], v54 offset:30720
  v_mfma_f32_16x16x32_bf16 v[252:255], v[156:159], v[44:47], v[252:255]
  ds_read_b64_tr_b16 v[38:39], v54 offset:30976
  s_waitcnt lgkmcnt(8)
  v_mfma_f32_16x16x32_bf16 v[240:243], v[160:163], v[16:19], v[240:243]
  ds_read_b64_tr_b16 v[40:41], v55 offset:28672
  v_mfma_f32_16x16x32_bf16 v[240:243], v[168:171], v[20:23], v[240:243]
  ds_read_b64_tr_b16 v[42:43], v55 offset:28928
  v_mfma_f32_16x16x32_bf16 v[244:247], v[164:167], v[16:19], v[244:247]
  ds_read_b64_tr_b16 v[44:45], v55 offset:30720
  v_mfma_f32_16x16x32_bf16 v[244:247], v[172:175], v[20:23], v[244:247]
  ds_read_b64_tr_b16 v[46:47], v55 offset:30976
  s_add_u32 s30, s46, 33555456
  buffer_store_dwordx4 v[200:203], v6, s[4:7], s30 offen sc1
  s_waitcnt lgkmcnt(8)
  v_mfma_f32_16x16x32_bf16 v[248:251], v[160:163], v[24:27], v[248:251]
  v_mfma_f32_16x16x32_bf16 v[248:251], v[168:171], v[28:31], v[248:251]
  v_mfma_f32_16x16x32_bf16 v[252:255], v[164:167], v[24:27], v[252:255]
  v_mfma_f32_16x16x32_bf16 v[252:255], v[172:175], v[28:31], v[252:255]
  v_add_u32 v54, 4294868992, v54
  v_add_u32 v55, 4294868992, v55
  s_waitcnt lgkmcnt(0)
  s_waitcnt vmcnt(7)
  s_barrier
  s_cmp_lg_u32 s20, 6
  s_cbranch_scc1 L_o13_front_kernel
  s_load_dword s32, s[4:5], s99 glc
  s_load_dword s45, s[4:5], s34 glc
L_o13_front_kernel:
  v_mfma_f32_16x16x32_bf16 v[240:243], v[176:179], v[32:35], v[240:243]
  ds_read_b64_tr_b16 v[16:17], v54 offset:0
  ds_read_b64_tr_b16 v[18:19], v54 offset:256
  v_mfma_f32_16x16x32_bf16 v[240:243], v[184:187], v[36:39], v[240:243]
  ds_read_b64_tr_b16 v[20:21], v54 offset:2048
  ds_read_b64_tr_b16 v[22:23], v54 offset:2304
  v_mfma_f32_16x16x32_bf16 v[244:247], v[180:183], v[32:35], v[244:247]
  ds_read_b64_tr_b16 v[24:25], v55 offset:0
  ds_read_b64_tr_b16 v[26:27], v55 offset:256
  v_mfma_f32_16x16x32_bf16 v[244:247], v[188:191], v[36:39], v[244:247]
  ds_read_b64_tr_b16 v[28:29], v55 offset:2048
  ds_read_b64_tr_b16 v[30:31], v55 offset:2304
  v_mfma_f32_16x16x32_bf16 v[248:251], v[176:179], v[40:43], v[248:251]
  ds_read_b64_tr_b16 v[32:33], v54 offset:4096
  v_mfma_f32_16x16x32_bf16 v[248:251], v[184:187], v[44:47], v[248:251]
  ds_read_b64_tr_b16 v[34:35], v54 offset:4352
  v_mfma_f32_16x16x32_bf16 v[252:255], v[180:183], v[40:43], v[252:255]
  ds_read_b64_tr_b16 v[36:37], v54 offset:6144
  v_mfma_f32_16x16x32_bf16 v[252:255], v[188:191], v[44:47], v[252:255]
  ds_read_b64_tr_b16 v[38:39], v54 offset:6400
  s_waitcnt lgkmcnt(8)
  v_mfma_f32_16x16x32_bf16 v[208:211], v[64:67], v[16:19], 0
  ds_read_b64_tr_b16 v[40:41], v55 offset:4096
  v_mfma_f32_16x16x32_bf16 v[208:211], v[72:75], v[20:23], v[208:211]
  ds_read_b64_tr_b16 v[42:43], v55 offset:4352
  v_mfma_f32_16x16x32_bf16 v[212:215], v[68:71], v[16:19], 0
  ds_read_b64_tr_b16 v[44:45], v55 offset:6144
  v_mfma_f32_16x16x32_bf16 v[212:215], v[76:79], v[20:23], v[212:215]
  ds_read_b64_tr_b16 v[46:47], v55 offset:6400
  s_add_u32 m0, s28, 114688
  s_add_u32 s30, s26, 192
  buffer_load_dwordx4 v50, s[16:19], s30 offen lds
  s_waitcnt lgkmcnt(8)
  v_mfma_f32_16x16x32_bf16 v[216:219], v[64:67], v[24:27], 0
  ds_read_b64_tr_b16 v[16:17], v54 offset:8192
  v_mfma_f32_16x16x32_bf16 v[216:219], v[72:75], v[28:31], v[216:219]
  ds_read_b64_tr_b16 v[18:19], v54 offset:8448
  v_mfma_f32_16x16x32_bf16 v[220:223], v[68:71], v[24:27], 0
  ds_read_b64_tr_b16 v[20:21], v54 offset:10240
  v_mfma_f32_16x16x32_bf16 v[220:223], v[76:79], v[28:31], v[220:223]
  ds_read_b64_tr_b16 v[22:23], v54 offset:10496
  s_add_u32 m0, s28, 122880
  s_add_u32 s30, s26, 1048768
  buffer_load_dwordx4 v50, s[16:19], s30 offen lds
  v_cvt_pk_bf16_f32 v192, v240, v241
  v_cvt_pk_bf16_f32 v193, v242, v243
  v_cvt_pk_bf16_f32 v194, v244, v245
  v_cvt_pk_bf16_f32 v195, v246, v247
  v_cvt_pk_bf16_f32 v196, v248, v249
  v_cvt_pk_bf16_f32 v197, v250, v251
  v_cvt_pk_bf16_f32 v198, v252, v253
  v_cvt_pk_bf16_f32 v199, v254, v255
  s_waitcnt lgkmcnt(8)
  v_mfma_f32_16x16x32_bf16 v[208:211], v[80:83], v[32:35], v[208:211]
  ds_read_b64_tr_b16 v[24:25], v55 offset:8192
  v_mfma_f32_16x16x32_bf16 v[208:211], v[88:91], v[36:39], v[208:211]
  ds_read_b64_tr_b16 v[26:27], v55 offset:8448
  v_mfma_f32_16x16x32_bf16 v[212:215], v[84:87], v[32:35], v[212:215]
  ds_read_b64_tr_b16 v[28:29], v55 offset:10240
  v_mfma_f32_16x16x32_bf16 v[212:215], v[92:95], v[36:39], v[212:215]
  ds_read_b64_tr_b16 v[30:31], v55 offset:10496
  s_add_u32 m0, s28, 131072
  s_add_u32 s30, s26, 2097344
  buffer_load_dwordx4 v50, s[16:19], s30 offen lds
  s_waitcnt lgkmcnt(8)
  v_mfma_f32_16x16x32_bf16 v[216:219], v[80:83], v[40:43], v[216:219]
  ds_read_b64_tr_b16 v[32:33], v54 offset:12288
  v_mfma_f32_16x16x32_bf16 v[216:219], v[88:91], v[44:47], v[216:219]
  ds_read_b64_tr_b16 v[34:35], v54 offset:12544
  v_mfma_f32_16x16x32_bf16 v[220:223], v[84:87], v[40:43], v[220:223]
  ds_read_b64_tr_b16 v[36:37], v54 offset:14336
  v_mfma_f32_16x16x32_bf16 v[220:223], v[92:95], v[44:47], v[220:223]
  ds_read_b64_tr_b16 v[38:39], v54 offset:14592
  s_add_u32 m0, s28, 139264
  s_add_u32 s30, s26, 3145920
  buffer_load_dwordx4 v50, s[16:19], s30 offen lds
  s_waitcnt lgkmcnt(8)
  v_mfma_f32_16x16x32_bf16 v[208:211], v[96:99], v[16:19], v[208:211]
  ds_read_b64_tr_b16 v[40:41], v55 offset:12288
  v_mfma_f32_16x16x32_bf16 v[208:211], v[104:107], v[20:23], v[208:211]
  ds_read_b64_tr_b16 v[42:43], v55 offset:12544
  v_mfma_f32_16x16x32_bf16 v[212:215], v[100:103], v[16:19], v[212:215]
  ds_read_b64_tr_b16 v[44:45], v55 offset:14336
  v_mfma_f32_16x16x32_bf16 v[212:215], v[108:111], v[20:23], v[212:215]
  ds_read_b64_tr_b16 v[46:47], v55 offset:14592
  s_add_u32 s30, s46, 33559552
  buffer_store_dwordx4 v[204:207], v6, s[4:7], s30 offen sc1
  s_waitcnt lgkmcnt(8)
  v_mfma_f32_16x16x32_bf16 v[216:219], v[96:99], v[24:27], v[216:219]
  ds_read_b64_tr_b16 v[16:17], v54 offset:16384
  v_mfma_f32_16x16x32_bf16 v[216:219], v[104:107], v[28:31], v[216:219]
  ds_read_b64_tr_b16 v[18:19], v54 offset:16640
  v_mfma_f32_16x16x32_bf16 v[220:223], v[100:103], v[24:27], v[220:223]
  ds_read_b64_tr_b16 v[20:21], v54 offset:18432
  v_mfma_f32_16x16x32_bf16 v[220:223], v[108:111], v[28:31], v[220:223]
  ds_read_b64_tr_b16 v[22:23], v54 offset:18688
  s_waitcnt lgkmcnt(8)
  v_mfma_f32_16x16x32_bf16 v[208:211], v[112:115], v[32:35], v[208:211]
  ds_read_b64_tr_b16 v[24:25], v55 offset:16384
  v_mfma_f32_16x16x32_bf16 v[208:211], v[120:123], v[36:39], v[208:211]
  ds_read_b64_tr_b16 v[26:27], v55 offset:16640
  v_mfma_f32_16x16x32_bf16 v[212:215], v[116:119], v[32:35], v[212:215]
  ds_read_b64_tr_b16 v[28:29], v55 offset:18432
  v_mfma_f32_16x16x32_bf16 v[212:215], v[124:127], v[36:39], v[212:215]
  ds_read_b64_tr_b16 v[30:31], v55 offset:18688
  s_waitcnt lgkmcnt(8)
  v_mfma_f32_16x16x32_bf16 v[216:219], v[112:115], v[40:43], v[216:219]
  ds_read_b64_tr_b16 v[32:33], v54 offset:20480
  v_mfma_f32_16x16x32_bf16 v[216:219], v[120:123], v[44:47], v[216:219]
  ds_read_b64_tr_b16 v[34:35], v54 offset:20736
  v_mfma_f32_16x16x32_bf16 v[220:223], v[116:119], v[40:43], v[220:223]
  ds_read_b64_tr_b16 v[36:37], v54 offset:22528
  v_mfma_f32_16x16x32_bf16 v[220:223], v[124:127], v[44:47], v[220:223]
  ds_read_b64_tr_b16 v[38:39], v54 offset:22784
  s_waitcnt lgkmcnt(8)
  v_mfma_f32_16x16x32_bf16 v[208:211], v[128:131], v[16:19], v[208:211]
  ds_read_b64_tr_b16 v[40:41], v55 offset:20480
  v_mfma_f32_16x16x32_bf16 v[208:211], v[136:139], v[20:23], v[208:211]
  ds_read_b64_tr_b16 v[42:43], v55 offset:20736
  v_mfma_f32_16x16x32_bf16 v[212:215], v[132:135], v[16:19], v[212:215]
  ds_read_b64_tr_b16 v[44:45], v55 offset:22528
  v_mfma_f32_16x16x32_bf16 v[212:215], v[140:143], v[20:23], v[212:215]
  ds_read_b64_tr_b16 v[46:47], v55 offset:22784
  s_add_u32 s30, s46, 33556480
  buffer_store_dwordx4 v[224:227], v6, s[4:7], s30 offen sc1
  s_waitcnt lgkmcnt(8)
  v_mfma_f32_16x16x32_bf16 v[216:219], v[128:131], v[24:27], v[216:219]
  ds_read_b64_tr_b16 v[16:17], v54 offset:24576
  v_mfma_f32_16x16x32_bf16 v[216:219], v[136:139], v[28:31], v[216:219]
  ds_read_b64_tr_b16 v[18:19], v54 offset:24832
  v_mfma_f32_16x16x32_bf16 v[220:223], v[132:135], v[24:27], v[220:223]
  ds_read_b64_tr_b16 v[20:21], v54 offset:26624
  v_mfma_f32_16x16x32_bf16 v[220:223], v[140:143], v[28:31], v[220:223]
  ds_read_b64_tr_b16 v[22:23], v54 offset:26880
  s_waitcnt lgkmcnt(8)
  v_mfma_f32_16x16x32_bf16 v[208:211], v[144:147], v[32:35], v[208:211]
  ds_read_b64_tr_b16 v[24:25], v55 offset:24576
  v_mfma_f32_16x16x32_bf16 v[208:211], v[152:155], v[36:39], v[208:211]
  ds_read_b64_tr_b16 v[26:27], v55 offset:24832
  v_mfma_f32_16x16x32_bf16 v[212:215], v[148:151], v[32:35], v[212:215]
  ds_read_b64_tr_b16 v[28:29], v55 offset:26624
  v_mfma_f32_16x16x32_bf16 v[212:215], v[156:159], v[36:39], v[212:215]
  ds_read_b64_tr_b16 v[30:31], v55 offset:26880
  s_waitcnt lgkmcnt(8)
  v_mfma_f32_16x16x32_bf16 v[216:219], v[144:147], v[40:43], v[216:219]
  ds_read_b64_tr_b16 v[32:33], v54 offset:28672
  v_mfma_f32_16x16x32_bf16 v[216:219], v[152:155], v[44:47], v[216:219]
  ds_read_b64_tr_b16 v[34:35], v54 offset:28928
  v_mfma_f32_16x16x32_bf16 v[220:223], v[148:151], v[40:43], v[220:223]
  ds_read_b64_tr_b16 v[36:37], v54 offset:30720
  v_mfma_f32_16x16x32_bf16 v[220:223], v[156:159], v[44:47], v[220:223]
  ds_read_b64_tr_b16 v[38:39], v54 offset:30976
  s_waitcnt lgkmcnt(8)
  v_mfma_f32_16x16x32_bf16 v[208:211], v[160:163], v[16:19], v[208:211]
  ds_read_b64_tr_b16 v[40:41], v55 offset:28672
  v_mfma_f32_16x16x32_bf16 v[208:211], v[168:171], v[20:23], v[208:211]
  ds_read_b64_tr_b16 v[42:43], v55 offset:28928
  v_mfma_f32_16x16x32_bf16 v[212:215], v[164:167], v[16:19], v[212:215]
  ds_read_b64_tr_b16 v[44:45], v55 offset:30720
  v_mfma_f32_16x16x32_bf16 v[212:215], v[172:175], v[20:23], v[212:215]
  ds_read_b64_tr_b16 v[46:47], v55 offset:30976
  s_add_u32 s30, s46, 33560576
  buffer_store_dwordx4 v[228:231], v6, s[4:7], s30 offen sc1
  s_waitcnt lgkmcnt(8)
  v_mfma_f32_16x16x32_bf16 v[216:219], v[160:163], v[24:27], v[216:219]
  v_mfma_f32_16x16x32_bf16 v[216:219], v[168:171], v[28:31], v[216:219]
  v_mfma_f32_16x16x32_bf16 v[220:223], v[164:167], v[24:27], v[220:223]
  v_mfma_f32_16x16x32_bf16 v[220:223], v[172:175], v[28:31], v[220:223]
  v_add_u32 v54, 49152, v54
  v_add_u32 v55, 49152, v55
  s_waitcnt lgkmcnt(0)
  s_cmp_lg_u32 s20, 6
  s_cbranch_scc1 L_o14_front_kernel
  s_cmp_ge_u32 s32, 16
  s_cbranch_scc0 L_spinh_front_kernel
  s_cmp_ge_u32 s45, 16
  s_cbranch_scc0 L_spinh_front_kernel
  s_branch L_okh_front_kernel
  s_waitcnt vmcnt(0)
L_chkh_front_kernel:
  v_readfirstlane_b32 s30, v60
  s_nop 0
  s_cmp_ge_u32 s30, 16
  s_cbranch_scc0 L_spinh_front_kernel
  v_readfirstlane_b32 s30, v61
  s_nop 0
  s_cmp_ge_u32 s30, 16
  s_cbranch_scc0 L_spinh_front_kernel
  s_branch L_okh_front_kernel
L_spinh_front_kernel:
  s_add_u32 s100, s100, 1
  s_cmp_gt_u32 s100, 0x20000
  s_cbranch_scc1 L_end_front_kernel
  s_sleep 2
  buffer_load_dword v60, v58, s[4:7], s99 offen sc1
  buffer_load_dword v61, v58, s[4:7], s34 offen sc1
  s_waitcnt vmcnt(0)
  s_branch L_chkh_front_kernel
L_okh_front_kernel:
L_o14_front_kernel:
  s_waitcnt vmcnt(10)
  s_barrier
  v_mfma_f32_16x16x32_bf16 v[208:211], v[176:179], v[32:35], v[208:211]
  ds_read_b64_tr_b16 v[16:17], v54 offset:0
  ds_read_b64_tr_b16 v[18:19], v54 offset:256
  v_mfma_f32_16x16x32_bf16 v[208:211], v[184:187], v[36:39], v[208:211]
  ds_read_b64_tr_b16 v[20:21], v54 offset:2048
  ds_read_b64_tr_b16 v[22:23], v54 offset:2304
  v_mfma_f32_16x16x32_bf16 v[212:215], v[180:183], v[32:35], v[212:215]
  ds_read_b64_tr_b16 v[24:25], v55 offset:0
  ds_read_b64_tr_b16 v[26:27], v55 offset:256
  v_mfma_f32_16x16x32_bf16 v[212:215], v[188:191], v[36:39], v[212:215]
  ds_read_b64_tr_b16 v[28:29], v55 offset:2048
  ds_read_b64_tr_b16 v[30:31], v55 offset:2304
  v_mfma_f32_16x16x32_bf16 v[216:219], v[176:179], v[40:43], v[216:219]
  ds_read_b64_tr_b16 v[32:33], v54 offset:4096
  v_mfma_f32_16x16x32_bf16 v[216:219], v[184:187], v[44:47], v[216:219]
  ds_read_b64_tr_b16 v[34:35], v54 offset:4352
  v_mfma_f32_16x16x32_bf16 v[220:223], v[180:183], v[40:43], v[220:223]
  ds_read_b64_tr_b16 v[36:37], v54 offset:6144
  v_mfma_f32_16x16x32_bf16 v[220:223], v[188:191], v[44:47], v[220:223]
  ds_read_b64_tr_b16 v[38:39], v54 offset:6400
  s_waitcnt lgkmcnt(8)
  v_mfma_f32_16x16x32_bf16 v[240:243], v[64:67], v[16:19], 0
  ds_read_b64_tr_b16 v[40:41], v55 offset:4096
  v_mfma_f32_16x16x32_bf16 v[240:243], v[72:75], v[20:23], v[240:243]
  ds_read_b64_tr_b16 v[42:43], v55 offset:4352
  v_mfma_f32_16x16x32_bf16 v[244:247], v[68:71], v[16:19], 0
  ds_read_b64_tr_b16 v[44:45], v55 offset:6144
  v_mfma_f32_16x16x32_bf16 v[244:247], v[76:79], v[20:23], v[244:247]
  ds_read_b64_tr_b16 v[46:47], v55 offset:6400
  s_add_u32 m0, s28, 49152
  s_add_u32 s30, s26, 0
  buffer_load_dwordx4 v49, s[40:43], s30 offen lds
  s_waitcnt lgkmcnt(8)
  v_mfma_f32_16x16x32_bf16 v[248:251], v[64:67], v[24:27], 0
  ds_read_b64_tr_b16 v[16:17], v54 offset:8192
  v_mfma_f32_16x16x32_bf16 v[248:251], v[72:75], v[28:31], v[248:251]
  ds_read_b64_tr_b16 v[18:19], v54 offset:8448
  v_mfma_f32_16x16x32_bf16 v[252:255], v[68:71], v[24:27], 0
  ds_read_b64_tr_b16 v[20:21], v54 offset:10240
  v_mfma_f32_16x16x32_bf16 v[252:255], v[76:79], v[28:31], v[252:255]
  ds_read_b64_tr_b16 v[22:23], v54 offset:10496
  s_add_u32 m0, s28, 57344
  s_add_u32 s30, s26, 262144
  buffer_load_dwordx4 v49, s[40:43], s30 offen lds
  v_cvt_pk_bf16_f32 v200, v208, v209
  v_cvt_pk_bf16_f32 v201, v210, v211
  v_cvt_pk_bf16_f32 v202, v212, v213
  v_cvt_pk_bf16_f32 v203, v214, v215
  v_cvt_pk_bf16_f32 v204, v216, v217
  v_cvt_pk_bf16_f32 v205, v218, v219
  v_cvt_pk_bf16_f32 v206, v220, v221
  v_cvt_pk_bf16_f32 v207, v222, v223
  s_waitcnt lgkmcnt(8)
  v_mfma_f32_16x16x32_bf16 v[240:243], v[80:83], v[32:35], v[240:243]
  ds_read_b64_tr_b16 v[24:25], v55 offset:8192
  v_mfma_f32_16x16x32_bf16 v[240:243], v[88:91], v[36:39], v[240:243]
  ds_read_b64_tr_b16 v[26:27], v55 offset:8448
  v_mfma_f32_16x16x32_bf16 v[244:247], v[84:87], v[32:35], v[244:247]
  ds_read_b64_tr_b16 v[28:29], v55 offset:10240
  v_mfma_f32_16x16x32_bf16 v[244:247], v[92:95], v[36:39], v[244:247]
  ds_read_b64_tr_b16 v[30:31], v55 offset:10496
  s_add_u32 m0, s28, 16384
  s_add_u32 s30, s36, 0
  buffer_load_dwordx4 v51, s[4:7], s30 offen lds
  s_waitcnt lgkmcnt(8)
  v_mfma_f32_16x16x32_bf16 v[248:251], v[80:83], v[40:43], v[248:251]
  ds_read_b64_tr_b16 v[32:33], v54 offset:12288
  v_mfma_f32_16x16x32_bf16 v[248:251], v[88:91], v[44:47], v[248:251]
  ds_read_b64_tr_b16 v[34:35], v54 offset:12544
  v_mfma_f32_16x16x32_bf16 v[252:255], v[84:87], v[40:43], v[252:255]
  ds_read_b64_tr_b16 v[36:37], v54 offset:14336
  v_mfma_f32_16x16x32_bf16 v[252:255], v[92:95], v[44:47], v[252:255]
  ds_read_b64_tr_b16 v[38:39], v54 offset:14592
  s_add_u32 m0, s28, 24576
  s_add_u32 s30, s36, 73728
  buffer_load_dwordx4 v51, s[4:7], s30 offen lds
  s_waitcnt lgkmcnt(8)
  v_mfma_f32_16x16x32_bf16 v[240:243], v[96:99], v[16:19], v[240:243]
  ds_read_b64_tr_b16 v[40:41], v55 offset:12288
  v_mfma_f32_16x16x32_bf16 v[240:243], v[104:107], v[20:23], v[240:243]
  ds_read_b64_tr_b16 v[42:43], v55 offset:12544
  v_mfma_f32_16x16x32_bf16 v[244:247], v[100:103], v[16:19], v[244:247]
  ds_read_b64_tr_b16 v[44:45], v55 offset:14336
  v_mfma_f32_16x16x32_bf16 v[244:247], v[108:111], v[20:23], v[244:247]
  ds_read_b64_tr_b16 v[46:47], v55 offset:14592
  s_add_u32 m0, s28, 32768
  s_add_u32 s30, s37, 0
  buffer_load_dwordx4 v51, s[4:7], s30 offen lds
  s_add_u32 s30, s46, 33557504
  buffer_store_dwordx4 v[232:235], v6, s[4:7], s30 offen sc1
  s_waitcnt lgkmcnt(8)
  v_mfma_f32_16x16x32_bf16 v[248:251], v[96:99], v[24:27], v[248:251]
  ds_read_b64_tr_b16 v[16:17], v54 offset:16384
  v_mfma_f32_16x16x32_bf16 v[248:251], v[104:107], v[28:31], v[248:251]
  ds_read_b64_tr_b16 v[18:19], v54 offset:16640
  v_mfma_f32_16x16x32_bf16 v[252:255], v[100:103], v[24:27], v[252:255]
  ds_read_b64_tr_b16 v[20:21], v54 offset:18432
  v_mfma_f32_16x16x32_bf16 v[252:255], v[108:111], v[28:31], v[252:255]
  ds_read_b64_tr_b16 v[22:23], v54 offset:18688
  s_add_u32 m0, s28, 40960
  s_add_u32 s30, s37, 73728
  buffer_load_dwordx4 v51, s[4:7], s30 offen lds
  s_waitcnt lgkmcnt(8)
  v_mfma_f32_16x16x32_bf16 v[240:243], v[112:115], v[32:35], v[240:243]
  ds_read_b64_tr_b16 v[24:25], v55 offset:16384
  v_mfma_f32_16x16x32_bf16 v[240:243], v[120:123], v[36:39], v[240:243]
  ds_read_b64_tr_b16 v[26:27], v55 offset:16640
  v_mfma_f32_16x16x32_bf16 v[244:247], v[116:119], v[32:35], v[244:247]
  ds_read_b64_tr_b16 v[28:29], v55 offset:18432
  v_mfma_f32_16x16x32_bf16 v[244:247], v[124:127], v[36:39], v[244:247]
  ds_read_b64_tr_b16 v[30:31], v55 offset:18688
  s_waitcnt lgkmcnt(8)
  v_mfma_f32_16x16x32_bf16 v[248:251], v[112:115], v[40:43], v[248:251]
  ds_read_b64_tr_b16 v[32:33], v54 offset:20480
  v_mfma_f32_16x16x32_bf16 v[248:251], v[120:123], v[44:47], v[248:251]
  ds_read_b64_tr_b16 v[34:35], v54 offset:20736
  v_mfma_f32_16x16x32_bf16 v[252:255], v[116:119], v[40:43], v[252:255]
  ds_read_b64_tr_b16 v[36:37], v54 offset:22528
  v_mfma_f32_16x16x32_bf16 v[252:255], v[124:127], v[44:47], v[252:255]
  ds_read_b64_tr_b16 v[38:39], v54 offset:22784
  s_waitcnt lgkmcnt(8)
  v_mfma_f32_16x16x32_bf16 v[240:243], v[128:131], v[16:19], v[240:243]
  ds_read_b64_tr_b16 v[40:41], v55 offset:20480
  v_mfma_f32_16x16x32_bf16 v[240:243], v[136:139], v[20:23], v[240:243]
  ds_read_b64_tr_b16 v[42:43], v55 offset:20736
  v_mfma_f32_16x16x32_bf16 v[244:247], v[132:135], v[16:19], v[244:247]
  ds_read_b64_tr_b16 v[44:45], v55 offset:22528
  v_mfma_f32_16x16x32_bf16 v[244:247], v[140:143], v[20:23], v[244:247]
  ds_read_b64_tr_b16 v[46:47], v55 offset:22784
  s_add_u32 s30, s46, 33561600
  buffer_store_dwordx4 v[236:239], v6, s[4:7], s30 offen sc1
  s_waitcnt lgkmcnt(8)
  v_mfma_f32_16x16x32_bf16 v[248:251], v[128:131], v[24:27], v[248:251]
  ds_read_b64_tr_b16 v[16:17], v54 offset:24576
  v_mfma_f32_16x16x32_bf16 v[248:251], v[136:139], v[28:31], v[248:251]
  ds_read_b64_tr_b16 v[18:19], v54 offset:24832
  v_mfma_f32_16x16x32_bf16 v[252:255], v[132:135], v[24:27], v[252:255]
  ds_read_b64_tr_b16 v[20:21], v54 offset:26624
  v_mfma_f32_16x16x32_bf16 v[252:255], v[140:143], v[28:31], v[252:255]
  ds_read_b64_tr_b16 v[22:23], v54 offset:26880
  s_waitcnt lgkmcnt(8)
  v_mfma_f32_16x16x32_bf16 v[240:243], v[144:147], v[32:35], v[240:243]
  ds_read_b64_tr_b16 v[24:25], v55 offset:24576
  v_mfma_f32_16x16x32_bf16 v[240:243], v[152:155], v[36:39], v[240:243]
  ds_read_b64_tr_b16 v[26:27], v55 offset:24832
  v_mfma_f32_16x16x32_bf16 v[244:247], v[148:151], v[32:35], v[244:247]
  ds_read_b64_tr_b16 v[28:29], v55 offset:26624
  v_mfma_f32_16x16x32_bf16 v[244:247], v[156:159], v[36:39], v[244:247]
  ds_read_b64_tr_b16 v[30:31], v55 offset:26880
  s_waitcnt lgkmcnt(8)
  v_mfma_f32_16x16x32_bf16 v[248:251], v[144:147], v[40:43], v[248:251]
  ds_read_b64_tr_b16 v[32:33], v54 offset:28672
  v_mfma_f32_16x16x32_bf16 v[248:251], v[152:155], v[44:47], v[248:251]
  ds_read_b64_tr_b16 v[34:35], v54 offset:28928
  v_mfma_f32_16x16x32_bf16 v[252:255], v[148:151], v[40:43], v[252:255]
  ds_read_b64_tr_b16 v[36:37], v54 offset:30720
  v_mfma_f32_16x16x32_bf16 v[252:255], v[156:159], v[44:47], v[252:255]
  ds_read_b64_tr_b16 v[38:39], v54 offset:30976
  s_waitcnt lgkmcnt(8)
  v_mfma_f32_16x16x32_bf16 v[240:243], v[160:163], v[16:19], v[240:243]
  ds_read_b64_tr_b16 v[40:41], v55 offset:28672
  v_mfma_f32_16x16x32_bf16 v[240:243], v[168:171], v[20:23], v[240:243]
  ds_read_b64_tr_b16 v[42:43], v55 offset:28928
  v_mfma_f32_16x16x32_bf16 v[244:247], v[164:167], v[16:19], v[244:247]
  ds_read_b64_tr_b16 v[44:45], v55 offset:30720
  v_mfma_f32_16x16x32_bf16 v[244:247], v[172:175], v[20:23], v[244:247]
  ds_read_b64_tr_b16 v[46:47], v55 offset:30976
  s_add_u32 s30, s46, 50331648
  buffer_store_dwordx4 v[192:195], v6, s[4:7], s30 offen sc1
  s_waitcnt lgkmcnt(8)
  v_mfma_f32_16x16x32_bf16 v[248:251], v[160:163], v[24:27], v[248:251]
  v_mfma_f32_16x16x32_bf16 v[248:251], v[168:171], v[28:31], v[248:251]
  v_mfma_f32_16x16x32_bf16 v[252:255], v[164:167], v[24:27], v[252:255]
  v_mfma_f32_16x16x32_bf16 v[252:255], v[172:175], v[28:31], v[252:255]
  v_add_u32 v54, 49152, v54
  v_add_u32 v55, 49152, v55
  s_waitcnt lgkmcnt(0)
  s_waitcnt vmcnt(12)
  s_barrier
  v_mfma_f32_16x16x32_bf16 v[240:243], v[176:179], v[32:35], v[240:243]
  ds_read_b64_tr_b16 v[16:17], v54 offset:0
  ds_read_b64_tr_b16 v[18:19], v54 offset:256
  v_mfma_f32_16x16x32_bf16 v[240:243], v[184:187], v[36:39], v[240:243]
  ds_read_b64_tr_b16 v[20:21], v54 offset:2048
  ds_read_b64_tr_b16 v[22:23], v54 offset:2304
  v_mfma_f32_16x16x32_bf16 v[244:247], v[180:183], v[32:35], v[244:247]
  ds_read_b64_tr_b16 v[24:25], v55 offset:0
  ds_read_b64_tr_b16 v[26:27], v55 offset:256
  v_mfma_f32_16x16x32_bf16 v[244:247], v[188:191], v[36:39], v[244:247]
  ds_read_b64_tr_b16 v[28:29], v55 offset:2048
  ds_read_b64_tr_b16 v[30:31], v55 offset:2304
  v_mfma_f32_16x16x32_bf16 v[248:251], v[176:179], v[40:43], v[248:251]
  ds_read_b64_tr_b16 v[32:33], v54 offset:4096
  v_mfma_f32_16x16x32_bf16 v[248:251], v[184:187], v[44:47], v[248:251]
  ds_read_b64_tr_b16 v[34:35], v54 offset:4352
  v_mfma_f32_16x16x32_bf16 v[252:255], v[180:183], v[40:43], v[252:255]
  ds_read_b64_tr_b16 v[36:37], v54 offset:6144
  v_mfma_f32_16x16x32_bf16 v[252:255], v[188:191], v[44:47], v[252:255]
  ds_read_b64_tr_b16 v[38:39], v54 offset:6400
  s_waitcnt lgkmcnt(8)
  v_mfma_f32_16x16x32_bf16 v[208:211], v[64:67], v[16:19], 0
  ds_read_b64_tr_b16 v[40:41], v55 offset:4096
  v_mfma_f32_16x16x32_bf16 v[208:211], v[72:75], v[20:23], v[208:211]
  ds_read_b64_tr_b16 v[42:43], v55 offset:4352
  v_mfma_f32_16x16x32_bf16 v[212:215], v[68:71], v[16:19], 0
  ds_read_b64_tr_b16 v[44:45], v55 offset:6144
  v_mfma_f32_16x16x32_bf16 v[212:215], v[76:79], v[20:23], v[212:215]
  ds_read_b64_tr_b16 v[46:47], v55 offset:6400
  s_add_u32 m0, s28, 98304
  s_add_u32 s30, s26, 524288
  buffer_load_dwordx4 v49, s[40:43], s30 offen lds
  s_waitcnt lgkmcnt(8)
  v_mfma_f32_16x16x32_bf16 v[216:219], v[64:67], v[24:27], 0
  ds_read_b64_tr_b16 v[16:17], v54 offset:8192
  v_mfma_f32_16x16x32_bf16 v[216:219], v[72:75], v[28:31], v[216:219]
  ds_read_b64_tr_b16 v[18:19], v54 offset:8448
  v_mfma_f32_16x16x32_bf16 v[220:223], v[68:71], v[24:27], 0
  ds_read_b64_tr_b16 v[20:21], v54 offset:10240
  v_mfma_f32_16x16x32_bf16 v[220:223], v[76:79], v[28:31], v[220:223]
  ds_read_b64_tr_b16 v[22:23], v54 offset:10496
  s_add_u32 m0, s28, 106496
  s_add_u32 s30, s26, 786432
  buffer_load_dwordx4 v49, s[40:43], s30 offen lds
  v_cvt_pk_bf16_f32 v224, v240, v241
  v_cvt_pk_bf16_f32 v225, v242, v243
  v_cvt_pk_bf16_f32 v226, v244, v245
  v_cvt_pk_bf16_f32 v227, v246, v247
  v_cvt_pk_bf16_f32 v228, v248, v249
  v_cvt_pk_bf16_f32 v229, v250, v251
  v_cvt_pk_bf16_f32 v230, v252, v253
  v_cvt_pk_bf16_f32 v231, v254, v255
  s_waitcnt lgkmcnt(8)
  v_mfma_f32_16x16x32_bf16 v[208:211], v[80:83], v[32:35], v[208:211]
  ds_read_b64_tr_b16 v[24:25], v55 offset:8192
  v_mfma_f32_16x16x32_bf16 v[208:211], v[88:91], v[36:39], v[208:211]
  ds_read_b64_tr_b16 v[26:27], v55 offset:8448
  v_mfma_f32_16x16x32_bf16 v[212:215], v[84:87], v[32:35], v[212:215]
  ds_read_b64_tr_b16 v[28:29], v55 offset:10240
  v_mfma_f32_16x16x32_bf16 v[212:215], v[92:95], v[36:39], v[212:215]
  ds_read_b64_tr_b16 v[30:31], v55 offset:10496
  s_add_u32 m0, s28, 65536
  s_add_u32 s30, s36, 128
  buffer_load_dwordx4 v51, s[4:7], s30 offen lds
  s_waitcnt lgkmcnt(8)
  v_mfma_f32_16x16x32_bf16 v[216:219], v[80:83], v[40:43], v[216:219]
  ds_read_b64_tr_b16 v[32:33], v54 offset:12288
  v_mfma_f32_16x16x32_bf16 v[216:219], v[88:91], v[44:47], v[216:219]
  ds_read_b64_tr_b16 v[34:35], v54 offset:12544
  v_mfma_f32_16x16x32_bf16 v[220:223], v[84:87], v[40:43], v[220:223]
  ds_read_b64_tr_b16 v[36:37], v54 offset:14336
  v_mfma_f32_16x16x32_bf16 v[220:223], v[92:95], v[44:47], v[220:223]
  ds_read_b64_tr_b16 v[38:39], v54 offset:14592
  s_add_u32 m0, s28, 73728
  s_add_u32 s30, s36, 73856
  buffer_load_dwordx4 v51, s[4:7], s30 offen lds
  s_waitcnt lgkmcnt(8)
  v_mfma_f32_16x16x32_bf16 v[208:211], v[96:99], v[16:19], v[208:211]
  ds_read_b64_tr_b16 v[40:41], v55 offset:12288
  v_mfma_f32_16x16x32_bf16 v[208:211], v[104:107], v[20:23], v[208:211]
  ds_read_b64_tr_b16 v[42:43], v55 offset:12544
  v_mfma_f32_16x16x32_bf16 v[212:215], v[100:103], v[16:19], v[212:215]
  ds_read_b64_tr_b16 v[44:45], v55 offset:14336
  v_mfma_f32_16x16x32_bf16 v[212:215], v[108:111], v[20:23], v[212:215]
  ds_read_b64_tr_b16 v[46:47], v55 offset:14592
  s_add_u32 m0, s28, 81920
  s_add_u32 s30, s37, 128
  buffer_load_dwordx4 v51, s[4:7], s30 offen lds
  s_add_u32 s30, s46, 50332672
  buffer_store_dwordx4 v[196:199], v6, s[4:7], s30 offen sc1
  s_waitcnt lgkmcnt(8)
  v_mfma_f32_16x16x32_bf16 v[216:219], v[96:99], v[24:27], v[216:219]
  ds_read_b64_tr_b16 v[16:17], v54 offset:16384
  v_mfma_f32_16x16x32_bf16 v[216:219], v[104:107], v[28:31], v[216:219]
  ds_read_b64_tr_b16 v[18:19], v54 offset:16640
  v_mfma_f32_16x16x32_bf16 v[220:223], v[100:103], v[24:27], v[220:223]
  ds_read_b64_tr_b16 v[20:21], v54 offset:18432
  v_mfma_f32_16x16x32_bf16 v[220:223], v[108:111], v[28:31], v[220:223]
  ds_read_b64_tr_b16 v[22:23], v54 offset:18688
  s_add_u32 m0, s28, 90112
  s_add_u32 s30, s37, 73856
  buffer_load_dwordx4 v51, s[4:7], s30 offen lds
  s_waitcnt lgkmcnt(8)
  v_mfma_f32_16x16x32_bf16 v[208:211], v[112:115], v[32:35], v[208:211]
  ds_read_b64_tr_b16 v[24:25], v55 offset:16384
  v_mfma_f32_16x16x32_bf16 v[208:211], v[120:123], v[36:39], v[208:211]
  ds_read_b64_tr_b16 v[26:27], v55 offset:16640
  v_mfma_f32_16x16x32_bf16 v[212:215], v[116:119], v[32:35], v[212:215]
  ds_read_b64_tr_b16 v[28:29], v55 offset:18432
  v_mfma_f32_16x16x32_bf16 v[212:215], v[124:127], v[36:39], v[212:215]
  ds_read_b64_tr_b16 v[30:31], v55 offset:18688
  s_waitcnt lgkmcnt(8)
  v_mfma_f32_16x16x32_bf16 v[216:219], v[112:115], v[40:43], v[216:219]
  ds_read_b64_tr_b16 v[32:33], v54 offset:20480
  v_mfma_f32_16x16x32_bf16 v[216:219], v[120:123], v[44:47], v[216:219]
  ds_read_b64_tr_b16 v[34:35], v54 offset:20736
  v_mfma_f32_16x16x32_bf16 v[220:223], v[116:119], v[40:43], v[220:223]
  ds_read_b64_tr_b16 v[36:37], v54 offset:22528
  v_mfma_f32_16x16x32_bf16 v[220:223], v[124:127], v[44:47], v[220:223]
  ds_read_b64_tr_b16 v[38:39], v54 offset:22784
  s_waitcnt lgkmcnt(8)
  v_mfma_f32_16x16x32_bf16 v[208:211], v[128:131], v[16:19], v[208:211]
  ds_read_b64_tr_b16 v[40:41], v55 offset:20480
  v_mfma_f32_16x16x32_bf16 v[208:211], v[136:139], v[20:23], v[208:211]
  ds_read_b64_tr_b16 v[42:43], v55 offset:20736
  v_mfma_f32_16x16x32_bf16 v[212:215], v[132:135], v[16:19], v[212:215]
  ds_read_b64_tr_b16 v[44:45], v55 offset:22528
  v_mfma_f32_16x16x32_bf16 v[212:215], v[140:143], v[20:23], v[212:215]
  ds_read_b64_tr_b16 v[46:47], v55 offset:22784
  s_add_u32 s30, s46, 50333696
  buffer_store_dwordx4 v[200:203], v6, s[4:7], s30 offen sc1
  s_waitcnt lgkmcnt(8)
  v_mfma_f32_16x16x32_bf16 v[216:219], v[128:131], v[24:27], v[216:219]
  ds_read_b64_tr_b16 v[16:17], v54 offset:24576
  v_mfma_f32_16x16x32_bf16 v[216:219], v[136:139], v[28:31], v[216:219]
  ds_read_b64_tr_b16 v[18:19], v54 offset:24832
  v_mfma_f32_16x16x32_bf16 v[220:223], v[132:135], v[24:27], v[220:223]
  ds_read_b64_tr_b16 v[20:21], v54 offset:26624
  v_mfma_f32_16x16x32_bf16 v[220:223], v[140:143], v[28:31], v[220:223]
  ds_read_b64_tr_b16 v[22:23], v54 offset:26880
  s_waitcnt lgkmcnt(8)
  v_mfma_f32_16x16x32_bf16 v[208:211], v[144:147], v[32:35], v[208:211]
  ds_read_b64_tr_b16 v[24:25], v55 offset:24576
  v_mfma_f32_16x16x32_bf16 v[208:211], v[152:155], v[36:39], v[208:211]
  ds_read_b64_tr_b16 v[26:27], v55 offset:24832
  v_mfma_f32_16x16x32_bf16 v[212:215], v[148:151], v[32:35], v[212:215]
  ds_read_b64_tr_b16 v[28:29], v55 offset:26624
  v_mfma_f32_16x16x32_bf16 v[212:215], v[156:159], v[36:39], v[212:215]
  ds_read_b64_tr_b16 v[30:31], v55 offset:26880
  s_waitcnt lgkmcnt(8)
  v_mfma_f32_16x16x32_bf16 v[216:219], v[144:147], v[40:43], v[216:219]
  ds_read_b64_tr_b16 v[32:33], v54 offset:28672
  v_mfma_f32_16x16x32_bf16 v[216:219], v[152:155], v[44:47], v[216:219]
  ds_read_b64_tr_b16 v[34:35], v54 offset:28928
  v_mfma_f32_16x16x32_bf16 v[220:223], v[148:151], v[40:43], v[220:223]
  ds_read_b64_tr_b16 v[36:37], v54 offset:30720
  v_mfma_f32_16x16x32_bf16 v[220:223], v[156:159], v[44:47], v[220:223]
  ds_read_b64_tr_b16 v[38:39], v54 offset:30976
  s_waitcnt lgkmcnt(8)
  v_mfma_f32_16x16x32_bf16 v[208:211], v[160:163], v[16:19], v[208:211]
  ds_read_b64_tr_b16 v[40:41], v55 offset:28672
  v_mfma_f32_16x16x32_bf16 v[208:211], v[168:171], v[20:23], v[208:211]
  ds_read_b64_tr_b16 v[42:43], v55 offset:28928
  v_mfma_f32_16x16x32_bf16 v[212:215], v[164:167], v[16:19], v[212:215]
  ds_read_b64_tr_b16 v[44:45], v55 offset:30720
  v_mfma_f32_16x16x32_bf16 v[212:215], v[172:175], v[20:23], v[212:215]
  ds_read_b64_tr_b16 v[46:47], v55 offset:30976
  s_add_u32 s30, s46, 50334720
  buffer_store_dwordx4 v[204:207], v6, s[4:7], s30 offen sc1
  s_waitcnt lgkmcnt(8)
  v_mfma_f32_16x16x32_bf16 v[216:219], v[160:163], v[24:27], v[216:219]
  v_mfma_f32_16x16x32_bf16 v[216:219], v[168:171], v[28:31], v[216:219]
  v_mfma_f32_16x16x32_bf16 v[220:223], v[164:167], v[24:27], v[220:223]
  v_mfma_f32_16x16x32_bf16 v[220:223], v[172:175], v[28:31], v[220:223]
  s_waitcnt lgkmcnt(0)
  s_waitcnt vmcnt(11)
  s_barrier
  v_mfma_f32_16x16x32_bf16 v[208:211], v[176:179], v[32:35], v[208:211]
  ds_read_b128 v[128:131], v52 offset:0
  ds_read_b128 v[132:135], v53 offset:0
  v_mfma_f32_16x16x32_bf16 v[208:211], v[184:187], v[36:39], v[208:211]
  ds_read_b128 v[136:139], v52 offset:2048
  ds_read_b128 v[140:143], v53 offset:2048
  v_mfma_f32_16x16x32_bf16 v[212:215], v[180:183], v[32:35], v[212:215]
  ds_read_b128 v[144:147], v52 offset:16384
  ds_read_b128 v[148:151], v53 offset:16384
  v_mfma_f32_16x16x32_bf16 v[212:215], v[188:191], v[36:39], v[212:215]
  ds_read_b128 v[152:155], v52 offset:18432
  ds_read_b128 v[156:159], v53 offset:18432
  v_mfma_f32_16x16x32_bf16 v[216:219], v[176:179], v[40:43], v[216:219]
  ds_read_b64_tr_b16 v[16:17], v7 offset:0
  v_mfma_f32_16x16x32_bf16 v[216:219], v[184:187], v[44:47], v[216:219]
  ds_read_b64_tr_b16 v[18:19], v9 offset:512
  v_mfma_f32_16x16x32_bf16 v[220:223], v[180:183], v[40:43], v[220:223]
  ds_read_b64_tr_b16 v[20:21], v7 offset:8192
  v_mfma_f32_16x16x32_bf16 v[220:223], v[188:191], v[44:47], v[220:223]
  ds_read_b64_tr_b16 v[22:23], v9 offset:8704
  s_waitcnt lgkmcnt(8)
  ds_read_b64_tr_b16 v[24:25], v8 offset:0
  ds_read_b64_tr_b16 v[26:27], v10 offset:512
  ds_read_b64_tr_b16 v[28:29], v8 offset:8192
  ds_read_b64_tr_b16 v[30:31], v10 offset:8704
  s_waitcnt lgkmcnt(4)
  v_mfma_f32_16x16x32_bf16 v[64:67], v[16:19], v[128:131], 0
  ds_read_b64_tr_b16 v[32:33], v9 offset:0
  v_mfma_f32_16x16x32_bf16 v[64:67], v[20:23], v[132:135], v[64:67]
  ds_read_b64_tr_b16 v[34:35], v7 offset:512
  v_mfma_f32_16x16x32_bf16 v[80:83], v[16:19], v[136:139], 0
  ds_read_b64_tr_b16 v[36:37], v9 offset:8192
  v_mfma_f32_16x16x32_bf16 v[80:83], v[20:23], v[140:143], v[80:83]
  ds_read_b64_tr_b16 v[38:39], v7 offset:8704
  v_mfma_f32_16x16x32_bf16 v[96:99], v[16:19], v[144:147], 0
  s_add_u32 m0, s28, 147456
  s_add_u32 s30, s26, 1048576
  buffer_load_dwordx4 v49, s[40:43], s30 offen lds
  v_mfma_f32_16x16x32_bf16 v[96:99], v[20:23], v[148:151], v[96:99]
  s_add_u32 m0, s28, 155648
  s_add_u32 s30, s26, 1310720
  buffer_load_dwordx4 v49, s[40:43], s30 offen lds
  v_mfma_f32_16x16x32_bf16 v[112:115], v[16:19], v[152:155], 0
  s_add_u32 m0, s28, 114688
  s_add_u32 s30, s36, 256
  buffer_load_dwordx4 v51, s[4:7], s30 offen lds
  v_mfma_f32_16x16x32_bf16 v[112:115], v[20:23], v[156:159], v[112:115]
  v_cvt_pk_bf16_f32 v232, v208, v209
  v_cvt_pk_bf16_f32 v233, v210, v211
  v_cvt_pk_bf16_f32 v234, v212, v213
  v_cvt_pk_bf16_f32 v235, v214, v215
  v_cvt_pk_bf16_f32 v236, v216, v217
  v_cvt_pk_bf16_f32 v237, v218, v219
  v_cvt_pk_bf16_f32 v238, v220, v221
  v_cvt_pk_bf16_f32 v239, v222, v223
  s_add_u32 s30, s46, 50335744
  buffer_store_dwordx4 v[224:227], v6, s[4:7], s30 offen sc1
  s_waitcnt lgkmcnt(4)
  v_mfma_f32_16x16x32_bf16 v[68:71], v[24:27], v[128:131], 0
  ds_read_b64_tr_b16 v[40:41], v10 offset:0
  v_mfma_f32_16x16x32_bf16 v[68:71], v[28:31], v[132:135], v[68:71]
  ds_read_b64_tr_b16 v[42:43], v8 offset:512
  v_mfma_f32_16x16x32_bf16 v[84:87], v[24:27], v[136:139], 0
  ds_read_b64_tr_b16 v[44:45], v10 offset:8192
  v_mfma_f32_16x16x32_bf16 v[84:87], v[28:31], v[140:143], v[84:87]
  ds_read_b64_tr_b16 v[46:47], v8 offset:8704
  v_mfma_f32_16x16x32_bf16 v[100:103], v[24:27], v[144:147], 0
  s_add_u32 m0, s28, 122880
  s_add_u32 s30, s36, 73984
  buffer_load_dwordx4 v51, s[4:7], s30 offen lds
  v_mfma_f32_16x16x32_bf16 v[100:103], v[28:31], v[148:151], v[100:103]
  s_add_u32 m0, s28, 131072
  s_add_u32 s30, s37, 256
  buffer_load_dwordx4 v51, s[4:7], s30 offen lds
  v_mfma_f32_16x16x32_bf16 v[116:119], v[24:27], v[152:155], 0
  s_add_u32 m0, s28, 139264
  s_add_u32 s30, s37, 73984
  buffer_load_dwordx4 v51, s[4:7], s30 offen lds
  v_mfma_f32_16x16x32_bf16 v[116:119], v[28:31], v[156:159], v[116:119]
  s_add_u32 s30, s46, 50336768
  buffer_store_dwordx4 v[228:231], v6, s[4:7], s30 offen sc1
  s_waitcnt lgkmcnt(4)
  v_mfma_f32_16x16x32_bf16 v[72:75], v[32:35], v[128:131], 0
  v_add_u32 v52, 49152, v52
  v_add_u32 v53, 49152, v53
  v_mfma_f32_16x16x32_bf16 v[72:75], v[36:39], v[132:135], v[72:75]
  v_add_u32 v7, 49152, v7
  v_add_u32 v8, 49152, v8
  v_mfma_f32_16x16x32_bf16 v[88:91], v[32:35], v[136:139], 0
  v_add_u32 v9, 49152, v9
  v_add_u32 v10, 49152, v10
  v_mfma_f32_16x16x32_bf16 v[88:91], v[36:39], v[140:143], v[88:91]
  s_waitcnt lgkmcnt(0)
  s_waitcnt vmcnt(10)
  s_barrier
  v_mfma_f32_16x16x32_bf16 v[104:107], v[32:35], v[144:147], 0
  ds_read_b128 v[160:163], v52 offset:0
  ds_read_b128 v[164:167], v53 offset:0
  v_mfma_f32_16x16x32_bf16 v[104:107], v[36:39], v[148:151], v[104:107]
  ds_read_b128 v[168:171], v52 offset:2048
  ds_read_b128 v[172:175], v53 offset:2048
  v_mfma_f32_16x16x32_bf16 v[120:123], v[32:35], v[152:155], 0
  ds_read_b128 v[176:179], v52 offset:16384
  ds_read_b128 v[180:183], v53 offset:16384
  v_mfma_f32_16x16x32_bf16 v[120:123], v[36:39], v[156:159], v[120:123]
  ds_read_b128 v[184:187], v52 offset:18432
  ds_read_b128 v[188:191], v53 offset:18432
  v_mfma_f32_16x16x32_bf16 v[76:79], v[40:43], v[128:131], 0
  ds_read_b64_tr_b16 v[16:17], v7 offset:0
  ds_read_b64_tr_b16 v[18:19], v9 offset:512
  v_mfma_f32_16x16x32_bf16 v[76:79], v[44:47], v[132:135], v[76:79]
  ds_read_b64_tr_b16 v[20:21], v7 offset:8192
  ds_read_b64_tr_b16 v[22:23], v9 offset:8704
  v_mfma_f32_16x16x32_bf16 v[92:95], v[40:43], v[136:139], 0
  v_mfma_f32_16x16x32_bf16 v[92:95], v[44:47], v[140:143], v[92:95]
  s_waitcnt lgkmcnt(8)
  v_mfma_f32_16x16x32_bf16 v[108:111], v[40:43], v[144:147], 0
  ds_read_b64_tr_b16 v[24:25], v8 offset:0
  v_mfma_f32_16x16x32_bf16 v[108:111], v[44:47], v[148:151], v[108:111]
  ds_read_b64_tr_b16 v[26:27], v10 offset:512
  v_mfma_f32_16x16x32_bf16 v[124:127], v[40:43], v[152:155], 0
  ds_read_b64_tr_b16 v[28:29], v8 offset:8192
  v_mfma_f32_16x16x32_bf16 v[124:127], v[44:47], v[156:159], v[124:127]
  ds_read_b64_tr_b16 v[30:31], v10 offset:8704
  s_waitcnt lgkmcnt(4)
  v_mfma_f32_16x16x32_bf16 v[64:67], v[16:19], v[160:163], v[64:67]
  ds_read_b64_tr_b16 v[32:33], v9 offset:0
  v_mfma_f32_16x16x32_bf16 v[64:67], v[20:23], v[164:167], v[64:67]
  ds_read_b64_tr_b16 v[34:35], v7 offset:512
  v_mfma_f32_16x16x32_bf16 v[80:83], v[16:19], v[168:171], v[80:83]
  ds_read_b64_tr_b16 v[36:37], v9 offset:8192
  v_mfma_f32_16x16x32_bf16 v[80:83], v[20:23], v[172:175], v[80:83]
  ds_read_b64_tr_b16 v[38:39], v7 offset:8704
  v_mfma_f32_16x16x32_bf16 v[96:99], v[16:19], v[176:179], v[96:99]
  s_add_u32 m0, s28, 49152
  s_add_u32 s30, s26, 1572864
  buffer_load_dwordx4 v49, s[40:43], s30 offen lds
  v_mfma_f32_16x16x32_bf16 v[96:99], v[20:23], v[180:183], v[96:99]
  s_add_u32 m0, s28, 57344
  s_add_u32 s30, s26, 1835008
  buffer_load_dwordx4 v49, s[40:43], s30 offen lds
  v_mfma_f32_16x16x32_bf16 v[112:115], v[16:19], v[184:187], v[112:115]
  s_add_u32 m0, s28, 16384
  s_add_u32 s30, s36, 384
  buffer_load_dwordx4 v51, s[4:7], s30 offen lds
  v_mfma_f32_16x16x32_bf16 v[112:115], v[20:23], v[188:191], v[112:115]
  s_add_u32 s30, s46, 50337792
  buffer_store_dwordx4 v[232:235], v6, s[4:7], s30 offen sc1
  s_waitcnt lgkmcnt(4)
  v_mfma_f32_16x16x32_bf16 v[68:71], v[24:27], v[160:163], v[68:71]
  ds_read_b64_tr_b16 v[40:41], v10 offset:0
  v_mfma_f32_16x16x32_bf16 v[68:71], v[28:31], v[164:167], v[68:71]
  ds_read_b64_tr_b16 v[42:43], v8 offset:512
  v_mfma_f32_16x16x32_bf16 v[84:87], v[24:27], v[168:171], v[84:87]
  ds_read_b64_tr_b16 v[44:45], v10 offset:8192
  v_mfma_f32_16x16x32_bf16 v[84:87], v[28:31], v[172:175], v[84:87]
  ds_read_b64_tr_b16 v[46:47], v8 offset:8704
  v_mfma_f32_16x16x32_bf16 v[100:103], v[24:27], v[176:179], v[100:103]
  s_add_u32 m0, s28, 24576
  s_add_u32 s30, s36, 74112
  buffer_load_dwordx4 v51, s[4:7], s30 offen lds
  v_mfma_f32_16x16x32_bf16 v[100:103], v[28:31], v[180:183], v[100:103]
  s_add_u32 m0, s28, 32768
  s_add_u32 s30, s37, 384
  buffer_load_dwordx4 v51, s[4:7], s30 offen lds
  v_mfma_f32_16x16x32_bf16 v[116:119], v[24:27], v[184:187], v[116:119]
  s_add_u32 m0, s28, 40960
  s_add_u32 s30, s37, 74112
  buffer_load_dwordx4 v51, s[4:7], s30 offen lds
  v_mfma_f32_16x16x32_bf16 v[116:119], v[28:31], v[188:191], v[116:119]
  s_add_u32 s30, s46, 50338816
  buffer_store_dwordx4 v[236:239], v6, s[4:7], s30 offen sc1
  s_waitcnt lgkmcnt(4)
  v_mfma_f32_16x16x32_bf16 v[72:75], v[32:35], v[160:163], v[72:75]
  v_add_u32 v52, 49152, v52
  v_add_u32 v53, 49152, v53
  v_mfma_f32_16x16x32_bf16 v[72:75], v[36:39], v[164:167], v[72:75]
  v_add_u32 v7, 49152, v7
  v_add_u32 v8, 49152, v8
  v_mfma_f32_16x16x32_bf16 v[88:91], v[32:35], v[168:171], v[88:91]
  v_add_u32 v9, 49152, v9
  v_add_u32 v10, 49152, v10
  v_mfma_f32_16x16x32_bf16 v[88:91], v[36:39], v[172:175], v[88:91]
  s_waitcnt lgkmcnt(0)
  s_waitcnt vmcnt(9)
  s_barrier
  v_mfma_f32_16x16x32_bf16 v[104:107], v[32:35], v[176:179], v[104:107]
  ds_read_b128 v[128:131], v52 offset:0
  ds_read_b128 v[132:135], v53 offset:0
  v_mfma_f32_16x16x32_bf16 v[104:107], v[36:39], v[180:183], v[104:107]
  ds_read_b128 v[136:139], v52 offset:2048
  ds_read_b128 v[140:143], v53 offset:2048
  v_mfma_f32_16x16x32_bf16 v[120:123], v[32:35], v[184:187], v[120:123]
  ds_read_b128 v[144:147], v52 offset:16384
  ds_read_b128 v[148:151], v53 offset:16384
  v_mfma_f32_16x16x32_bf16 v[120:123], v[36:39], v[188:191], v[120:123]
  ds_read_b128 v[152:155], v52 offset:18432
  ds_read_b128 v[156:159], v53 offset:18432
  v_mfma_f32_16x16x32_bf16 v[76:79], v[40:43], v[160:163], v[76:79]
  ds_read_b64_tr_b16 v[16:17], v7 offset:0
  ds_read_b64_tr_b16 v[18:19], v9 offset:512
  v_mfma_f32_16x16x32_bf16 v[76:79], v[44:47], v[164:167], v[76:79]
  ds_read_b64_tr_b16 v[20:21], v7 offset:8192
  ds_read_b64_tr_b16 v[22:23], v9 offset:8704
  v_mfma_f32_16x16x32_bf16 v[92:95], v[40:43], v[168:171], v[92:95]
  v_mfma_f32_16x16x32_bf16 v[92:95], v[44:47], v[172:175], v[92:95]
  s_waitcnt lgkmcnt(8)
  v_mfma_f32_16x16x32_bf16 v[108:111], v[40:43], v[176:179], v[108:111]
  ds_read_b64_tr_b16 v[24:25], v8 offset:0
  v_mfma_f32_16x16x32_bf16 v[108:111], v[44:47], v[180:183], v[108:111]
  ds_read_b64_tr_b16 v[26:27], v10 offset:512
  v_mfma_f32_16x16x32_bf16 v[124:127], v[40:43], v[184:187], v[124:127]
  ds_read_b64_tr_b16 v[28:29], v8 offset:8192
  v_mfma_f32_16x16x32_bf16 v[124:127], v[44:47], v[188:191], v[124:127]
  ds_read_b64_tr_b16 v[30:31], v10 offset:8704
  s_waitcnt lgkmcnt(4)
  v_mfma_f32_16x16x32_bf16 v[64:67], v[16:19], v[128:131], v[64:67]
  ds_read_b64_tr_b16 v[32:33], v9 offset:0
  v_mfma_f32_16x16x32_bf16 v[64:67], v[20:23], v[132:135], v[64:67]
  ds_read_b64_tr_b16 v[34:35], v7 offset:512
  v_mfma_f32_16x16x32_bf16 v[80:83], v[16:19], v[136:139], v[80:83]
  ds_read_b64_tr_b16 v[36:37], v9 offset:8192
  v_mfma_f32_16x16x32_bf16 v[80:83], v[20:23], v[140:143], v[80:83]
  ds_read_b64_tr_b16 v[38:39], v7 offset:8704
  v_mfma_f32_16x16x32_bf16 v[96:99], v[16:19], v[144:147], v[96:99]
  s_add_u32 m0, s28, 98304
  s_add_u32 s30, s26, 2097152
  buffer_load_dwordx4 v49, s[40:43], s30 offen lds
  v_mfma_f32_16x16x32_bf16 v[96:99], v[20:23], v[148:151], v[96:99]
  s_add_u32 m0, s28, 106496
  s_add_u32 s30, s26, 2359296
  buffer_load_dwordx4 v49, s[40:43], s30 offen lds
  v_mfma_f32_16x16x32_bf16 v[112:115], v[16:19], v[152:155], v[112:115]
  s_add_u32 m0, s28, 65536
  s_add_u32 s30, s36, 512
  buffer_load_dwordx4 v51, s[4:7], s30 offen lds
  v_mfma_f32_16x16x32_bf16 v[112:115], v[20:23], v[156:159], v[112:115]
  s_waitcnt lgkmcnt(4)
  v_mfma_f32_16x16x32_bf16 v[68:71], v[24:27], v[128:131], v[68:71]
  ds_read_b64_tr_b16 v[40:41], v10 offset:0
  v_mfma_f32_16x16x32_bf16 v[68:71], v[28:31], v[132:135], v[68:71]
  ds_read_b64_tr_b16 v[42:43], v8 offset:512
  v_mfma_f32_16x16x32_bf16 v[84:87], v[24:27], v[136:139], v[84:87]
  ds_read_b64_tr_b16 v[44:45], v10 offset:8192
  v_mfma_f32_16x16x32_bf16 v[84:87], v[28:31], v[140:143], v[84:87]
  ds_read_b64_tr_b16 v[46:47], v8 offset:8704
  v_mfma_f32_16x16x32_bf16 v[100:103], v[24:27], v[144:147], v[100:103]
  s_add_u32 m0, s28, 73728
  s_add_u32 s30, s36, 74240
  buffer_load_dwordx4 v51, s[4:7], s30 offen lds
  v_mfma_f32_16x16x32_bf16 v[100:103], v[28:31], v[148:151], v[100:103]
  s_add_u32 m0, s28, 81920
  s_add_u32 s30, s37, 512
  buffer_load_dwordx4 v51, s[4:7], s30 offen lds
  v_mfma_f32_16x16x32_bf16 v[116:119], v[24:27], v[152:155], v[116:119]
  s_add_u32 m0, s28, 90112
  s_add_u32 s30, s37, 74240
  buffer_load_dwordx4 v51, s[4:7], s30 offen lds
  v_mfma_f32_16x16x32_bf16 v[116:119], v[28:31], v[156:159], v[116:119]
  s_waitcnt lgkmcnt(4)
  v_mfma_f32_16x16x32_bf16 v[72:75], v[32:35], v[128:131], v[72:75]
  v_add_u32 v52, 4294868992, v52
  v_add_u32 v53, 4294868992, v53
  v_mfma_f32_16x16x32_bf16 v[72:75], v[36:39], v[132:135], v[72:75]
  v_add_u32 v7, 4294868992, v7
  v_add_u32 v8, 4294868992, v8
  v_mfma_f32_16x16x32_bf16 v[88:91], v[32:35], v[136:139], v[88:91]
  v_add_u32 v9, 4294868992, v9
  v_add_u32 v10, 4294868992, v10
  v_mfma_f32_16x16x32_bf16 v[88:91], v[36:39], v[140:143], v[88:91]
  s_waitcnt lgkmcnt(0)
  s_waitcnt vmcnt(7)
  s_barrier
  s_waitcnt vmcnt(0)
  v_mfma_f32_16x16x32_bf16 v[104:107], v[32:35], v[144:147], v[104:107]
  ds_read_b128 v[160:163], v52 offset:0
  ds_read_b128 v[164:167], v53 offset:0
  v_mfma_f32_16x16x32_bf16 v[104:107], v[36:39], v[148:151], v[104:107]
  ds_read_b128 v[168:171], v52 offset:2048
  ds_read_b128 v[172:175], v53 offset:2048
  v_mfma_f32_16x16x32_bf16 v[120:123], v[32:35], v[152:155], v[120:123]
  ds_read_b128 v[176:179], v52 offset:16384
  ds_read_b128 v[180:183], v53 offset:16384
  v_mfma_f32_16x16x32_bf16 v[120:123], v[36:39], v[156:159], v[120:123]
  ds_read_b128 v[184:187], v52 offset:18432
  ds_read_b128 v[188:191], v53 offset:18432
  v_mfma_f32_16x16x32_bf16 v[76:79], v[40:43], v[128:131], v[76:79]
  ds_read_b64_tr_b16 v[16:17], v7 offset:0
  ds_read_b64_tr_b16 v[18:19], v9 offset:512
  v_mfma_f32_16x16x32_bf16 v[76:79], v[44:47], v[132:135], v[76:79]
  ds_read_b64_tr_b16 v[20:21], v7 offset:8192
  ds_read_b64_tr_b16 v[22:23], v9 offset:8704
  v_mfma_f32_16x16x32_bf16 v[92:95], v[40:43], v[136:139], v[92:95]
  v_mfma_f32_16x16x32_bf16 v[92:95], v[44:47], v[140:143], v[92:95]
  s_waitcnt lgkmcnt(8)
  v_mfma_f32_16x16x32_bf16 v[108:111], v[40:43], v[144:147], v[108:111]
  ds_read_b64_tr_b16 v[24:25], v8 offset:0
  v_mfma_f32_16x16x32_bf16 v[108:111], v[44:47], v[148:151], v[108:111]
  ds_read_b64_tr_b16 v[26:27], v10 offset:512
  v_mfma_f32_16x16x32_bf16 v[124:127], v[40:43], v[152:155], v[124:127]
  ds_read_b64_tr_b16 v[28:29], v8 offset:8192
  v_mfma_f32_16x16x32_bf16 v[124:127], v[44:47], v[156:159], v[124:127]
  ds_read_b64_tr_b16 v[30:31], v10 offset:8704
  s_waitcnt lgkmcnt(4)
  v_mfma_f32_16x16x32_bf16 v[64:67], v[16:19], v[160:163], v[64:67]
  ds_read_b64_tr_b16 v[32:33], v9 offset:0
  v_mfma_f32_16x16x32_bf16 v[64:67], v[20:23], v[164:167], v[64:67]
  ds_read_b64_tr_b16 v[34:35], v7 offset:512
  v_mfma_f32_16x16x32_bf16 v[80:83], v[16:19], v[168:171], v[80:83]
  ds_read_b64_tr_b16 v[36:37], v9 offset:8192
  v_mfma_f32_16x16x32_bf16 v[80:83], v[20:23], v[172:175], v[80:83]
  ds_read_b64_tr_b16 v[38:39], v7 offset:8704
  v_mfma_f32_16x16x32_bf16 v[96:99], v[16:19], v[176:179], v[96:99]
  s_add_u32 m0, s28, 147456
  s_add_u32 s30, s26, 2621440
  buffer_load_dwordx4 v49, s[40:43], s30 offen lds
  v_mfma_f32_16x16x32_bf16 v[96:99], v[20:23], v[180:183], v[96:99]
  s_add_u32 m0, s28, 155648
  s_add_u32 s30, s26, 2883584
  buffer_load_dwordx4 v49, s[40:43], s30 offen lds
  v_mfma_f32_16x16x32_bf16 v[112:115], v[16:19], v[184:187], v[112:115]
  s_add_u32 m0, s28, 114688
  s_add_u32 s30, s36, 640
  buffer_load_dwordx4 v51, s[4:7], s30 offen lds
  v_mfma_f32_16x16x32_bf16 v[112:115], v[20:23], v[188:191], v[112:115]
  s_waitcnt lgkmcnt(4)
  v_mfma_f32_16x16x32_bf16 v[68:71], v[24:27], v[160:163], v[68:71]
  ds_read_b64_tr_b16 v[40:41], v10 offset:0
  v_mfma_f32_16x16x32_bf16 v[68:71], v[28:31], v[164:167], v[68:71]
  ds_read_b64_tr_b16 v[42:43], v8 offset:512
  v_mfma_f32_16x16x32_bf16 v[84:87], v[24:27], v[168:171], v[84:87]
  ds_read_b64_tr_b16 v[44:45], v10 offset:8192
  v_mfma_f32_16x16x32_bf16 v[84:87], v[28:31], v[172:175], v[84:87]
  ds_read_b64_tr_b16 v[46:47], v8 offset:8704
  v_mfma_f32_16x16x32_bf16 v[100:103], v[24:27], v[176:179], v[100:103]
  s_add_u32 m0, s28, 122880
  s_add_u32 s30, s36, 74368
  buffer_load_dwordx4 v51, s[4:7], s30 offen lds
  v_mfma_f32_16x16x32_bf16 v[100:103], v[28:31], v[180:183], v[100:103]
  s_add_u32 m0, s28, 131072
  s_add_u32 s30, s37, 640
  buffer_load_dwordx4 v51, s[4:7], s30 offen lds
  v_mfma_f32_16x16x32_bf16 v[116:119], v[24:27], v[184:187], v[116:119]
  s_add_u32 m0, s28, 139264
  s_add_u32 s30, s37, 74368
  buffer_load_dwordx4 v51, s[4:7], s30 offen lds
  v_mfma_f32_16x16x32_bf16 v[116:119], v[28:31], v[188:191], v[116:119]
  s_waitcnt lgkmcnt(4)
  v_mfma_f32_16x16x32_bf16 v[72:75], v[32:35], v[160:163], v[72:75]
  v_add_u32 v52, 49152, v52
  v_add_u32 v53, 49152, v53
  v_mfma_f32_16x16x32_bf16 v[72:75], v[36:39], v[164:167], v[72:75]
  v_add_u32 v7, 49152, v7
  v_add_u32 v8, 49152, v8
  v_mfma_f32_16x16x32_bf16 v[88:91], v[32:35], v[168:171], v[88:91]
  v_add_u32 v9, 49152, v9
  v_add_u32 v10, 49152, v10
  v_mfma_f32_16x16x32_bf16 v[88:91], v[36:39], v[172:175], v[88:91]
  s_waitcnt lgkmcnt(0)
  s_waitcnt vmcnt(6)
  s_barrier
  s_cmp_lg_u32 s20, 2
  s_cbranch_scc1 L_o15_front_kernel
  v_mov_b32 v61, 1
  s_mov_b64 exec, 1
  buffer_atomic_add v61, v58, s[4:7], s98 offen sc1
  s_mov_b64 exec, -1
L_o15_front_kernel:
  v_mfma_f32_16x16x32_bf16 v[104:107], v[32:35], v[176:179], v[104:107]
  ds_read_b128 v[128:131], v52 offset:0
  ds_read_b128 v[132:135], v53 offset:0
  v_mfma_f32_16x16x32_bf16 v[104:107], v[36:39], v[180:183], v[104:107]
  ds_read_b128 v[136:139], v52 offset:2048
  ds_read_b128 v[140:143], v53 offset:2048
  v_mfma_f32_16x16x32_bf16 v[120:123], v[32:35], v[184:187], v[120:123]
  ds_read_b128 v[144:147], v52 offset:16384
  ds_read_b128 v[148:151], v53 offset:16384
  v_mfma_f32_16x16x32_bf16 v[120:123], v[36:39], v[188:191], v[120:123]
  ds_read_b128 v[152:155], v52 offset:18432
  ds_read_b128 v[156:159], v53 offset:18432
  v_mfma_f32_16x16x32_bf16 v[76:79], v[40:43], v[160:163], v[76:79]
  ds_read_b64_tr_b16 v[16:17], v7 offset:0
  ds_read_b64_tr_b16 v[18:19], v9 offset:512
  v_mfma_f32_16x16x32_bf16 v[76:79], v[44:47], v[164:167], v[76:79]
  ds_read_b64_tr_b16 v[20:21], v7 offset:8192
  ds_read_b64_tr_b16 v[22:23], v9 offset:8704
  v_mfma_f32_16x16x32_bf16 v[92:95], v[40:43], v[168:171], v[92:95]
  v_mfma_f32_16x16x32_bf16 v[92:95], v[44:47], v[172:175], v[92:95]
  s_waitcnt lgkmcnt(8)
  v_mfma_f32_16x16x32_bf16 v[108:111], v[40:43], v[176:179], v[108:111]
  ds_read_b64_tr_b16 v[24:25], v8 offset:0
  v_mfma_f32_16x16x32_bf16 v[108:111], v[44:47], v[180:183], v[108:111]
  ds_read_b64_tr_b16 v[26:27], v10 offset:512
  v_mfma_f32_16x16x32_bf16 v[124:127], v[40:43], v[184:187], v[124:127]
  ds_read_b64_tr_b16 v[28:29], v8 offset:8192
  v_mfma_f32_16x16x32_bf16 v[124:127], v[44:47], v[188:191], v[124:127]
  ds_read_b64_tr_b16 v[30:31], v10 offset:8704
  s_waitcnt lgkmcnt(4)
  v_mfma_f32_16x16x32_bf16 v[64:67], v[16:19], v[128:131], v[64:67]
  ds_read_b64_tr_b16 v[32:33], v9 offset:0
  v_mfma_f32_16x16x32_bf16 v[64:67], v[20:23], v[132:135], v[64:67]
  ds_read_b64_tr_b16 v[34:35], v7 offset:512
  v_mfma_f32_16x16x32_bf16 v[80:83], v[16:19], v[136:139], v[80:83]
  ds_read_b64_tr_b16 v[36:37], v9 offset:8192
  v_mfma_f32_16x16x32_bf16 v[80:83], v[20:23], v[140:143], v[80:83]
  ds_read_b64_tr_b16 v[38:39], v7 offset:8704
  v_mfma_f32_16x16x32_bf16 v[96:99], v[16:19], v[144:147], v[96:99]
  s_add_u32 m0, s28, 49152
  s_add_u32 s30, s26, 3145728
  buffer_load_dwordx4 v49, s[40:43], s30 offen lds
  v_mfma_f32_16x16x32_bf16 v[96:99], v[20:23], v[148:151], v[96:99]
  s_add_u32 m0, s28, 57344
  s_add_u32 s30, s26, 3407872
  buffer_load_dwordx4 v49, s[40:43], s30 offen lds
  v_mfma_f32_16x16x32_bf16 v[112:115], v[16:19], v[152:155], v[112:115]
  s_add_u32 m0, s28, 16384
  s_add_u32 s30, s36, 768
  buffer_load_dwordx4 v51, s[4:7], s30 offen lds
  v_mfma_f32_16x16x32_bf16 v[112:115], v[20:23], v[156:159], v[112:115]
  s_waitcnt lgkmcnt(4)
  v_mfma_f32_16x16x32_bf16 v[68:71], v[24:27], v[128:131], v[68:71]
  ds_read_b64_tr_b16 v[40:41], v10 offset:0
  v_mfma_f32_16x16x32_bf16 v[68:71], v[28:31], v[132:135], v[68:71]
  ds_read_b64_tr_b16 v[42:43], v8 offset:512
  v_mfma_f32_16x16x32_bf16 v[84:87], v[24:27], v[136:139], v[84:87]
  ds_read_b64_tr_b16 v[44:45], v10 offset:8192
  v_mfma_f32_16x16x32_bf16 v[84:87], v[28:31], v[140:143], v[84:87]
  ds_read_b64_tr_b16 v[46:47], v8 offset:8704
  v_mfma_f32_16x16x32_bf16 v[100:103], v[24:27], v[144:147], v[100:103]
  s_add_u32 m0, s28, 24576
  s_add_u32 s30, s36, 74496
  buffer_load_dwordx4 v51, s[4:7], s30 offen lds
  v_mfma_f32_16x16x32_bf16 v[100:103], v[28:31], v[148:151], v[100:103]
  s_add_u32 m0, s28, 32768
  s_add_u32 s30, s37, 768
  buffer_load_dwordx4 v51, s[4:7], s30 offen lds
  v_mfma_f32_16x16x32_bf16 v[116:119], v[24:27], v[152:155], v[116:119]
  s_add_u32 m0, s28, 40960
  s_add_u32 s30, s37, 74496
  buffer_load_dwordx4 v51, s[4:7], s30 offen lds
  v_mfma_f32_16x16x32_bf16 v[116:119], v[28:31], v[156:159], v[116:119]
  s_waitcnt lgkmcnt(4)
  v_mfma_f32_16x16x32_bf16 v[72:75], v[32:35], v[128:131], v[72:75]
  v_add_u32 v52, 49152, v52
  v_add_u32 v53, 49152, v53
  v_mfma_f32_16x16x32_bf16 v[72:75], v[36:39], v[132:135], v[72:75]
  v_add_u32 v7, 49152, v7
  v_add_u32 v8, 49152, v8
  v_mfma_f32_16x16x32_bf16 v[88:91], v[32:35], v[136:139], v[88:91]
  v_add_u32 v9, 49152, v9
  v_add_u32 v10, 49152, v10
  v_mfma_f32_16x16x32_bf16 v[88:91], v[36:39], v[140:143], v[88:91]
  s_waitcnt lgkmcnt(0)
  s_waitcnt vmcnt(6)
  s_barrier
  v_mfma_f32_16x16x32_bf16 v[104:107], v[32:35], v[144:147], v[104:107]
  ds_read_b128 v[160:163], v52 offset:0
  ds_read_b128 v[164:167], v53 offset:0
  v_mfma_f32_16x16x32_bf16 v[104:107], v[36:39], v[148:151], v[104:107]
  ds_read_b128 v[168:171], v52 offset:2048
  ds_read_b128 v[172:175], v53 offset:2048
  v_mfma_f32_16x16x32_bf16 v[120:123], v[32:35], v[152:155], v[120:123]
  ds_read_b128 v[176:179], v52 offset:16384
  ds_read_b128 v[180:183], v53 offset:16384
  v_mfma_f32_16x16x32_bf16 v[120:123], v[36:39], v[156:159], v[120:123]
  ds_read_b128 v[184:187], v52 offset:18432
  ds_read_b128 v[188:191], v53 offset:18432
  v_mfma_f32_16x16x32_bf16 v[76:79], v[40:43], v[128:131], v[76:79]
  ds_read_b64_tr_b16 v[16:17], v7 offset:0
  ds_read_b64_tr_b16 v[18:19], v9 offset:512
  v_mfma_f32_16x16x32_bf16 v[76:79], v[44:47], v[132:135], v[76:79]
  ds_read_b64_tr_b16 v[20:21], v7 offset:8192
  ds_read_b64_tr_b16 v[22:23], v9 offset:8704
  v_mfma_f32_16x16x32_bf16 v[92:95], v[40:43], v[136:139], v[92:95]
  v_mfma_f32_16x16x32_bf16 v[92:95], v[44:47], v[140:143], v[92:95]
  s_waitcnt lgkmcnt(8)
  v_mfma_f32_16x16x32_bf16 v[108:111], v[40:43], v[144:147], v[108:111]
  ds_read_b64_tr_b16 v[24:25], v8 offset:0
  v_mfma_f32_16x16x32_bf16 v[108:111], v[44:47], v[148:151], v[108:111]
  ds_read_b64_tr_b16 v[26:27], v10 offset:512
  v_mfma_f32_16x16x32_bf16 v[124:127], v[40:43], v[152:155], v[124:127]
  ds_read_b64_tr_b16 v[28:29], v8 offset:8192
  v_mfma_f32_16x16x32_bf16 v[124:127], v[44:47], v[156:159], v[124:127]
  ds_read_b64_tr_b16 v[30:31], v10 offset:8704
  s_waitcnt lgkmcnt(4)
  v_mfma_f32_16x16x32_bf16 v[64:67], v[16:19], v[160:163], v[64:67]
  ds_read_b64_tr_b16 v[32:33], v9 offset:0
  v_mfma_f32_16x16x32_bf16 v[64:67], v[20:23], v[164:167], v[64:67]
  ds_read_b64_tr_b16 v[34:35], v7 offset:512
  v_mfma_f32_16x16x32_bf16 v[80:83], v[16:19], v[168:171], v[80:83]
  ds_read_b64_tr_b16 v[36:37], v9 offset:8192
  v_mfma_f32_16x16x32_bf16 v[80:83], v[20:23], v[172:175], v[80:83]
  ds_read_b64_tr_b16 v[38:39], v7 offset:8704
  v_mfma_f32_16x16x32_bf16 v[96:99], v[16:19], v[176:179], v[96:99]
  s_add_u32 m0, s28, 98304
  s_add_u32 s30, s26, 3670016
  buffer_load_dwordx4 v49, s[40:43], s30 offen lds
  v_mfma_f32_16x16x32_bf16 v[96:99], v[20:23], v[180:183], v[96:99]
  s_add_u32 m0, s28, 106496
  s_add_u32 s30, s26, 3932160
  buffer_load_dwordx4 v49, s[40:43], s30 offen lds
  v_mfma_f32_16x16x32_bf16 v[112:115], v[16:19], v[184:187], v[112:115]
  s_add_u32 m0, s28, 65536
  s_add_u32 s30, s36, 896
  buffer_load_dwordx4 v51, s[4:7], s30 offen lds
  v_mfma_f32_16x16x32_bf16 v[112:115], v[20:23], v[188:191], v[112:115]
  s_waitcnt lgkmcnt(4)
  v_mfma_f32_16x16x32_bf16 v[68:71], v[24:27], v[160:163], v[68:71]
  ds_read_b64_tr_b16 v[40:41], v10 offset:0
  v_mfma_f32_16x16x32_bf16 v[68:71], v[28:31], v[164:167], v[68:71]
  ds_read_b64_tr_b16 v[42:43], v8 offset:512
  v_mfma_f32_16x16x32_bf16 v[84:87], v[24:27], v[168:171], v[84:87]
  ds_read_b64_tr_b16 v[44:45], v10 offset:8192
  v_mfma_f32_16x16x32_bf16 v[84:87], v[28:31], v[172:175], v[84:87]
  ds_read_b64_tr_b16 v[46:47], v8 offset:8704
  v_mfma_f32_16x16x32_bf16 v[100:103], v[24:27], v[176:179], v[100:103]
  s_add_u32 m0, s28, 73728
  s_add_u32 s30, s36, 74624
  buffer_load_dwordx4 v51, s[4:7], s30 offen lds
  v_mfma_f32_16x16x32_bf16 v[100:103], v[28:31], v[180:183], v[100:103]
  s_add_u32 m0, s28, 81920
  s_add_u32 s30, s37, 896
  buffer_load_dwordx4 v51, s[4:7], s30 offen lds
  v_mfma_f32_16x16x32_bf16 v[116:119], v[24:27], v[184:187], v[116:119]
  s_add_u32 m0, s28, 90112
  s_add_u32 s30, s37, 74624
  buffer_load_dwordx4 v51, s[4:7], s30 offen lds
  v_mfma_f32_16x16x32_bf16 v[116:119], v[28:31], v[188:191], v[116:119]
  s_waitcnt lgkmcnt(4)
  v_mfma_f32_16x16x32_bf16 v[72:75], v[32:35], v[160:163], v[72:75]
  v_add_u32 v52, 4294868992, v52
  v_add_u32 v53, 4294868992, v53
  v_mfma_f32_16x16x32_bf16 v[72:75], v[36:39], v[164:167], v[72:75]
  v_add_u32 v7, 4294868992, v7
  v_add_u32 v8, 4294868992, v8
  v_mfma_f32_16x16x32_bf16 v[88:91], v[32:35], v[168:171], v[88:91]
  v_add_u32 v9, 4294868992, v9
  v_add_u32 v10, 4294868992, v10
  v_mfma_f32_16x16x32_bf16 v[88:91], v[36:39], v[172:175], v[88:91]
  s_waitcnt lgkmcnt(0)
  s_waitcnt vmcnt(6)
  s_barrier
  s_cmp_lg_u32 s20, 6
  s_cbranch_scc1 L_o16_front_kernel
  buffer_load_dword v60, v58, s[4:7], s98 offen sc1
L_o16_front_kernel:
  v_mfma_f32_16x16x32_bf16 v[104:107], v[32:35], v[176:179], v[104:107]
  ds_read_b128 v[128:131], v52 offset:0
  ds_read_b128 v[132:135], v53 offset:0
  v_mfma_f32_16x16x32_bf16 v[104:107], v[36:39], v[180:183], v[104:107]
  ds_read_b128 v[136:139], v52 offset:2048
  ds_read_b128 v[140:143], v53 offset:2048
  v_mfma_f32_16x16x32_bf16 v[120:123], v[32:35], v[184:187], v[120:123]
  ds_read_b128 v[144:147], v52 offset:16384
  ds_read_b128 v[148:151], v53 offset:16384
  v_mfma_f32_16x16x32_bf16 v[120:123], v[36:39], v[188:191], v[120:123]
  ds_read_b128 v[152:155], v52 offset:18432
  ds_read_b128 v[156:159], v53 offset:18432
  v_mfma_f32_16x16x32_bf16 v[76:79], v[40:43], v[160:163], v[76:79]
  ds_read_b64_tr_b16 v[16:17], v7 offset:0
  ds_read_b64_tr_b16 v[18:19], v9 offset:512
  v_mfma_f32_16x16x32_bf16 v[76:79], v[44:47], v[164:167], v[76:79]
  ds_read_b64_tr_b16 v[20:21], v7 offset:8192
  ds_read_b64_tr_b16 v[22:23], v9 offset:8704
  v_mfma_f32_16x16x32_bf16 v[92:95], v[40:43], v[168:171], v[92:95]
  v_mfma_f32_16x16x32_bf16 v[92:95], v[44:47], v[172:175], v[92:95]
  s_waitcnt lgkmcnt(8)
  v_mfma_f32_16x16x32_bf16 v[108:111], v[40:43], v[176:179], v[108:111]
  ds_read_b64_tr_b16 v[24:25], v8 offset:0
  v_mfma_f32_16x16x32_bf16 v[108:111], v[44:47], v[180:183], v[108:111]
  ds_read_b64_tr_b16 v[26:27], v10 offset:512
  v_mfma_f32_16x16x32_bf16 v[124:127], v[40:43], v[184:187], v[124:127]
  ds_read_b64_tr_b16 v[28:29], v8 offset:8192
  v_mfma_f32_16x16x32_bf16 v[124:127], v[44:47], v[188:191], v[124:127]
  ds_read_b64_tr_b16 v[30:31], v10 offset:8704
  s_waitcnt lgkmcnt(4)
  v_mfma_f32_16x16x32_bf16 v[64:67], v[16:19], v[128:131], v[64:67]
  ds_read_b64_tr_b16 v[32:33], v9 offset:0
  v_mfma_f32_16x16x32_bf16 v[64:67], v[20:23], v[132:135], v[64:67]
  ds_read_b64_tr_b16 v[34:35], v7 offset:512
  v_mfma_f32_16x16x32_bf16 v[80:83], v[16:19], v[136:139], v[80:83]
  ds_read_b64_tr_b16 v[36:37], v9 offset:8192
  v_mfma_f32_16x16x32_bf16 v[80:83], v[20:23], v[140:143], v[80:83]
  ds_read_b64_tr_b16 v[38:39], v7 offset:8704
  v_mfma_f32_16x16x32_bf16 v[96:99], v[16:19], v[144:147], v[96:99]
  s_add_u32 m0, s28, 147456
  s_add_u32 s30, s26, 4194304
  buffer_load_dwordx4 v49, s[40:43], s30 offen lds
  v_mfma_f32_16x16x32_bf16 v[96:99], v[20:23], v[148:151], v[96:99]
  s_add_u32 m0, s28, 155648
  s_add_u32 s30, s26, 4456448
  buffer_load_dwordx4 v49, s[40:43], s30 offen lds
  v_mfma_f32_16x16x32_bf16 v[112:115], v[16:19], v[152:155], v[112:115]
  s_add_u32 m0, s28, 114688
  s_add_u32 s30, s36, 1024
  buffer_load_dwordx4 v51, s[4:7], s30 offen lds
  v_mfma_f32_16x16x32_bf16 v[112:115], v[20:23], v[156:159], v[112:115]
  s_waitcnt lgkmcnt(4)
  v_mfma_f32_16x16x32_bf16 v[68:71], v[24:27], v[128:131], v[68:71]
  ds_read_b64_tr_b16 v[40:41], v10 offset:0
  v_mfma_f32_16x16x32_bf16 v[68:71], v[28:31], v[132:135], v[68:71]
  ds_read_b64_tr_b16 v[42:43], v8 offset:512
  v_mfma_f32_16x16x32_bf16 v[84:87], v[24:27], v[136:139], v[84:87]
  ds_read_b64_tr_b16 v[44:45], v10 offset:8192
  v_mfma_f32_16x16x32_bf16 v[84:87], v[28:31], v[140:143], v[84:87]
  ds_read_b64_tr_b16 v[46:47], v8 offset:8704
  v_mfma_f32_16x16x32_bf16 v[100:103], v[24:27], v[144:147], v[100:103]
  s_add_u32 m0, s28, 122880
  s_add_u32 s30, s36, 74752
  buffer_load_dwordx4 v51, s[4:7], s30 offen lds
  v_mfma_f32_16x16x32_bf16 v[100:103], v[28:31], v[148:151], v[100:103]
  s_add_u32 m0, s28, 131072
  s_add_u32 s30, s37, 1024
  buffer_load_dwordx4 v51, s[4:7], s30 offen lds
  v_mfma_f32_16x16x32_bf16 v[116:119], v[24:27], v[152:155], v[116:119]
  s_add_u32 m0, s28, 139264
  s_add_u32 s30, s37, 74752
  buffer_load_dwordx4 v51, s[4:7], s30 offen lds
  v_mfma_f32_16x16x32_bf16 v[116:119], v[28:31], v[156:159], v[116:119]
  s_waitcnt lgkmcnt(4)
  v_mfma_f32_16x16x32_bf16 v[72:75], v[32:35], v[128:131], v[72:75]
  v_add_u32 v52, 49152, v52
  v_add_u32 v53, 49152, v53
  v_mfma_f32_16x16x32_bf16 v[72:75], v[36:39], v[132:135], v[72:75]
  v_add_u32 v7, 49152, v7
  v_add_u32 v8, 49152, v8
  v_mfma_f32_16x16x32_bf16 v[88:91], v[32:35], v[136:139], v[88:91]
  v_add_u32 v9, 49152, v9
  v_add_u32 v10, 49152, v10
  v_mfma_f32_16x16x32_bf16 v[88:91], v[36:39], v[140:143], v[88:91]
  s_waitcnt lgkmcnt(0)
  s_waitcnt vmcnt(6)
  s_barrier
  v_mfma_f32_16x16x32_bf16 v[104:107], v[32:35], v[144:147], v[104:107]
  ds_read_b128 v[160:163], v52 offset:0
  ds_read_b128 v[164:167], v53 offset:0
  v_mfma_f32_16x16x32_bf16 v[104:107], v[36:39], v[148:151], v[104:107]
  ds_read_b128 v[168:171], v52 offset:2048
  ds_read_b128 v[172:175], v53 offset:2048
  v_mfma_f32_16x16x32_bf16 v[120:123], v[32:35], v[152:155], v[120:123]
  ds_read_b128 v[176:179], v52 offset:16384
  ds_read_b128 v[180:183], v53 offset:16384
  v_mfma_f32_16x16x32_bf16 v[120:123], v[36:39], v[156:159], v[120:123]
  ds_read_b128 v[184:187], v52 offset:18432
  ds_read_b128 v[188:191], v53 offset:18432
  v_mfma_f32_16x16x32_bf16 v[76:79], v[40:43], v[128:131], v[76:79]
  ds_read_b64_tr_b16 v[16:17], v7 offset:0
  ds_read_b64_tr_b16 v[18:19], v9 offset:512
  v_mfma_f32_16x16x32_bf16 v[76:79], v[44:47], v[132:135], v[76:79]
  ds_read_b64_tr_b16 v[20:21], v7 offset:8192
  ds_read_b64_tr_b16 v[22:23], v9 offset:8704
  v_mfma_f32_16x16x32_bf16 v[92:95], v[40:43], v[136:139], v[92:95]
  v_mfma_f32_16x16x32_bf16 v[92:95], v[44:47], v[140:143], v[92:95]
  s_waitcnt lgkmcnt(8)
  v_mfma_f32_16x16x32_bf16 v[108:111], v[40:43], v[144:147], v[108:111]
  ds_read_b64_tr_b16 v[24:25], v8 offset:0
  v_mfma_f32_16x16x32_bf16 v[108:111], v[44:47], v[148:151], v[108:111]
  ds_read_b64_tr_b16 v[26:27], v10 offset:512
  v_mfma_f32_16x16x32_bf16 v[124:127], v[40:43], v[152:155], v[124:127]
  ds_read_b64_tr_b16 v[28:29], v8 offset:8192
  v_mfma_f32_16x16x32_bf16 v[124:127], v[44:47], v[156:159], v[124:127]
  ds_read_b64_tr_b16 v[30:31], v10 offset:8704
  s_waitcnt lgkmcnt(4)
  v_mfma_f32_16x16x32_bf16 v[64:67], v[16:19], v[160:163], v[64:67]
  ds_read_b64_tr_b16 v[32:33], v9 offset:0
  v_mfma_f32_16x16x32_bf16 v[64:67], v[20:23], v[164:167], v[64:67]
  ds_read_b64_tr_b16 v[34:35], v7 offset:512
  v_mfma_f32_16x16x32_bf16 v[80:83], v[16:19], v[168:171], v[80:83]
  ds_read_b64_tr_b16 v[36:37], v9 offset:8192
  v_mfma_f32_16x16x32_bf16 v[80:83], v[20:23], v[172:175], v[80:83]
  ds_read_b64_tr_b16 v[38:39], v7 offset:8704
  v_mfma_f32_16x16x32_bf16 v[96:99], v[16:19], v[176:179], v[96:99]
  v_mfma_f32_16x16x32_bf16 v[96:99], v[20:23], v[180:183], v[96:99]
  v_mfma_f32_16x16x32_bf16 v[112:115], v[16:19], v[184:187], v[112:115]
  v_mfma_f32_16x16x32_bf16 v[112:115], v[20:23], v[188:191], v[112:115]
  s_waitcnt lgkmcnt(4)
  v_mfma_f32_16x16x32_bf16 v[68:71], v[24:27], v[160:163], v[68:71]
  ds_read_b64_tr_b16 v[40:41], v10 offset:0
  v_mfma_f32_16x16x32_bf16 v[68:71], v[28:31], v[164:167], v[68:71]
  ds_read_b64_tr_b16 v[42:43], v8 offset:512
  v_mfma_f32_16x16x32_bf16 v[84:87], v[24:27], v[168:171], v[84:87]
  ds_read_b64_tr_b16 v[44:45], v10 offset:8192
  v_mfma_f32_16x16x32_bf16 v[84:87], v[28:31], v[172:175], v[84:87]
  ds_read_b64_tr_b16 v[46:47], v8 offset:8704
  v_mfma_f32_16x16x32_bf16 v[100:103], v[24:27], v[176:179], v[100:103]
  v_mfma_f32_16x16x32_bf16 v[100:103], v[28:31], v[180:183], v[100:103]
  v_mfma_f32_16x16x32_bf16 v[116:119], v[24:27], v[184:187], v[116:119]
  v_mfma_f32_16x16x32_bf16 v[116:119], v[28:31], v[188:191], v[116:119]
  s_waitcnt lgkmcnt(4)
  v_mfma_f32_16x16x32_bf16 v[72:75], v[32:35], v[160:163], v[72:75]
  v_add_u32 v52, 49152, v52
  v_add_u32 v53, 49152, v53
  v_mfma_f32_16x16x32_bf16 v[72:75], v[36:39], v[164:167], v[72:75]
  v_add_u32 v7, 49152, v7
  v_add_u32 v8, 49152, v8
  v_mfma_f32_16x16x32_bf16 v[88:91], v[32:35], v[168:171], v[88:91]
  v_add_u32 v9, 49152, v9
  v_add_u32 v10, 49152, v10
  v_mfma_f32_16x16x32_bf16 v[88:91], v[36:39], v[172:175], v[88:91]
  s_waitcnt lgkmcnt(0)
  s_cmp_lg_u32 s20, 6
  s_cbranch_scc1 L_o17_front_kernel
  s_waitcnt vmcnt(6)
L_chkk_front_kernel:
  v_readfirstlane_b32 s30, v60
  s_nop 0
  s_and_b32 s30, s30, 0xff
  s_cmp_ge_u32 s30, 8
  s_cbranch_scc0 L_spink_front_kernel
  s_branch L_okk_front_kernel
L_spink_front_kernel:
  s_add_u32 s100, s100, 1
  s_cmp_gt_u32 s100, 0x20000
  s_cbranch_scc1 L_end_front_kernel
  s_sleep 2
  buffer_load_dword v60, v58, s[4:7], s98 offen sc1
  s_waitcnt vmcnt(0)
  s_branch L_chkk_front_kernel
L_okk_front_kernel:
L_o17_front_kernel:
  s_waitcnt vmcnt(0)
  s_barrier
  v_mfma_f32_16x16x32_bf16 v[104:107], v[32:35], v[176:179], v[104:107]
  ds_read_b128 v[128:131], v52 offset:0
  ds_read_b128 v[132:135], v53 offset:0
  v_mfma_f32_16x16x32_bf16 v[104:107], v[36:39], v[180:183], v[104:107]
  ds_read_b128 v[136:139], v52 offset:2048
  ds_read_b128 v[140:143], v53 offset:2048
  v_mfma_f32_16x16x32_bf16 v[120:123], v[32:35], v[184:187], v[120:123]
  ds_read_b128 v[144:147], v52 offset:16384
  ds_read_b128 v[148:151], v53 offset:16384
  v_mfma_f32_16x16x32_bf16 v[120:123], v[36:39], v[188:191], v[120:123]
  ds_read_b128 v[152:155], v52 offset:18432
  ds_read_b128 v[156:159], v53 offset:18432
  v_mfma_f32_16x16x32_bf16 v[76:79], v[40:43], v[160:163], v[76:79]
  ds_read_b64_tr_b16 v[16:17], v7 offset:0
  ds_read_b64_tr_b16 v[18:19], v9 offset:512
  v_mfma_f32_16x16x32_bf16 v[76:79], v[44:47], v[164:167], v[76:79]
  ds_read_b64_tr_b16 v[20:21], v7 offset:8192
  ds_read_b64_tr_b16 v[22:23], v9 offset:8704
  v_mfma_f32_16x16x32_bf16 v[92:95], v[40:43], v[168:171], v[92:95]
  v_mfma_f32_16x16x32_bf16 v[92:95], v[44:47], v[172:175], v[92:95]
  s_waitcnt lgkmcnt(8)
  v_mfma_f32_16x16x32_bf16 v[108:111], v[40:43], v[176:179], v[108:111]
  ds_read_b64_tr_b16 v[24:25], v8 offset:0
  v_mfma_f32_16x16x32_bf16 v[108:111], v[44:47], v[180:183], v[108:111]
  ds_read_b64_tr_b16 v[26:27], v10 offset:512
  v_mfma_f32_16x16x32_bf16 v[124:127], v[40:43], v[184:187], v[124:127]
  ds_read_b64_tr_b16 v[28:29], v8 offset:8192
  v_mfma_f32_16x16x32_bf16 v[124:127], v[44:47], v[188:191], v[124:127]
  ds_read_b64_tr_b16 v[30:31], v10 offset:8704
  s_waitcnt lgkmcnt(4)
  v_mfma_f32_16x16x32_bf16 v[64:67], v[16:19], v[128:131], v[64:67]
  ds_read_b64_tr_b16 v[32:33], v9 offset:0
  v_mfma_f32_16x16x32_bf16 v[64:67], v[20:23], v[132:135], v[64:67]
  ds_read_b64_tr_b16 v[34:35], v7 offset:512
  v_mfma_f32_16x16x32_bf16 v[80:83], v[16:19], v[136:139], v[80:83]
  ds_read_b64_tr_b16 v[36:37], v9 offset:8192
  v_mfma_f32_16x16x32_bf16 v[80:83], v[20:23], v[140:143], v[80:83]
  ds_read_b64_tr_b16 v[38:39], v7 offset:8704
  v_mfma_f32_16x16x32_bf16 v[96:99], v[16:19], v[144:147], v[96:99]
  v_mfma_f32_16x16x32_bf16 v[96:99], v[20:23], v[148:151], v[96:99]
  v_mfma_f32_16x16x32_bf16 v[112:115], v[16:19], v[152:155], v[112:115]
  v_mfma_f32_16x16x32_bf16 v[112:115], v[20:23], v[156:159], v[112:115]
  s_lshl_b32 s31, s20, 12
  s_mov_b32 m0, s31
  s_lshl_b32 s30, s23, 15
  s_add_u32 s30, s30, s24
  s_add_u32 s30, s30, 33554432
  buffer_load_dwordx4 v56, s[4:7], s30 offen offset:0 lds
  buffer_load_dwordx4 v56, s[4:7], s30 offen offset:1024 lds
  buffer_load_dwordx4 v56, s[4:7], s30 offen offset:2048 lds
  buffer_load_dwordx4 v56, s[4:7], s30 offen offset:3072 lds
  s_waitcnt lgkmcnt(4)
  v_mfma_f32_16x16x32_bf16 v[68:71], v[24:27], v[128:131], v[68:71]
  ds_read_b64_tr_b16 v[40:41], v10 offset:0
  v_mfma_f32_16x16x32_bf16 v[68:71], v[28:31], v[132:135], v[68:71]
  ds_read_b64_tr_b16 v[42:43], v8 offset:512
  v_mfma_f32_16x16x32_bf16 v[84:87], v[24:27], v[136:139], v[84:87]
  ds_read_b64_tr_b16 v[44:45], v10 offset:8192
  v_mfma_f32_16x16x32_bf16 v[84:87], v[28:31], v[140:143], v[84:87]
  ds_read_b64_tr_b16 v[46:47], v8 offset:8704
  v_mfma_f32_16x16x32_bf16 v[100:103], v[24:27], v[144:147], v[100:103]
  v_mfma_f32_16x16x32_bf16 v[100:103], v[28:31], v[148:151], v[100:103]
  v_mfma_f32_16x16x32_bf16 v[116:119], v[24:27], v[152:155], v[116:119]
  v_mfma_f32_16x16x32_bf16 v[116:119], v[28:31], v[156:159], v[116:119]
  s_lshl_b32 s31, s20, 12
  s_add_u32 m0, s31, 0x8000
  s_sub_u32 s30, s23, 1
  s_and_b32 s30, s30, 15
  s_lshl_b32 s30, s30, 15
  s_add_u32 s30, s30, s24
  s_add_u32 s30, s30, 33554432
  buffer_load_dwordx4 v56, s[4:7], s30 offen offset:0 lds
  buffer_load_dwordx4 v56, s[4:7], s30 offen offset:1024 lds
  buffer_load_dwordx4 v56, s[4:7], s30 offen offset:2048 lds
  buffer_load_dwordx4 v56, s[4:7], s30 offen offset:3072 lds
  s_lshl_b32 s31, s20, 12
  s_add_u32 m0, s31, 65536
  s_lshl_b32 s30, s23, 15
  s_add_u32 s30, s30, s24
  s_add_u32 s30, s30, 50331648
  buffer_load_dwordx4 v56, s[4:7], s30 offen offset:0 lds
  buffer_load_dwordx4 v56, s[4:7], s30 offen offset:1024 lds
  buffer_load_dwordx4 v56, s[4:7], s30 offen offset:2048 lds
  buffer_load_dwordx4 v56, s[4:7], s30 offen offset:3072 lds
  s_waitcnt lgkmcnt(4)
  v_mfma_f32_16x16x32_bf16 v[72:75], v[32:35], v[128:131], v[72:75]
  v_lshlrev_b32 v6, 4, v1
  s_lshl_b32 s38, s20, 12
  v_add_u32 v5, s38, v6
  s_mov_b32 s28, s38
  s_add_u32 s29, s38, 65536
  s_lshl_b32 s39, s22, 14
  v_mfma_f32_16x16x32_bf16 v[72:75], v[36:39], v[132:135], v[72:75]
  v_add_u32 v2, s39, v6
  s_lshl_b32 s38, s22, 11
  s_add_u32 s30, s38, 98304
  s_sub_u32 s31, 98304, s38
  v_add_u32 v3, s30, v2
  v_add_u32 v4, s31, v2
  v_mfma_f32_16x16x32_bf16 v[88:91], v[32:35], v[136:139], v[88:91]
  s_lshl_b32 s25, s23, 15
  s_add_u32 s25, s25, s24
  s_add_u32 s25, s25, 33554432
  s_mov_b32 s26, s23
  s_mov_b32 s96, s23
  s_mov_b32 s27, s101
  v_mfma_f32_16x16x32_bf16 v[88:91], v[36:39], v[140:143], v[88:91]
  s_mov_b32 s32, 0
  v_mov_b32 v14, 0xf149f2ca
  v_and_b32 v12, 31, v1
  v_lshrrev_b32 v13, 5, v1
  v_lshlrev_b32 v11, 2, v13
  v_sub_u32 v11, v12, v11
  v_mfma_f32_16x16x32_bf16 v[104:107], v[32:35], v[144:147], v[104:107]
  s_lshl_b32 s38, s21, 5
  s_lshl_b32 s39, s22, 6
  s_sub_u32 s38, s38, s39
  v_add_u32 v9, s38, v11
  s_ashr_i32 s97, s38, 5
  v_lshlrev_b32 v208, 7, v1
  v_mfma_f32_16x16x32_bf16 v[104:107], v[36:39], v[148:151], v[104:107]
  v_mov_b32 v11, 2130706432
  v_cmp_gt_u32 vcc, 5, v1
  s_lshl_b32 s38, s2, 3
  s_add_u32 s38, s38, s20
  v_cndmask_b32 v208, v11, v208, vcc
  s_mul_i32 s98, s38, 2304
  v_mfma_f32_16x16x32_bf16 v[120:123], v[32:35], v[152:155], v[120:123]
  s_mul_i32 s99, s38, 9216
  s_mul_i32 s38, s20, 640
  s_mul_i32 s98, s2, 18432
  s_mul_i32 s99, s2, 73728
  s_add_u32 s42, s98, 18432
  s_add_u32 s98, s98, s38
  v_mfma_f32_16x16x32_bf16 v[120:123], v[36:39], v[156:159], v[120:123]
  s_add_u32 s99, s99, s38
  v_and_b32 v210, 3, v1
  v_lshlrev_b32 v210, 7, v210
  s_waitcnt lgkmcnt(0)
  v_mfma_f32_16x16x32_bf16 v[76:79], v[40:43], v[128:131], v[76:79]
  v_bfe_u32 v12, v1, 2, 1
  v_lshlrev_b32 v12, 24, v12
  s_lshl_b32 s38, s23, 3
  s_add_u32 s38, s38, s20
  s_lshl_b32 s38, s38, 9
  v_add3_u32 v210, v210, v12, s38
  v_mfma_f32_16x16x32_bf16 v[76:79], v[44:47], v[132:135], v[76:79]
  v_cmp_gt_u32 vcc, 8, v1
  s_add_u32 s43, s24, 34045952
  s_nop 0
  v_cndmask_b32 v210, v11, v210, vcc
  s_lshl_b32 s38, s22, 11
  v_add_u32 v3, s38, v3
  v_subrev_u32 v4, s38, v4
  v_mfma_f32_16x16x32_bf16 v[92:95], v[40:43], v[136:139], v[92:95]
  v_and_b32 v12, 15, v1
  v_lshrrev_b32 v13, 4, v1
  v_lshlrev_b32 v13, 2, v13
  v_sub_u32 v12, v12, v13
  s_lshl_b32 s38, s97, 5
  v_add_u32 v9, s38, v12
  v_mfma_f32_16x16x32_bf16 v[92:95], v[44:47], v[140:143], v[92:95]
  s_mov_b32 s40, 0x40004000
  s_mov_b32 s41, 0x41c00000
  s_cmp_eq_u32 s20, 7
  s_cselect_b32 s38, 40, 0
  v_lshlrev_b32 v12, 7, v1
  v_mov_b32 v11, 2130706432
  v_mfma_f32_16x16x32_bf16 v[108:111], v[40:43], v[144:147], v[108:111]
  v_cmp_gt_u32 vcc, s38, v1
  s_mul_i32 s99, s2, 73728
  s_nop 0
  v_cndmask_b32 v208, v11, v12, vcc
  s_add_u32 s44, s25, 16777216
  s_sub_u32 s39, s26, 1
  s_cmp_eq_u32 s26, 0
  v_mfma_f32_16x16x32_bf16 v[108:111], v[44:47], v[148:151], v[108:111]
  s_cselect_b32 s26, s27, s39
  s_cselect_b32 s27, 0x4000, s27
  s_lshl_b32 s25, s26, 15
  s_add_u32 s25, s25, s24
  s_add_u32 s25, s25, 33554432
  s_xor_b32 s28, s28, 0x8000
  v_mfma_f32_16x16x32_bf16 v[124:127], v[40:43], v[152:155], v[124:127]
  s_mov_b32 s45, s44
  s_add_u32 s44, s25, 16777216
  s_sub_u32 s39, s26, 1
  s_cmp_eq_u32 s26, 0
  s_cselect_b32 s26, s27, s39
  s_cselect_b32 s27, 0x4000, s27
  v_mfma_f32_16x16x32_bf16 v[124:127], v[44:47], v[156:159], v[124:127]
  s_lshl_b32 s25, s26, 15
  s_add_u32 s25, s25, s24
  s_add_u32 s25, s25, 33554432
  s_xor_b32 s28, s28, 0x8000
  v_cvt_pk_bf16_f32 v160, v64, v65
  v_cvt_pk_bf16_f32 v161, v66, v67
  v_cvt_pk_bf16_f32 v162, v68, v69
  v_cvt_pk_bf16_f32 v163, v70, v71
  v_cvt_pk_bf16_f32 v164, v72, v73
  v_cvt_pk_bf16_f32 v165, v74, v75
  v_cvt_pk_bf16_f32 v166, v76, v77
  v_cvt_pk_bf16_f32 v167, v78, v79
  v_cvt_pk_bf16_f32 v168, v80, v81
  v_cvt_pk_bf16_f32 v169, v82, v83
  v_cvt_pk_bf16_f32 v170, v84, v85
  v_cvt_pk_bf16_f32 v171, v86, v87
  v_cvt_pk_bf16_f32 v172, v88, v89
  v_cvt_pk_bf16_f32 v173, v90, v91
  v_cvt_pk_bf16_f32 v174, v92, v93
  v_cvt_pk_bf16_f32 v175, v94, v95
  v_cvt_pk_bf16_f32 v176, v96, v97
  v_cvt_pk_bf16_f32 v177, v98, v99
  v_cvt_pk_bf16_f32 v178, v100, v101
  v_cvt_pk_bf16_f32 v179, v102, v103
  v_cvt_pk_bf16_f32 v180, v104, v105
  v_cvt_pk_bf16_f32 v181, v106, v107
  v_cvt_pk_bf16_f32 v182, v108, v109
  v_cvt_pk_bf16_f32 v183, v110, v111
  v_cvt_pk_bf16_f32 v184, v112, v113
  v_cvt_pk_bf16_f32 v185, v114, v115
  v_cvt_pk_bf16_f32 v186, v116, v117
  v_cvt_pk_bf16_f32 v187, v118, v119
  v_cvt_pk_bf16_f32 v188, v120, v121
  v_cvt_pk_bf16_f32 v189, v122, v123
  v_cvt_pk_bf16_f32 v190, v124, v125
  v_cvt_pk_bf16_f32 v191, v126, v127
  v_mov_b32 v28, 0x3f803f80
  v_mov_b32 v29, 0x3f803f80
  v_mov_b32 v30, 0x3f803f80
  v_mov_b32 v31, 0x3f803f80
  s_lshl_b32 s39, s22, 11
  s_lshl_b32 s38, s21, 13
  s_add_u32 s38, s38, 98304
  v_add_u32 v12, s38, v6
  v_add_u32 v13, s39, v12
  s_barrier
  ds_write_b128 v13, v[160:163] offset:0
  ds_write_b128 v13, v[164:167] offset:1024
  ds_write_b128 v13, v[168:171] offset:4096
  ds_write_b128 v13, v[172:175] offset:5120
  s_lshl_b32 s38, s101, 2
  s_add_u32 s38, s38, s21
  s_lshl_b32 s38, s38, 13
  s_add_u32 s38, s38, s24
  s_add_u32 s38, s38, s39
  s_add_u32 s38, s38, 16777216
  s_add_u32 s39, s38, 4096
  buffer_store_dwordx4 v[176:179], v6, s[4:7], s38 offen offset:0 sc1
  buffer_store_dwordx4 v[180:183], v6, s[4:7], s38 offen offset:1024 sc1
  buffer_store_dwordx4 v[184:187], v6, s[4:7], s39 offen offset:0 sc1
  buffer_store_dwordx4 v[188:191], v6, s[4:7], s39 offen offset:1024 sc1
  s_waitcnt vmcnt(12) lgkmcnt(0)
  s_barrier
  ds_read_b128 v[128:131], v12 offset:0
  ds_read_b128 v[132:135], v12 offset:1024
  ds_read_b128 v[136:139], v12 offset:2048
  ds_read_b128 v[140:143], v12 offset:3072
  ds_read_b128 v[144:147], v12 offset:4096
  ds_read_b128 v[148:151], v12 offset:5120
  ds_read_b128 v[152:155], v12 offset:6144
  ds_read_b128 v[156:159], v12 offset:7168
  s_xor_b32 s29, s29, 0x8000
L_qb_front_kernel:
  ds_read_b128 v[160:163], v2 offset:0
  ds_read_b128 v[164:167], v2 offset:1024
  ds_read_b128 v[168:171], v2 offset:2048
  ds_read_b128 v[172:175], v2 offset:3072
  ds_read_b128 v[176:179], v2 offset:4096
  ds_read_b128 v[180:183], v2 offset:5120
  s_waitcnt lgkmcnt(8)
  ds_read_b128 v[184:187], v2 offset:6144
  ds_read_b128 v[188:191], v2 offset:7168
  v_mov_b32 v192, 0
  v_mov_b32 v193, 0
  v_mov_b32 v194, 0
  v_mov_b32 v195, 0
  v_mov_b32 v196, 0
  v_mov_b32 v197, 0
  v_mov_b32 v198, 0
  v_mov_b32 v199, 0
  v_mov_b32 v220, 0
  v_mov_b32 v221, 0
  v_mov_b32 v222, 0
  v_mov_b32 v223, 0
  v_mov_b32 v224, 0
  v_mov_b32 v225, 0
  v_mov_b32 v226, 0
  v_mov_b32 v227, 0
  s_add_u32 s30, s96, 1
  s_cmp_lt_i32 s97, 0
  s_cbranch_scc0 L_p0live_front_kernel
  v_mfma_f32_32x32x16_bf16 v[64:79], v[192:195], v[192:195], 0
  v_mfma_f32_32x32x16_bf16 v[80:95], v[192:195], v[192:195], 0
  v_mfma_f32_32x32x16_bf16 v[96:111], v[192:195], v[192:195], 0
  v_mfma_f32_32x32x16_bf16 v[112:127], v[192:195], v[192:195], 0
  v_mov_b32 v16, 0
  v_mov_b32 v17, 0
  v_mov_b32 v18, 0
  v_mov_b32 v19, 0
  v_mov_b32 v20, 0
  v_mov_b32 v21, 0
  v_mov_b32 v22, 0
  v_mov_b32 v23, 0
  v_mov_b32 v48, v14
  v_mov_b32 v49, v14
  v_mov_b32 v50, v14
  v_mov_b32 v51, v14
  v_mov_b32 v52, v14
  v_mov_b32 v53, v14
  v_mov_b32 v54, v14
  v_mov_b32 v55, v14
  v_mov_b32 v56, v14
  v_mov_b32 v57, v14
  v_mov_b32 v58, v14
  v_mov_b32 v59, v14
  v_mov_b32 v60, v14
  v_mov_b32 v61, v14
  v_mov_b32 v62, v14
  v_mov_b32 v63, v14
  s_mov_b64 s[34:35], -1
  s_waitcnt vmcnt(0) lgkmcnt(0)
  s_barrier
  v_xor_b32 v2, 0x8000, v2
  v_xor_b32 v3, 0x8000, v3
  v_xor_b32 v4, 0x8000, v4
  s_sub_u32 s30, s30, 1
  s_cmp_eq_u32 s30, 0
  s_cbranch_scc1 L_tailV_dead_front_kernel
  ds_read_b128 v[160:163], v2 offset:0
  ds_read_b128 v[164:167], v2 offset:1024
  ds_read_b128 v[168:171], v2 offset:2048
  ds_read_b128 v[172:175], v2 offset:3072
  ds_read_b128 v[176:179], v2 offset:4096
  ds_read_b128 v[180:183], v2 offset:5120
  ds_read_b128 v[184:187], v2 offset:6144
  ds_read_b128 v[188:191], v2 offset:7168
  s_branch L_full_front_kernel
L_tailV_dead_front_kernel:
  ds_read_b128 v[160:163], v3 offset:0
  ds_read_b128 v[164:167], v3 offset:1024
  ds_read_b128 v[168:171], v3 offset:2048
  ds_read_b128 v[172:175], v3 offset:3072
  ds_read_b128 v[176:179], v4 offset:4096
  ds_read_b128 v[180:183], v4 offset:5120
  ds_read_b128 v[184:187], v4 offset:6144
  ds_read_b128 v[188:191], v4 offset:7168
  s_branch L_drain_front_kernel
L_p0live_front_kernel:
  s_mov_b64 s[34:35], 0
  s_waitcnt vmcnt(12)
  s_waitcnt lgkmcnt(4)
  v_mfma_f32_16x16x32_bf16 v[32:35], v[160:163], v[128:131], 0
  v_mfma_f32_16x16x32_bf16 v[32:35], v[164:167], v[132:135], v[32:35]
  v_mfma_f32_16x16x32_bf16 v[32:35], v[168:171], v[136:139], v[32:35]
  v_mfma_f32_16x16x32_bf16 v[32:35], v[172:175], v[140:143], v[32:35]
  v_mfma_f32_16x16x32_bf16 v[36:39], v[160:163], v[144:147], 0
  ds_read_b128 v[160:163], v2 offset:8192
  v_mfma_f32_16x16x32_bf16 v[36:39], v[164:167], v[148:151], v[36:39]
  ds_read_b128 v[164:167], v2 offset:9216
  v_mfma_f32_16x16x32_bf16 v[36:39], v[168:171], v[152:155], v[36:39]
  ds_read_b128 v[168:171], v2 offset:10240
  v_mfma_f32_16x16x32_bf16 v[36:39], v[172:175], v[156:159], v[36:39]
  ds_read_b128 v[172:175], v2 offset:11264
  s_waitcnt lgkmcnt(4)
  v_mfma_f32_16x16x32_bf16 v[40:43], v[176:179], v[128:131], 0
  v_mfma_f32_16x16x32_bf16 v[40:43], v[180:183], v[132:135], v[40:43]
  v_mfma_f32_16x16x32_bf16 v[40:43], v[184:187], v[136:139], v[40:43]
  v_mfma_f32_16x16x32_bf16 v[40:43], v[188:191], v[140:143], v[40:43]
  v_mfma_f32_16x16x32_bf16 v[44:47], v[176:179], v[144:147], 0
  ds_read_b128 v[176:179], v2 offset:12288
  v_mfma_f32_16x16x32_bf16 v[44:47], v[180:183], v[148:151], v[44:47]
  ds_read_b128 v[180:183], v2 offset:13312
  v_mfma_f32_16x16x32_bf16 v[44:47], v[184:187], v[152:155], v[44:47]
  ds_read_b128 v[184:187], v2 offset:14336
  v_mfma_f32_16x16x32_bf16 v[44:47], v[188:191], v[156:159], v[44:47]
  ds_read_b128 v[188:191], v2 offset:15360
  v_mfma_f32_32x32x16_bf16 v[64:79], v[192:195], v[192:195], 0
  v_mfma_f32_32x32x16_bf16 v[80:95], v[192:195], v[192:195], 0
  v_mfma_f32_32x32x16_bf16 v[96:111], v[192:195], v[192:195], 0
  v_mfma_f32_32x32x16_bf16 v[112:127], v[192:195], v[192:195], 0
  s_cmp_lg_u32 s97, 0
  s_cbranch_scc1 L_nm0_front_kernel
  v_cmp_gt_i32 s[8:9], 0, v9
  v_cmp_gt_i32 s[10:11], 1, v9
  v_cmp_gt_i32 s[12:13], 2, v9
  v_cndmask_b32 v32, v32, v14, s[8:9]
  v_cmp_gt_i32 s[14:15], 3, v9
  v_cndmask_b32 v33, v33, v14, s[10:11]
  v_cmp_gt_i32 s[8:9], -16, v9
  v_cndmask_b32 v34, v34, v14, s[12:13]
  v_cmp_gt_i32 s[10:11], -15, v9
  v_cndmask_b32 v35, v35, v14, s[14:15]
  v_cmp_gt_i32 s[12:13], -14, v9
  v_cndmask_b32 v36, v36, v14, s[8:9]
  v_cmp_gt_i32 s[14:15], -13, v9
  v_cndmask_b32 v37, v37, v14, s[10:11]
  v_cmp_gt_i32 s[8:9], 16, v9
  v_cndmask_b32 v38, v38, v14, s[12:13]
  v_cmp_gt_i32 s[10:11], 17, v9
  v_cndmask_b32 v39, v39, v14, s[14:15]
  v_cmp_gt_i32 s[12:13], 18, v9
  v_cndmask_b32 v40, v40, v14, s[8:9]
  v_cmp_gt_i32 s[14:15], 19, v9
  v_cndmask_b32 v41, v41, v14, s[10:11]
  v_cmp_gt_i32 s[8:9], 0, v9
  v_cndmask_b32 v42, v42, v14, s[12:13]
  v_cmp_gt_i32 s[10:11], 1, v9
  v_cndmask_b32 v43, v43, v14, s[14:15]
  v_cmp_gt_i32 s[12:13], 2, v9
  v_cndmask_b32 v44, v44, v14, s[8:9]
  v_cmp_gt_i32 s[14:15], 3, v9
  v_cndmask_b32 v45, v45, v14, s[10:11]
  v_cndmask_b32 v46, v46, v14, s[12:13]
  v_cndmask_b32 v47, v47, v14, s[14:15]
L_nm0_front_kernel:
  v_max3_f32 v10, v32, v33, v34
  v_max3_f32 v25, v35, v40, v41
  v_max3_f32 v10, v10, v42, v43
  v_max_f32 v10, v10, v25
  v_max3_f32 v24, v36, v37, v38
  v_max3_f32 v26, v39, v44, v45
  v_max3_f32 v24, v24, v46, v47
  v_max_f32 v24, v24, v26
  v_mov_b32 v25, v10
  v_mov_b32 v26, v24
  s_nop 0
  v_permlane16_swap_b32 v25, v10
  v_permlane16_swap_b32 v26, v24
  v_max_f32 v10, v10, v25
  v_max_f32 v24, v24, v26
  v_mov_b32 v25, v10
  v_mov_b32 v26, v24
  s_nop 0
  v_permlane32_swap_b32 v25, v10
  v_permlane32_swap_b32 v26, v24
  v_max_f32 v10, v10, v25
  v_max_f32 v24, v24, v26
  v_add_f32 v10, s41, v10
  v_add_f32 v24, s41, v24
  v_sub_f32 v16, 0, v10
  v_sub_f32 v17, 0, v10
  v_sub_f32 v18, 0, v10
  v_sub_f32 v19, 0, v10
  v_sub_f32 v20, 0, v24
  v_sub_f32 v21, 0, v24
  v_sub_f32 v22, 0, v24
  v_sub_f32 v23, 0, v24
  s_waitcnt lgkmcnt(4)
  v_mfma_f32_16x16x32_bf16 v[48:51], v[160:163], v[128:131], v[16:19]
  v_sub_f32 v32, v32, v10
  v_sub_f32 v33, v33, v10
  v_sub_f32 v34, v34, v10
  v_mfma_f32_16x16x32_bf16 v[48:51], v[164:167], v[132:135], v[48:51]
  v_sub_f32 v35, v35, v10
  v_sub_f32 v36, v36, v24
  v_mfma_f32_16x16x32_bf16 v[48:51], v[168:171], v[136:139], v[48:51]
  v_sub_f32 v37, v37, v24
  v_sub_f32 v38, v38, v24
  v_sub_f32 v39, v39, v24
  v_mfma_f32_16x16x32_bf16 v[48:51], v[172:175], v[140:143], v[48:51]
  v_sub_f32 v40, v40, v10
  v_sub_f32 v41, v41, v10
  v_mfma_f32_16x16x32_bf16 v[52:55], v[160:163], v[144:147], v[20:23]
  v_sub_f32 v42, v42, v10
  v_sub_f32 v43, v43, v10
  v_sub_f32 v44, v44, v24
  v_mfma_f32_16x16x32_bf16 v[52:55], v[164:167], v[148:151], v[52:55]
  v_sub_f32 v45, v45, v24
  v_sub_f32 v46, v46, v24
  v_mfma_f32_16x16x32_bf16 v[52:55], v[168:171], v[152:155], v[52:55]
  v_sub_f32 v47, v47, v24
  v_exp_f32 v212, v32
  v_exp_f32 v213, v33
  v_mfma_f32_16x16x32_bf16 v[52:55], v[172:175], v[156:159], v[52:55]
  v_exp_f32 v214, v34
  v_cvt_pk_bf16_f32 v192, v212, v213
  s_waitcnt vmcnt(0) lgkmcnt(0)
  s_barrier
  s_cmp_lg_u32 s32, 1
  s_cbranch_scc1 L_nsa_front_kernel
  s_cmp_lg_u32 s20, 2
  s_cbranch_scc1 L_nsa_front_kernel
  s_lshr_b32 s38, s33, 3
  s_lshl_b32 s39, s23, 2
  s_add_u32 s39, s39, s38
  s_lshl_b32 s39, s39, 7
  s_add_u32 s39, s39, 38912
  s_and_b32 s38, s33, 7
  s_lshl_b32 s38, 1, s38
  v_mov_b32 v251, 0
  v_mov_b32 v250, s38
  s_mov_b64 exec, 1
  buffer_atomic_add v250, v251, s[4:7], s39 offen sc1
  s_mov_b64 exec, -1
L_nsa_front_kernel:
  v_xor_b32 v2, 0x8000, v2
  v_xor_b32 v3, 0x8000, v3
  v_xor_b32 v4, 0x8000, v4
  s_sub_u32 s30, s30, 1
  s_cmp_eq_u32 s30, 0
  s_cbranch_scc1 L_tailV_p0_front_kernel
  ds_read_b128 v[160:163], v2 offset:0
  ds_read_b128 v[164:167], v2 offset:1024
  ds_read_b128 v[168:171], v2 offset:2048
  ds_read_b128 v[172:175], v2 offset:3072
  v_mfma_f32_16x16x32_bf16 v[56:59], v[176:179], v[128:131], v[16:19]
  v_exp_f32 v215, v35
  v_exp_f32 v216, v36
  v_cvt_pk_bf16_f32 v193, v214, v215
  v_mfma_f32_16x16x32_bf16 v[56:59], v[180:183], v[132:135], v[56:59]
  v_exp_f32 v217, v37
  v_exp_f32 v218, v38
  v_mfma_f32_16x16x32_bf16 v[56:59], v[184:187], v[136:139], v[56:59]
  v_cvt_pk_bf16_f32 v196, v216, v217
  v_exp_f32 v219, v39
  v_exp_f32 v212, v40
  v_mfma_f32_16x16x32_bf16 v[56:59], v[188:191], v[140:143], v[56:59]
  v_cvt_pk_bf16_f32 v197, v218, v219
  v_exp_f32 v213, v41
  v_mfma_f32_16x16x32_bf16 v[60:63], v[176:179], v[144:147], v[20:23]
  ds_read_b128 v[176:179], v2 offset:4096
  v_exp_f32 v214, v42
  v_cvt_pk_bf16_f32 v194, v212, v213
  v_exp_f32 v215, v43
  v_mfma_f32_16x16x32_bf16 v[60:63], v[180:183], v[148:151], v[60:63]
  ds_read_b128 v[180:183], v2 offset:5120
  v_exp_f32 v216, v44
  v_cvt_pk_bf16_f32 v195, v214, v215
  v_mfma_f32_16x16x32_bf16 v[60:63], v[184:187], v[152:155], v[60:63]
  ds_read_b128 v[184:187], v2 offset:6144
  v_exp_f32 v217, v45
  v_exp_f32 v218, v46
  v_cvt_pk_bf16_f32 v198, v216, v217
  v_mfma_f32_16x16x32_bf16 v[60:63], v[188:191], v[156:159], v[60:63]
  ds_read_b128 v[188:191], v2 offset:7168
  v_exp_f32 v219, v47
  s_nop 0
  v_cvt_pk_bf16_f32 v199, v218, v219
  s_cmp_gt_u32 s97, 1
  s_cbranch_scc1 L_nm1_0_front_kernel
  v_cmp_gt_i32 s[8:9], 32, v9
  v_cmp_gt_i32 s[10:11], 33, v9
  v_cmp_gt_i32 s[12:13], 34, v9
  v_cndmask_b32 v48, v48, v14, s[8:9]
  v_cmp_gt_i32 s[14:15], 35, v9
  v_cndmask_b32 v49, v49, v14, s[10:11]
  v_cmp_gt_i32 s[8:9], 16, v9
  v_cndmask_b32 v50, v50, v14, s[12:13]
  v_cmp_gt_i32 s[10:11], 17, v9
  v_cndmask_b32 v51, v51, v14, s[14:15]
  v_cmp_gt_i32 s[12:13], 18, v9
  v_cndmask_b32 v52, v52, v14, s[8:9]
  v_cmp_gt_i32 s[14:15], 19, v9
  v_cndmask_b32 v53, v53, v14, s[10:11]
  v_cmp_gt_i32 s[8:9], 48, v9
  v_cndmask_b32 v54, v54, v14, s[12:13]
  v_cmp_gt_i32 s[10:11], 49, v9
  v_cndmask_b32 v55, v55, v14, s[14:15]
  v_cmp_gt_i32 s[12:13], 50, v9
  v_cndmask_b32 v56, v56, v14, s[8:9]
  v_cmp_gt_i32 s[14:15], 51, v9
  v_cndmask_b32 v57, v57, v14, s[10:11]
  v_cmp_gt_i32 s[8:9], 32, v9
  v_cndmask_b32 v58, v58, v14, s[12:13]
  v_cmp_gt_i32 s[10:11], 33, v9
  v_cndmask_b32 v59, v59, v14, s[14:15]
  v_cmp_gt_i32 s[12:13], 34, v9
  v_cndmask_b32 v60, v60, v14, s[8:9]
  v_cmp_gt_i32 s[14:15], 35, v9
  v_cndmask_b32 v61, v61, v14, s[10:11]
  v_cndmask_b32 v62, v62, v14, s[12:13]
  v_cndmask_b32 v63, v63, v14, s[14:15]
L_nm1_0_front_kernel:
  s_branch L_full_front_kernel
L_tailV_p0_front_kernel:
  ds_read_b128 v[160:163], v3 offset:0
  ds_read_b128 v[164:167], v3 offset:1024
  ds_read_b128 v[168:171], v3 offset:2048
  ds_read_b128 v[172:175], v3 offset:3072
  v_mfma_f32_16x16x32_bf16 v[56:59], v[176:179], v[128:131], v[16:19]
  v_exp_f32 v215, v35
  v_exp_f32 v216, v36
  v_cvt_pk_bf16_f32 v193, v214, v215
  v_mfma_f32_16x16x32_bf16 v[56:59], v[180:183], v[132:135], v[56:59]
  v_exp_f32 v217, v37
  v_exp_f32 v218, v38
  v_mfma_f32_16x16x32_bf16 v[56:59], v[184:187], v[136:139], v[56:59]
  v_cvt_pk_bf16_f32 v196, v216, v217
  v_exp_f32 v219, v39
  v_exp_f32 v212, v40
  v_mfma_f32_16x16x32_bf16 v[56:59], v[188:191], v[140:143], v[56:59]
  v_cvt_pk_bf16_f32 v197, v218, v219
  v_exp_f32 v213, v41
  v_mfma_f32_16x16x32_bf16 v[60:63], v[176:179], v[144:147], v[20:23]
  ds_read_b128 v[176:179], v4 offset:4096
  v_exp_f32 v214, v42
  v_cvt_pk_bf16_f32 v194, v212, v213
  v_exp_f32 v215, v43
  v_mfma_f32_16x16x32_bf16 v[60:63], v[180:183], v[148:151], v[60:63]
  ds_read_b128 v[180:183], v4 offset:5120
  v_exp_f32 v216, v44
  v_cvt_pk_bf16_f32 v195, v214, v215
  v_mfma_f32_16x16x32_bf16 v[60:63], v[184:187], v[152:155], v[60:63]
  ds_read_b128 v[184:187], v4 offset:6144
  v_exp_f32 v217, v45
  v_exp_f32 v218, v46
  v_cvt_pk_bf16_f32 v198, v216, v217
  v_mfma_f32_16x16x32_bf16 v[60:63], v[188:191], v[156:159], v[60:63]
  ds_read_b128 v[188:191], v4 offset:7168
  v_exp_f32 v219, v47
  s_nop 0
  v_cvt_pk_bf16_f32 v199, v218, v219
  s_cmp_gt_u32 s97, 1
  s_cbranch_scc1 L_nm1_1_front_kernel
  v_cmp_gt_i32 s[8:9], 32, v9
  v_cmp_gt_i32 s[10:11], 33, v9
  v_cmp_gt_i32 s[12:13], 34, v9
  v_cndmask_b32 v48, v48, v14, s[8:9]
  v_cmp_gt_i32 s[14:15], 35, v9
  v_cndmask_b32 v49, v49, v14, s[10:11]
  v_cmp_gt_i32 s[8:9], 16, v9
  v_cndmask_b32 v50, v50, v14, s[12:13]
  v_cmp_gt_i32 s[10:11], 17, v9
  v_cndmask_b32 v51, v51, v14, s[14:15]
  v_cmp_gt_i32 s[12:13], 18, v9
  v_cndmask_b32 v52, v52, v14, s[8:9]
  v_cmp_gt_i32 s[14:15], 19, v9
  v_cndmask_b32 v53, v53, v14, s[10:11]
  v_cmp_gt_i32 s[8:9], 48, v9
  v_cndmask_b32 v54, v54, v14, s[12:13]
  v_cmp_gt_i32 s[10:11], 49, v9
  v_cndmask_b32 v55, v55, v14, s[14:15]
  v_cmp_gt_i32 s[12:13], 50, v9
  v_cndmask_b32 v56, v56, v14, s[8:9]
  v_cmp_gt_i32 s[14:15], 51, v9
  v_cndmask_b32 v57, v57, v14, s[10:11]
  v_cmp_gt_i32 s[8:9], 32, v9
  v_cndmask_b32 v58, v58, v14, s[12:13]
  v_cmp_gt_i32 s[10:11], 33, v9
  v_cndmask_b32 v59, v59, v14, s[14:15]
  v_cmp_gt_i32 s[12:13], 34, v9
  v_cndmask_b32 v60, v60, v14, s[8:9]
  v_cmp_gt_i32 s[14:15], 35, v9
  v_cndmask_b32 v61, v61, v14, s[10:11]
  v_cndmask_b32 v62, v62, v14, s[12:13]
  v_cndmask_b32 v63, v63, v14, s[14:15]
L_nm1_1_front_kernel:
  s_branch L_drain_front_kernel
.p2align 3
L_full_front_kernel:
  s_waitcnt lgkmcnt(4)
  v_mfma_f32_16x16x32_bf16 v[32:35], v[160:163], v[128:131], v[16:19]
  v_exp_f32 v212, v48
  s_mov_b32 m0, s29
  v_mfma_f32_16x16x32_bf16 v[32:35], v[164:167], v[132:135], v[32:35]
  v_exp_f32 v213, v49
  buffer_load_dwordx4 v5, s[4:7], s44 offen offset:0 lds
  v_mfma_f32_16x16x32_bf16 v[32:35], v[168:171], v[136:139], v[32:35]
  v_exp_f32 v214, v50
  buffer_load_dwordx4 v5, s[4:7], s44 offen offset:1024 lds
  v_mfma_f32_16x16x32_bf16 v[32:35], v[172:175], v[140:143], v[32:35]
  v_exp_f32 v215, v51
  buffer_load_dwordx4 v5, s[4:7], s44 offen offset:2048 lds
  v_mfma_f32_16x16x32_bf16 v[36:39], v[160:163], v[144:147], v[20:23]
  ds_read_b128 v[160:163], v3 offset:0
  v_cvt_pk_bf16_f32 v200, v212, v213
  buffer_load_dwordx4 v5, s[4:7], s44 offen offset:3072 lds
  v_mfma_f32_16x16x32_bf16 v[36:39], v[164:167], v[148:151], v[36:39]
  ds_read_b128 v[164:167], v3 offset:1024
  v_exp_f32 v216, v52
  s_xor_b32 s29, s29, 0x8000
  v_mfma_f32_16x16x32_bf16 v[36:39], v[168:171], v[152:155], v[36:39]
  ds_read_b128 v[168:171], v3 offset:2048
  s_mov_b32 m0, s28
  v_mfma_f32_16x16x32_bf16 v[36:39], v[172:175], v[156:159], v[36:39]
  ds_read_b128 v[172:175], v3 offset:3072
  v_exp_f32 v217, v53
  buffer_load_dwordx4 v5, s[4:7], s25 offen offset:0 lds
  s_waitcnt lgkmcnt(4)
  v_mfma_f32_16x16x32_bf16 v[40:43], v[176:179], v[128:131], v[16:19]
  v_cvt_pk_bf16_f32 v201, v214, v215
  buffer_load_dwordx4 v5, s[4:7], s25 offen offset:1024 lds
  v_mfma_f32_16x16x32_bf16 v[40:43], v[180:183], v[132:135], v[40:43]
  v_exp_f32 v218, v54
  buffer_load_dwordx4 v5, s[4:7], s25 offen offset:2048 lds
  v_mfma_f32_16x16x32_bf16 v[40:43], v[184:187], v[136:139], v[40:43]
  v_exp_f32 v219, v55
  buffer_load_dwordx4 v5, s[4:7], s25 offen offset:3072 lds
  v_mfma_f32_16x16x32_bf16 v[40:43], v[188:191], v[140:143], v[40:43]
  v_cvt_pk_bf16_f32 v204, v216, v217
  s_add_u32 s44, s25, 16777216
  v_mfma_f32_16x16x32_bf16 v[44:47], v[176:179], v[144:147], v[20:23]
  ds_read_b128 v[176:179], v4 offset:4096
  v_exp_f32 v212, v56
  s_sub_u32 s39, s26, 1
  v_mfma_f32_16x16x32_bf16 v[44:47], v[180:183], v[148:151], v[44:47]
  ds_read_b128 v[180:183], v4 offset:5120
  s_cmp_eq_u32 s26, 0
  v_mfma_f32_16x16x32_bf16 v[44:47], v[184:187], v[152:155], v[44:47]
  ds_read_b128 v[184:187], v4 offset:6144
  v_exp_f32 v213, v57
  s_cselect_b32 s26, s27, s39
  v_mfma_f32_16x16x32_bf16 v[44:47], v[188:191], v[156:159], v[44:47]
  ds_read_b128 v[188:191], v4 offset:7168
  v_or3_b32 v10, v200, v201, v204
  s_cselect_b32 s27, 0x4000, s27
  s_waitcnt lgkmcnt(6)
  v_mfma_f32_16x16x32_bf16 v[64:67], v[160:163], v[192:195], v[64:67]
  v_exp_f32 v214, v58
  s_lshl_b32 s25, s26, 15
  v_mfma_f32_16x16x32_bf16 v[68:71], v[160:163], v[196:199], v[68:71]
  ds_read_b128 v[160:163], v2 offset:8192
  v_exp_f32 v215, v59
  s_add_u32 s25, s25, s24
  v_mfma_f32_16x16x32_bf16 v[72:75], v[164:167], v[192:195], v[72:75]
  v_cvt_pk_bf16_f32 v205, v218, v219
  s_add_u32 s25, s25, 33554432
  v_mfma_f32_16x16x32_bf16 v[76:79], v[164:167], v[196:199], v[76:79]
  ds_read_b128 v[164:167], v2 offset:9216
  s_xor_b32 s28, s28, 0x8000
  s_waitcnt lgkmcnt(6)
  v_mfma_f32_16x16x32_bf16 v[80:83], v[168:171], v[192:195], v[80:83]
  v_exp_f32 v216, v60
  v_mfma_f32_16x16x32_bf16 v[84:87], v[168:171], v[196:199], v[84:87]
  ds_read_b128 v[168:171], v2 offset:10240
  v_exp_f32 v217, v61
  v_mfma_f32_16x16x32_bf16 v[220:223], v[28:31], v[192:195], v[220:223]
  v_cvt_pk_bf16_f32 v202, v212, v213
  v_or3_b32 v10, v10, v205, v202
  v_mfma_f32_16x16x32_bf16 v[88:91], v[172:175], v[192:195], v[88:91]
  v_exp_f32 v218, v62
  v_mfma_f32_16x16x32_bf16 v[92:95], v[172:175], v[196:199], v[92:95]
  ds_read_b128 v[172:175], v2 offset:11264
  v_exp_f32 v219, v63
  buffer_load_dword v209, v208, s[88:91], s99 offen
  s_waitcnt lgkmcnt(6)
  v_mfma_f32_16x16x32_bf16 v[96:99], v[176:179], v[192:195], v[96:99]
  v_cvt_pk_bf16_f32 v203, v214, v215
  buffer_load_dword v209, v208, s[92:95], s99 offen
  v_mfma_f32_16x16x32_bf16 v[100:103], v[176:179], v[196:199], v[100:103]
  ds_read_b128 v[176:179], v2 offset:12288
  s_add_u32 s99, s99, 5120
  v_mfma_f32_16x16x32_bf16 v[104:107], v[180:183], v[192:195], v[104:107]
  v_cvt_pk_bf16_f32 v206, v216, v217
  v_mfma_f32_16x16x32_bf16 v[108:111], v[180:183], v[196:199], v[108:111]
  ds_read_b128 v[180:183], v2 offset:13312
  v_or3_b32 v10, v10, v203, v206
  v_mfma_f32_16x16x32_bf16 v[224:227], v[28:31], v[196:199], v[224:227]
  v_cvt_pk_bf16_f32 v207, v218, v219
  s_waitcnt lgkmcnt(6)
  v_mfma_f32_16x16x32_bf16 v[112:115], v[184:187], v[192:195], v[112:115]
  v_bitop3_b32 v10, v10, v207, s40 bitop3:0xa8
  v_mfma_f32_16x16x32_bf16 v[116:119], v[184:187], v[196:199], v[116:119]
  ds_read_b128 v[184:187], v2 offset:14336
  v_cmp_ne_u32 vcc, 0, v10
  v_mfma_f32_16x16x32_bf16 v[120:123], v[188:191], v[192:195], v[120:123]
  v_mfma_f32_16x16x32_bf16 v[124:127], v[188:191], v[196:199], v[124:127]
  ds_read_b128 v[188:191], v2 offset:15360
  s_cbranch_vccnz L_rare0_front_kernel
L_back0_front_kernel:
  s_waitcnt lgkmcnt(4)
  v_mfma_f32_16x16x32_bf16 v[48:51], v[160:163], v[128:131], v[16:19]
  v_exp_f32 v212, v32
  v_mfma_f32_16x16x32_bf16 v[48:51], v[164:167], v[132:135], v[48:51]
  v_exp_f32 v213, v33
  v_mfma_f32_16x16x32_bf16 v[48:51], v[168:171], v[136:139], v[48:51]
  v_exp_f32 v214, v34
  v_mfma_f32_16x16x32_bf16 v[48:51], v[172:175], v[140:143], v[48:51]
  v_exp_f32 v215, v35
  v_mfma_f32_16x16x32_bf16 v[52:55], v[160:163], v[144:147], v[20:23]
  ds_read_b128 v[160:163], v3 offset:8192
  v_cvt_pk_bf16_f32 v192, v212, v213
  v_mfma_f32_16x16x32_bf16 v[52:55], v[164:167], v[148:151], v[52:55]
  ds_read_b128 v[164:167], v3 offset:9216
  v_exp_f32 v216, v36
  v_mfma_f32_16x16x32_bf16 v[52:55], v[168:171], v[152:155], v[52:55]
  ds_read_b128 v[168:171], v3 offset:10240
  v_mfma_f32_16x16x32_bf16 v[52:55], v[172:175], v[156:159], v[52:55]
  ds_read_b128 v[172:175], v3 offset:11264
  v_exp_f32 v217, v37
  s_waitcnt lgkmcnt(4)
  v_mfma_f32_16x16x32_bf16 v[56:59], v[176:179], v[128:131], v[16:19]
  v_cvt_pk_bf16_f32 v193, v214, v215
  v_mfma_f32_16x16x32_bf16 v[56:59], v[180:183], v[132:135], v[56:59]
  v_exp_f32 v218, v38
  v_mfma_f32_16x16x32_bf16 v[56:59], v[184:187], v[136:139], v[56:59]
  v_exp_f32 v219, v39
  v_mfma_f32_16x16x32_bf16 v[56:59], v[188:191], v[140:143], v[56:59]
  v_cvt_pk_bf16_f32 v196, v216, v217
  v_mfma_f32_16x16x32_bf16 v[60:63], v[176:179], v[144:147], v[20:23]
  ds_read_b128 v[176:179], v4 offset:12288
  v_exp_f32 v212, v40
  v_mfma_f32_16x16x32_bf16 v[60:63], v[180:183], v[148:151], v[60:63]
  ds_read_b128 v[180:183], v4 offset:13312
  v_mfma_f32_16x16x32_bf16 v[60:63], v[184:187], v[152:155], v[60:63]
  ds_read_b128 v[184:187], v4 offset:14336
  v_exp_f32 v213, v41
  v_mfma_f32_16x16x32_bf16 v[60:63], v[188:191], v[156:159], v[60:63]
  ds_read_b128 v[188:191], v4 offset:15360
  v_or3_b32 v10, v192, v193, v196
  s_waitcnt lgkmcnt(6)
  v_mfma_f32_16x16x32_bf16 v[64:67], v[160:163], v[200:203], v[64:67]
  v_exp_f32 v214, v42
  v_mfma_f32_16x16x32_bf16 v[68:71], v[160:163], v[204:207], v[68:71]
  v_exp_f32 v215, v43
  v_mfma_f32_16x16x32_bf16 v[72:75], v[164:167], v[200:203], v[72:75]
  v_cvt_pk_bf16_f32 v197, v218, v219
  v_mfma_f32_16x16x32_bf16 v[76:79], v[164:167], v[204:207], v[76:79]
  s_waitcnt lgkmcnt(4)
  v_mfma_f32_16x16x32_bf16 v[80:83], v[168:171], v[200:203], v[80:83]
  v_exp_f32 v216, v44
  v_mfma_f32_16x16x32_bf16 v[84:87], v[168:171], v[204:207], v[84:87]
  v_exp_f32 v217, v45
  v_mfma_f32_16x16x32_bf16 v[220:223], v[28:31], v[200:203], v[220:223]
  v_cvt_pk_bf16_f32 v194, v212, v213
  v_or3_b32 v10, v10, v197, v194
  v_mfma_f32_16x16x32_bf16 v[88:91], v[172:175], v[200:203], v[88:91]
  v_exp_f32 v218, v46
  v_mfma_f32_16x16x32_bf16 v[92:95], v[172:175], v[204:207], v[92:95]
  v_exp_f32 v219, v47
  s_waitcnt vmcnt(2) lgkmcnt(0)
  s_barrier
  v_xor_b32 v2, 0x8000, v2
  v_xor_b32 v3, 0x8000, v3
  v_xor_b32 v4, 0x8000, v4
  s_sub_u32 s30, s30, 1
  s_cmp_eq_u32 s30, 0
  s_cbranch_scc1 L_tailV_full_front_kernel
  ds_read_b128 v[160:163], v2 offset:0
  ds_read_b128 v[164:167], v2 offset:1024
  ds_read_b128 v[168:171], v2 offset:2048
  ds_read_b128 v[172:175], v2 offset:3072
  v_mfma_f32_16x16x32_bf16 v[96:99], v[176:179], v[200:203], v[96:99]
  v_cvt_pk_bf16_f32 v195, v214, v215
  v_mfma_f32_16x16x32_bf16 v[100:103], v[176:179], v[204:207], v[100:103]
  ds_read_b128 v[176:179], v2 offset:4096
  v_mfma_f32_16x16x32_bf16 v[104:107], v[180:183], v[200:203], v[104:107]
  v_cvt_pk_bf16_f32 v198, v216, v217
  v_mfma_f32_16x16x32_bf16 v[108:111], v[180:183], v[204:207], v[108:111]
  ds_read_b128 v[180:183], v2 offset:5120
  v_or3_b32 v10, v10, v195, v198
  v_mfma_f32_16x16x32_bf16 v[224:227], v[28:31], v[204:207], v[224:227]
  v_cvt_pk_bf16_f32 v199, v218, v219
  v_mfma_f32_16x16x32_bf16 v[112:115], v[184:187], v[200:203], v[112:115]
  v_bitop3_b32 v10, v10, v199, s40 bitop3:0xa8
  v_mfma_f32_16x16x32_bf16 v[116:119], v[184:187], v[204:207], v[116:119]
  ds_read_b128 v[184:187], v2 offset:6144
  v_cmp_ne_u32 vcc, 0, v10
  v_mfma_f32_16x16x32_bf16 v[120:123], v[188:191], v[200:203], v[120:123]
  v_mfma_f32_16x16x32_bf16 v[124:127], v[188:191], v[204:207], v[124:127]
  ds_read_b128 v[188:191], v2 offset:7168
  s_or_b64 s[36:37], vcc, s[34:35]
  s_cbranch_scc1 L_rare1_front_kernel
L_back1_front_kernel:
  s_branch L_full_front_kernel
L_tailV_full_front_kernel:
  ds_read_b128 v[160:163], v3 offset:0
  ds_read_b128 v[164:167], v3 offset:1024
  ds_read_b128 v[168:171], v3 offset:2048
  ds_read_b128 v[172:175], v3 offset:3072
  v_mfma_f32_16x16x32_bf16 v[96:99], v[176:179], v[200:203], v[96:99]
  v_cvt_pk_bf16_f32 v195, v214, v215
  v_mfma_f32_16x16x32_bf16 v[100:103], v[176:179], v[204:207], v[100:103]
  ds_read_b128 v[176:179], v4 offset:4096
  v_mfma_f32_16x16x32_bf16 v[104:107], v[180:183], v[200:203], v[104:107]
  v_cvt_pk_bf16_f32 v198, v216, v217
  v_mfma_f32_16x16x32_bf16 v[108:111], v[180:183], v[204:207], v[108:111]
  ds_read_b128 v[180:183], v4 offset:5120
  v_or3_b32 v10, v10, v195, v198
  v_mfma_f32_16x16x32_bf16 v[224:227], v[28:31], v[204:207], v[224:227]
  v_cvt_pk_bf16_f32 v199, v218, v219
  v_mfma_f32_16x16x32_bf16 v[112:115], v[184:187], v[200:203], v[112:115]
  v_bitop3_b32 v10, v10, v199, s40 bitop3:0xa8
  v_mfma_f32_16x16x32_bf16 v[116:119], v[184:187], v[204:207], v[116:119]
  ds_read_b128 v[184:187], v4 offset:6144
  v_cmp_ne_u32 vcc, 0, v10
  v_mfma_f32_16x16x32_bf16 v[120:123], v[188:191], v[200:203], v[120:123]
  v_mfma_f32_16x16x32_bf16 v[124:127], v[188:191], v[204:207], v[124:127]
  ds_read_b128 v[188:191], v4 offset:7168
  s_or_b64 s[36:37], vcc, s[34:35]
  s_cbranch_scc1 L_rare2_front_kernel
L_back2_front_kernel:
L_drain_front_kernel:
  s_mov_b32 s47, s96
  s_cmp_eq_u32 s32, 0
  s_cselect_b32 s96, s101, 0x4000
  s_cmp_lg_u32 s32, 1
  s_cbranch_scc1 L_ntk_front_kernel
  s_cmp_lg_u32 s20, 3
  s_cbranch_scc1 L_ntk_front_kernel
  v_mov_b32 v244, 1
  v_mov_b32 v245, 0
  s_and_b32 s38, s2, 7
  s_lshl_b32 s38, s38, 2
  s_add_u32 s38, s38, 4
  s_mov_b64 exec, 1
  buffer_atomic_add v244, v245, s[52:55], s38 offen sc0 sc1
  s_mov_b64 exec, -1
L_ntk_front_kernel:
  s_waitcnt lgkmcnt(6)
  v_mfma_f32_16x16x32_bf16 v[64:67], v[160:163], v[192:195], v[64:67]
  v_exp_f32 v212, v48
  v_exp_f32 v213, v49
  s_lshl_b32 s38, s96, 2
  s_add_u32 s38, s38, s21
  v_mfma_f32_16x16x32_bf16 v[68:71], v[160:163], v[196:199], v[68:71]
  ds_read_b128 v[160:163], v4 offset:12288
  v_exp_f32 v214, v50
  v_cvt_pk_bf16_f32 v200, v212, v213
  s_lshl_b32 s38, s38, 13
  v_mfma_f32_16x16x32_bf16 v[72:75], v[164:167], v[192:195], v[72:75]
  v_exp_f32 v215, v51
  v_exp_f32 v216, v52
  s_add_u32 s38, s38, s24
  v_mfma_f32_16x16x32_bf16 v[76:79], v[164:167], v[196:199], v[76:79]
  ds_read_b128 v[164:167], v4 offset:13312
  v_cvt_pk_bf16_f32 v201, v214, v215
  v_exp_f32 v217, v53
  s_add_u32 s38, s38, 16777216
  s_waitcnt lgkmcnt(6)
  v_mfma_f32_16x16x32_bf16 v[80:83], v[168:171], v[192:195], v[80:83]
  v_exp_f32 v218, v54
  v_cvt_pk_bf16_f32 v204, v216, v217
  s_add_u32 s39, s38, 4096
  v_mfma_f32_16x16x32_bf16 v[84:87], v[168:171], v[196:199], v[84:87]
  ds_read_b128 v[168:171], v4 offset:14336
  v_exp_f32 v219, v55
  buffer_load_dwordx4 v[128:131], v6, s[4:7], s38 offen offset:0
  buffer_load_dwordx4 v[132:135], v6, s[4:7], s38 offen offset:1024
  v_mfma_f32_16x16x32_bf16 v[220:223], v[28:31], v[192:195], v[220:223]
  v_or3_b32 v10, v200, v201, v204
  v_exp_f32 v212, v56
  buffer_load_dwordx4 v[136:139], v6, s[4:7], s38 offen offset:2048
  v_mfma_f32_16x16x32_bf16 v[88:91], v[172:175], v[192:195], v[88:91]
  v_cvt_pk_bf16_f32 v205, v218, v219
  v_exp_f32 v213, v57
  buffer_load_dwordx4 v[140:143], v6, s[4:7], s38 offen offset:3072
  v_mfma_f32_16x16x32_bf16 v[92:95], v[172:175], v[196:199], v[92:95]
  ds_read_b128 v[172:175], v4 offset:15360
  v_exp_f32 v214, v58
  v_cvt_pk_bf16_f32 v202, v212, v213
  buffer_load_dwordx4 v[144:147], v6, s[4:7], s39 offen offset:0
  s_waitcnt lgkmcnt(6)
  v_mfma_f32_16x16x32_bf16 v[96:99], v[176:179], v[192:195], v[96:99]
  v_exp_f32 v215, v59
  v_or3_b32 v10, v10, v205, v202
  buffer_load_dwordx4 v[148:151], v6, s[4:7], s39 offen offset:1024
  v_mfma_f32_16x16x32_bf16 v[100:103], v[176:179], v[196:199], v[100:103]
  ds_read_b128 v[176:179], v3 offset:8192
  v_exp_f32 v216, v60
  buffer_load_dwordx4 v[152:155], v6, s[4:7], s39 offen offset:2048
  v_mfma_f32_16x16x32_bf16 v[104:107], v[180:183], v[192:195], v[104:107]
  v_cvt_pk_bf16_f32 v203, v214, v215
  v_exp_f32 v217, v61
  buffer_load_dwordx4 v[156:159], v6, s[4:7], s39 offen offset:3072
  s_mov_b32 m0, s29
  v_mfma_f32_16x16x32_bf16 v[108:111], v[180:183], v[196:199], v[108:111]
  ds_read_b128 v[180:183], v3 offset:9216
  v_exp_f32 v218, v62
  v_cvt_pk_bf16_f32 v206, v216, v217
  buffer_load_dwordx4 v5, s[4:7], s44 offen offset:0 lds
  v_mfma_f32_16x16x32_bf16 v[224:227], v[28:31], v[196:199], v[224:227]
  v_exp_f32 v219, v63
  v_or3_b32 v10, v10, v203, v206
  buffer_load_dwordx4 v5, s[4:7], s44 offen offset:1024 lds
  s_waitcnt lgkmcnt(6)
  v_mfma_f32_16x16x32_bf16 v[112:115], v[184:187], v[192:195], v[112:115]
  v_cvt_pk_bf16_f32 v207, v218, v219
  v_bitop3_b32 v10, v10, v207, s40 bitop3:0xa8
  buffer_load_dwordx4 v5, s[4:7], s44 offen offset:2048 lds
  v_mfma_f32_16x16x32_bf16 v[116:119], v[184:187], v[196:199], v[116:119]
  ds_read_b128 v[184:187], v3 offset:10240
  v_cmp_ne_u32 vcc, 0, v10
  buffer_load_dwordx4 v5, s[4:7], s44 offen offset:3072 lds
  v_mfma_f32_16x16x32_bf16 v[120:123], v[188:191], v[192:195], v[120:123]
  s_xor_b32 s29, s29, 0x8000
  v_mfma_f32_16x16x32_bf16 v[124:127], v[188:191], v[196:199], v[124:127]
  ds_read_b128 v[188:191], v3 offset:11264
  s_cbranch_vccnz L_rare3_front_kernel
L_back3_front_kernel:
  s_waitcnt lgkmcnt(6)
  v_mfma_f32_16x16x32_bf16 v[96:99], v[160:163], v[200:203], v[96:99]
  s_cmp_lg_u64 s[34:35], 0
  s_cselect_b32 s38, 0xf149f2ca, 0
  v_mfma_f32_16x16x32_bf16 v[100:103], v[160:163], v[204:207], v[100:103]
  v_sub_f32 v32, s38, v16
  v_sub_f32 v34, s38, v20
  v_mfma_f32_16x16x32_bf16 v[104:107], v[164:167], v[200:203], v[104:107]
  v_and_b32 v11, 15, v1
  v_mfma_f32_16x16x32_bf16 v[108:111], v[164:167], v[204:207], v[108:111]
  s_lshl_b32 s38, s20, 8
  v_lshlrev_b32 v11, 4, v11
  s_waitcnt lgkmcnt(4)
  v_mfma_f32_16x16x32_bf16 v[112:115], v[168:171], v[200:203], v[112:115]
  s_add_u32 s38, s38, 131072
  v_add_u32 v10, s38, v11
  v_mfma_f32_16x16x32_bf16 v[116:119], v[168:171], v[204:207], v[116:119]
  v_xor_b32 v27, 0x400, v10
  v_mfma_f32_16x16x32_bf16 v[220:223], v[28:31], v[200:203], v[220:223]
  s_xor_b32 s38, s28, 0x4000
  v_add_u32 v11, s38, v6
  v_mfma_f32_16x16x32_bf16 v[120:123], v[172:175], v[200:203], v[120:123]
  v_add_u32 v15, s28, v6
  v_mfma_f32_16x16x32_bf16 v[124:127], v[172:175], v[204:207], v[124:127]
  v_cvt_pk_bf16_f32 v228, v96, v97
  v_cvt_pk_bf16_f32 v229, v98, v99
  s_waitcnt lgkmcnt(0)
  v_mfma_f32_16x16x32_bf16 v[64:67], v[176:179], v[200:203], v[64:67]
  v_cvt_pk_bf16_f32 v230, v104, v105
  v_cvt_pk_bf16_f32 v231, v106, v107
  v_mfma_f32_16x16x32_bf16 v[68:71], v[176:179], v[204:207], v[68:71]
  ds_write_b128 v11, v[228:231] offset:0
  v_cvt_pk_bf16_f32 v232, v100, v101
  v_mfma_f32_16x16x32_bf16 v[72:75], v[180:183], v[200:203], v[72:75]
  v_cvt_pk_bf16_f32 v233, v102, v103
  v_cvt_pk_bf16_f32 v234, v108, v109
  v_mfma_f32_16x16x32_bf16 v[76:79], v[180:183], v[204:207], v[76:79]
  v_cvt_pk_bf16_f32 v235, v110, v111
  ds_write_b128 v11, v[232:235] offset:1024
  v_mfma_f32_16x16x32_bf16 v[224:227], v[28:31], v[204:207], v[224:227]
  v_cvt_pk_bf16_f32 v236, v112, v113
  v_cvt_pk_bf16_f32 v237, v114, v115
  v_mfma_f32_16x16x32_bf16 v[80:83], v[184:187], v[200:203], v[80:83]
  v_cvt_pk_bf16_f32 v238, v120, v121
  v_cvt_pk_bf16_f32 v239, v122, v123
  v_mfma_f32_16x16x32_bf16 v[84:87], v[184:187], v[204:207], v[84:87]
  ds_write_b128 v11, v[236:239] offset:2048
  v_cvt_pk_bf16_f32 v240, v116, v117
  v_mfma_f32_16x16x32_bf16 v[88:91], v[188:191], v[200:203], v[88:91]
  v_cvt_pk_bf16_f32 v241, v118, v119
  v_cvt_pk_bf16_f32 v242, v124, v125
  v_mfma_f32_16x16x32_bf16 v[92:95], v[188:191], v[204:207], v[92:95]
  v_cvt_pk_bf16_f32 v243, v126, v127
  ds_write_b128 v11, v[240:243] offset:3072
  v_mov_b32 v33, v220
  v_mov_b32 v35, v224
  ds_write_b128 v10, v[32:35]
  s_lshl_b32 s38, s47, 2
  s_add_u32 s38, s38, s21
  s_lshl_b32 s38, s38, 18
  s_lshl_b32 s39, s33, 12
  s_add_u32 s38, s38, s39
  s_lshl_b32 s39, s22, 11
  s_add_u32 s38, s38, s39
  s_add_u32 s38, s38, 67108864
  s_add_u32 s39, s38, 131072
  v_mov_b32 v246, 135168
  s_cmp_lg_u32 s32, 1
  s_cbranch_scc1 L_ntw_front_kernel
  s_cmp_lg_u32 s20, 3
  s_cbranch_scc1 L_ntw_front_kernel
  s_waitcnt vmcnt(12)
  s_mov_b64 exec, 1
  ds_write_b32 v246, v244
  s_mov_b64 exec, -1
L_ntw_front_kernel:
  s_waitcnt lgkmcnt(0)
  s_barrier
  ds_read_b32 v244, v246
  ds_read_b128 v[36:39], v27
  ds_read_b128 v[176:179], v15 offset:0
  ds_read_b128 v[180:183], v15 offset:1024
  ds_read_b128 v[184:187], v15 offset:2048
  ds_read_b128 v[188:191], v15 offset:3072
  s_waitcnt lgkmcnt(4)
  v_max_f32 v25, v32, v36
  v_max_f32 v26, v34, v38
  v_sub_f32 v32, v32, v25
  v_sub_f32 v36, v36, v25
  v_sub_f32 v34, v34, v26
  v_sub_f32 v38, v38, v26
  v_exp_f32 v32, v32
  v_exp_f32 v36, v36
  v_exp_f32 v34, v34
  v_exp_f32 v38, v38
  v_mul_f32 v33, v33, v32
  v_mul_f32 v35, v35, v34
  v_fmac_f32 v33, v36, v37
  v_fmac_f32 v35, v38, v39
  v_rcp_f32 v33, v33
  v_rcp_f32 v35, v35
  v_mul_f32 v40, v32, v33
  v_mul_f32 v42, v36, v33
  v_mul_f32 v41, v34, v35
  v_mul_f32 v43, v38, v35
  v_mul_f32 v64, v64, v40
  v_mul_f32 v65, v65, v40
  v_mul_f32 v66, v66, v40
  v_mul_f32 v67, v67, v40
  v_mul_f32 v68, v68, v41
  v_mul_f32 v69, v69, v41
  v_mul_f32 v70, v70, v41
  v_mul_f32 v71, v71, v41
  v_mul_f32 v72, v72, v40
  v_mul_f32 v73, v73, v40
  v_mul_f32 v74, v74, v40
  v_mul_f32 v75, v75, v40
  v_mul_f32 v76, v76, v41
  v_mul_f32 v77, v77, v41
  v_mul_f32 v78, v78, v41
  v_mul_f32 v79, v79, v41
  v_mul_f32 v80, v80, v40
  v_mul_f32 v81, v81, v40
  v_mul_f32 v82, v82, v40
  v_mul_f32 v83, v83, v40
  v_mul_f32 v84, v84, v41
  v_mul_f32 v85, v85, v41
  v_mul_f32 v86, v86, v41
  v_mul_f32 v87, v87, v41
  v_mul_f32 v88, v88, v40
  v_mul_f32 v89, v89, v40
  v_mul_f32 v90, v90, v40
  v_mul_f32 v91, v91, v40
  v_mul_f32 v92, v92, v41
  v_mul_f32 v93, v93, v41
  v_mul_f32 v94, v94, v41
  v_mul_f32 v95, v95, v41
  s_waitcnt lgkmcnt(0)
  s_mov_b32 s46, s39
  s_mov_b32 m0, s28
  s_nop 0
  buffer_load_dwordx4 v5, s[4:7], s25 offen offset:0 lds
  buffer_load_dwordx4 v5, s[4:7], s25 offen offset:1024 lds
  buffer_load_dwordx4 v5, s[4:7], s25 offen offset:2048 lds
  buffer_load_dwordx4 v5, s[4:7], s25 offen offset:3072 lds
  s_add_u32 s44, s25, 16777216
  s_sub_u32 s39, s26, 1
  s_cmp_eq_u32 s26, 0
  s_cselect_b32 s26, s27, s39
  s_cselect_b32 s27, 0x4000, s27
  s_lshl_b32 s25, s26, 15
  s_add_u32 s25, s25, s24
  s_add_u32 s25, s25, 33554432
  s_xor_b32 s28, s28, 0x8000
  v_lshlrev_b32 v48, 16, v176
  v_and_b32 v49, 0xffff0000, v176
  v_lshlrev_b32 v50, 16, v177
  v_and_b32 v51, 0xffff0000, v177
  v_lshlrev_b32 v52, 16, v178
  v_and_b32 v53, 0xffff0000, v178
  v_lshlrev_b32 v54, 16, v179
  v_and_b32 v55, 0xffff0000, v179
  v_fmac_f32 v64, v48, v42
  v_fmac_f32 v65, v49, v42
  v_fmac_f32 v66, v50, v42
  v_fmac_f32 v67, v51, v42
  v_fmac_f32 v72, v52, v42
  v_fmac_f32 v73, v53, v42
  v_fmac_f32 v74, v54, v42
  v_fmac_f32 v75, v55, v42
  v_cvt_pk_bf16_f32 v160, v64, v65
  v_cvt_pk_bf16_f32 v161, v66, v67
  v_cvt_pk_bf16_f32 v162, v72, v73
  v_cvt_pk_bf16_f32 v163, v74, v75
  buffer_store_dwordx4 v[160:163], v6, s[4:7], s38 offen offset:0 sc1
  v_lshlrev_b32 v48, 16, v180
  v_and_b32 v49, 0xffff0000, v180
  v_lshlrev_b32 v50, 16, v181
  v_and_b32 v51, 0xffff0000, v181
  v_lshlrev_b32 v52, 16, v182
  v_and_b32 v53, 0xffff0000, v182
  v_lshlrev_b32 v54, 16, v183
  v_and_b32 v55, 0xffff0000, v183
  v_fmac_f32 v68, v48, v43
  v_fmac_f32 v69, v49, v43
  v_fmac_f32 v70, v50, v43
  v_fmac_f32 v71, v51, v43
  v_fmac_f32 v76, v52, v43
  v_fmac_f32 v77, v53, v43
  v_fmac_f32 v78, v54, v43
  v_fmac_f32 v79, v55, v43
  v_cvt_pk_bf16_f32 v164, v68, v69
  v_cvt_pk_bf16_f32 v165, v70, v71
  v_cvt_pk_bf16_f32 v166, v76, v77
  v_cvt_pk_bf16_f32 v167, v78, v79
  buffer_store_dwordx4 v[164:167], v6, s[4:7], s46 offen offset:0 sc1
  v_lshlrev_b32 v48, 16, v184
  v_and_b32 v49, 0xffff0000, v184
  v_lshlrev_b32 v50, 16, v185
  v_and_b32 v51, 0xffff0000, v185
  v_lshlrev_b32 v52, 16, v186
  v_and_b32 v53, 0xffff0000, v186
  v_lshlrev_b32 v54, 16, v187
  v_and_b32 v55, 0xffff0000, v187
  v_fmac_f32 v80, v48, v42
  v_fmac_f32 v81, v49, v42
  v_fmac_f32 v82, v50, v42
  v_fmac_f32 v83, v51, v42
  v_fmac_f32 v88, v52, v42
  v_fmac_f32 v89, v53, v42
  v_fmac_f32 v90, v54, v42
  v_fmac_f32 v91, v55, v42
  v_cvt_pk_bf16_f32 v168, v80, v81
  v_cvt_pk_bf16_f32 v169, v82, v83
  v_cvt_pk_bf16_f32 v170, v88, v89
  v_cvt_pk_bf16_f32 v171, v90, v91
  buffer_store_dwordx4 v[168:171], v6, s[4:7], s38 offen offset:1024 sc1
  v_lshlrev_b32 v48, 16, v188
  v_and_b32 v49, 0xffff0000, v188
  v_lshlrev_b32 v50, 16, v189
  v_and_b32 v51, 0xffff0000, v189
  v_lshlrev_b32 v52, 16, v190
  v_and_b32 v53, 0xffff0000, v190
  v_lshlrev_b32 v54, 16, v191
  v_and_b32 v55, 0xffff0000, v191
  v_fmac_f32 v84, v48, v43
  v_fmac_f32 v85, v49, v43
  v_fmac_f32 v86, v50, v43
  v_fmac_f32 v87, v51, v43
  v_fmac_f32 v92, v52, v43
  v_fmac_f32 v93, v53, v43
  v_fmac_f32 v94, v54, v43
  v_fmac_f32 v95, v55, v43
  v_cvt_pk_bf16_f32 v172, v84, v85
  v_cvt_pk_bf16_f32 v173, v86, v87
  v_cvt_pk_bf16_f32 v174, v92, v93
  v_cvt_pk_bf16_f32 v175, v94, v95
  buffer_store_dwordx4 v[172:175], v6, s[4:7], s46 offen offset:1024 sc1
  s_add_u32 s32, s32, 1
  s_cmp_eq_u32 s32, 1
  s_cbranch_scc1 L_qb_front_kernel
  s_branch L_tail_front_kernel
L_rare0_front_kernel:
  v_max3_f32 v10, v48, v49, v50
  v_max3_f32 v12, v51, v56, v57
  v_max3_f32 v10, v10, v58, v59
  v_max_f32 v10, v10, v12
  v_max3_f32 v24, v52, v53, v54
  v_max3_f32 v12, v55, v60, v61
  v_max3_f32 v24, v24, v62, v63
  v_max_f32 v24, v24, v12
  v_mov_b32 v12, v10
  s_nop 1
  v_permlane16_swap_b32 v12, v10
  v_max_f32 v10, v10, v12
  v_mov_b32 v12, v10
  s_nop 1
  v_permlane32_swap_b32 v12, v10
  v_max_f32 v10, v10, v12
  v_mov_b32 v12, v24
  s_nop 1
  v_permlane16_swap_b32 v12, v24
  v_max_f32 v24, v24, v12
  v_mov_b32 v12, v24
  s_nop 1
  v_permlane32_swap_b32 v12, v24
  v_max_f32 v24, v24, v12
  v_add_f32 v10, s41, v10
  v_add_f32 v24, s41, v24
  s_cmp_lg_u64 s[34:35], 0
  s_mov_b64 s[34:35], 0
  s_cbranch_scc1 L_ra0_front_kernel
  v_max_f32 v10, 0, v10
  v_sub_f32 v25, 0, v10
  v_exp_f32 v25, v25
  v_max_f32 v24, 0, v24
  v_sub_f32 v26, 0, v24
  v_exp_f32 v26, v26
  s_nop 15
  v_mul_f32 v64, v64, v25
  v_mul_f32 v65, v65, v25
  v_mul_f32 v66, v66, v25
  v_mul_f32 v67, v67, v25
  v_mul_f32 v68, v68, v26
  v_mul_f32 v69, v69, v26
  v_mul_f32 v70, v70, v26
  v_mul_f32 v71, v71, v26
  v_mul_f32 v72, v72, v25
  v_mul_f32 v73, v73, v25
  v_mul_f32 v74, v74, v25
  v_mul_f32 v75, v75, v25
  v_mul_f32 v76, v76, v26
  v_mul_f32 v77, v77, v26
  v_mul_f32 v78, v78, v26
  v_mul_f32 v79, v79, v26
  v_mul_f32 v80, v80, v25
  v_mul_f32 v81, v81, v25
  v_mul_f32 v82, v82, v25
  v_mul_f32 v83, v83, v25
  v_mul_f32 v84, v84, v26
  v_mul_f32 v85, v85, v26
  v_mul_f32 v86, v86, v26
  v_mul_f32 v87, v87, v26
  v_mul_f32 v88, v88, v25
  v_mul_f32 v89, v89, v25
  v_mul_f32 v90, v90, v25
  v_mul_f32 v91, v91, v25
  v_mul_f32 v92, v92, v26
  v_mul_f32 v93, v93, v26
  v_mul_f32 v94, v94, v26
  v_mul_f32 v95, v95, v26
  v_mul_f32 v96, v96, v25
  v_mul_f32 v97, v97, v25
  v_mul_f32 v98, v98, v25
  v_mul_f32 v99, v99, v25
  v_mul_f32 v100, v100, v26
  v_mul_f32 v101, v101, v26
  v_mul_f32 v102, v102, v26
  v_mul_f32 v103, v103, v26
  v_mul_f32 v104, v104, v25
  v_mul_f32 v105, v105, v25
  v_mul_f32 v106, v106, v25
  v_mul_f32 v107, v107, v25
  v_mul_f32 v108, v108, v26
  v_mul_f32 v109, v109, v26
  v_mul_f32 v110, v110, v26
  v_mul_f32 v111, v111, v26
  v_mul_f32 v112, v112, v25
  v_mul_f32 v113, v113, v25
  v_mul_f32 v114, v114, v25
  v_mul_f32 v115, v115, v25
  v_mul_f32 v116, v116, v26
  v_mul_f32 v117, v117, v26
  v_mul_f32 v118, v118, v26
  v_mul_f32 v119, v119, v26
  v_mul_f32 v120, v120, v25
  v_mul_f32 v121, v121, v25
  v_mul_f32 v122, v122, v25
  v_mul_f32 v123, v123, v25
  v_mul_f32 v124, v124, v26
  v_mul_f32 v125, v125, v26
  v_mul_f32 v126, v126, v26
  v_mul_f32 v127, v127, v26
  v_mul_f32 v220, v220, v25
  v_mul_f32 v221, v221, v25
  v_mul_f32 v222, v222, v25
  v_mul_f32 v223, v223, v25
  v_mul_f32 v224, v224, v26
  v_mul_f32 v225, v225, v26
  v_mul_f32 v226, v226, v26
  v_mul_f32 v227, v227, v26
L_ra0_front_kernel:
  v_sub_f32 v48, v48, v10
  v_sub_f32 v49, v49, v10
  v_sub_f32 v50, v50, v10
  v_sub_f32 v51, v51, v10
  v_sub_f32 v52, v52, v24
  v_sub_f32 v53, v53, v24
  v_sub_f32 v54, v54, v24
  v_sub_f32 v55, v55, v24
  v_sub_f32 v56, v56, v10
  v_sub_f32 v57, v57, v10
  v_sub_f32 v58, v58, v10
  v_sub_f32 v59, v59, v10
  v_sub_f32 v60, v60, v24
  v_sub_f32 v61, v61, v24
  v_sub_f32 v62, v62, v24
  v_sub_f32 v63, v63, v24
  v_sub_f32 v32, v32, v10
  v_sub_f32 v33, v33, v10
  v_sub_f32 v34, v34, v10
  v_sub_f32 v35, v35, v10
  v_sub_f32 v36, v36, v24
  v_sub_f32 v37, v37, v24
  v_sub_f32 v38, v38, v24
  v_sub_f32 v39, v39, v24
  v_sub_f32 v40, v40, v10
  v_sub_f32 v41, v41, v10
  v_sub_f32 v42, v42, v10
  v_sub_f32 v43, v43, v10
  v_sub_f32 v44, v44, v24
  v_sub_f32 v45, v45, v24
  v_sub_f32 v46, v46, v24
  v_sub_f32 v47, v47, v24
  v_sub_f32 v16, v16, v10
  v_sub_f32 v17, v17, v10
  v_sub_f32 v18, v18, v10
  v_sub_f32 v19, v19, v10
  v_sub_f32 v20, v20, v24
  v_sub_f32 v21, v21, v24
  v_sub_f32 v22, v22, v24
  v_sub_f32 v23, v23, v24
  v_exp_f32 v212, v48
  v_exp_f32 v213, v49
  v_exp_f32 v214, v50
  v_cvt_pk_bf16_f32 v200, v212, v213
  v_exp_f32 v215, v51
  v_exp_f32 v216, v52
  v_cvt_pk_bf16_f32 v201, v214, v215
  v_exp_f32 v217, v53
  v_exp_f32 v218, v54
  v_cvt_pk_bf16_f32 v204, v216, v217
  v_exp_f32 v219, v55
  v_exp_f32 v212, v56
  v_cvt_pk_bf16_f32 v205, v218, v219
  v_exp_f32 v213, v57
  v_exp_f32 v214, v58
  v_cvt_pk_bf16_f32 v202, v212, v213
  v_exp_f32 v215, v59
  v_exp_f32 v216, v60
  v_cvt_pk_bf16_f32 v203, v214, v215
  v_exp_f32 v217, v61
  v_exp_f32 v218, v62
  v_cvt_pk_bf16_f32 v206, v216, v217
  v_exp_f32 v219, v63
  s_nop 0
  v_cvt_pk_bf16_f32 v207, v218, v219
  s_nop 1
  s_branch L_back0_front_kernel
L_rare1_front_kernel:
  v_max3_f32 v10, v32, v33, v34
  v_max3_f32 v12, v35, v40, v41
  v_max3_f32 v10, v10, v42, v43
  v_max_f32 v10, v10, v12
  v_max3_f32 v24, v36, v37, v38
  v_max3_f32 v12, v39, v44, v45
  v_max3_f32 v24, v24, v46, v47
  v_max_f32 v24, v24, v12
  v_mov_b32 v12, v10
  s_nop 1
  v_permlane16_swap_b32 v12, v10
  v_max_f32 v10, v10, v12
  v_mov_b32 v12, v10
  s_nop 1
  v_permlane32_swap_b32 v12, v10
  v_max_f32 v10, v10, v12
  v_mov_b32 v12, v24
  s_nop 1
  v_permlane16_swap_b32 v12, v24
  v_max_f32 v24, v24, v12
  v_mov_b32 v12, v24
  s_nop 1
  v_permlane32_swap_b32 v12, v24
  v_max_f32 v24, v24, v12
  v_add_f32 v10, s41, v10
  v_add_f32 v24, s41, v24
  s_cmp_lg_u64 s[34:35], 0
  s_mov_b64 s[34:35], 0
  s_cbranch_scc1 L_ra1_front_kernel
  v_max_f32 v10, 0, v10
  v_sub_f32 v25, 0, v10
  v_exp_f32 v25, v25
  v_max_f32 v24, 0, v24
  v_sub_f32 v26, 0, v24
  v_exp_f32 v26, v26
  s_nop 15
  v_mul_f32 v64, v64, v25
  v_mul_f32 v65, v65, v25
  v_mul_f32 v66, v66, v25
  v_mul_f32 v67, v67, v25
  v_mul_f32 v68, v68, v26
  v_mul_f32 v69, v69, v26
  v_mul_f32 v70, v70, v26
  v_mul_f32 v71, v71, v26
  v_mul_f32 v72, v72, v25
  v_mul_f32 v73, v73, v25
  v_mul_f32 v74, v74, v25
  v_mul_f32 v75, v75, v25
  v_mul_f32 v76, v76, v26
  v_mul_f32 v77, v77, v26
  v_mul_f32 v78, v78, v26
  v_mul_f32 v79, v79, v26
  v_mul_f32 v80, v80, v25
  v_mul_f32 v81, v81, v25
  v_mul_f32 v82, v82, v25
  v_mul_f32 v83, v83, v25
  v_mul_f32 v84, v84, v26
  v_mul_f32 v85, v85, v26
  v_mul_f32 v86, v86, v26
  v_mul_f32 v87, v87, v26
  v_mul_f32 v88, v88, v25
  v_mul_f32 v89, v89, v25
  v_mul_f32 v90, v90, v25
  v_mul_f32 v91, v91, v25
  v_mul_f32 v92, v92, v26
  v_mul_f32 v93, v93, v26
  v_mul_f32 v94, v94, v26
  v_mul_f32 v95, v95, v26
  v_mul_f32 v96, v96, v25
  v_mul_f32 v97, v97, v25
  v_mul_f32 v98, v98, v25
  v_mul_f32 v99, v99, v25
  v_mul_f32 v100, v100, v26
  v_mul_f32 v101, v101, v26
  v_mul_f32 v102, v102, v26
  v_mul_f32 v103, v103, v26
  v_mul_f32 v104, v104, v25
  v_mul_f32 v105, v105, v25
  v_mul_f32 v106, v106, v25
  v_mul_f32 v107, v107, v25
  v_mul_f32 v108, v108, v26
  v_mul_f32 v109, v109, v26
  v_mul_f32 v110, v110, v26
  v_mul_f32 v111, v111, v26
  v_mul_f32 v112, v112, v25
  v_mul_f32 v113, v113, v25
  v_mul_f32 v114, v114, v25
  v_mul_f32 v115, v115, v25
  v_mul_f32 v116, v116, v26
  v_mul_f32 v117, v117, v26
  v_mul_f32 v118, v118, v26
  v_mul_f32 v119, v119, v26
  v_mul_f32 v120, v120, v25
  v_mul_f32 v121, v121, v25
  v_mul_f32 v122, v122, v25
  v_mul_f32 v123, v123, v25
  v_mul_f32 v124, v124, v26
  v_mul_f32 v125, v125, v26
  v_mul_f32 v126, v126, v26
  v_mul_f32 v127, v127, v26
  v_mul_f32 v220, v220, v25
  v_mul_f32 v221, v221, v25
  v_mul_f32 v222, v222, v25
  v_mul_f32 v223, v223, v25
  v_mul_f32 v224, v224, v26
  v_mul_f32 v225, v225, v26
  v_mul_f32 v226, v226, v26
  v_mul_f32 v227, v227, v26
L_ra1_front_kernel:
  v_sub_f32 v32, v32, v10
  v_sub_f32 v33, v33, v10
  v_sub_f32 v34, v34, v10
  v_sub_f32 v35, v35, v10
  v_sub_f32 v36, v36, v24
  v_sub_f32 v37, v37, v24
  v_sub_f32 v38, v38, v24
  v_sub_f32 v39, v39, v24
  v_sub_f32 v40, v40, v10
  v_sub_f32 v41, v41, v10
  v_sub_f32 v42, v42, v10
  v_sub_f32 v43, v43, v10
  v_sub_f32 v44, v44, v24
  v_sub_f32 v45, v45, v24
  v_sub_f32 v46, v46, v24
  v_sub_f32 v47, v47, v24
  v_sub_f32 v48, v48, v10
  v_sub_f32 v49, v49, v10
  v_sub_f32 v50, v50, v10
  v_sub_f32 v51, v51, v10
  v_sub_f32 v52, v52, v24
  v_sub_f32 v53, v53, v24
  v_sub_f32 v54, v54, v24
  v_sub_f32 v55, v55, v24
  v_sub_f32 v56, v56, v10
  v_sub_f32 v57, v57, v10
  v_sub_f32 v58, v58, v10
  v_sub_f32 v59, v59, v10
  v_sub_f32 v60, v60, v24
  v_sub_f32 v61, v61, v24
  v_sub_f32 v62, v62, v24
  v_sub_f32 v63, v63, v24
  v_sub_f32 v16, v16, v10
  v_sub_f32 v17, v17, v10
  v_sub_f32 v18, v18, v10
  v_sub_f32 v19, v19, v10
  v_sub_f32 v20, v20, v24
  v_sub_f32 v21, v21, v24
  v_sub_f32 v22, v22, v24
  v_sub_f32 v23, v23, v24
  v_exp_f32 v212, v32
  v_exp_f32 v213, v33
  v_exp_f32 v214, v34
  v_cvt_pk_bf16_f32 v192, v212, v213
  v_exp_f32 v215, v35
  v_exp_f32 v216, v36
  v_cvt_pk_bf16_f32 v193, v214, v215
  v_exp_f32 v217, v37
  v_exp_f32 v218, v38
  v_cvt_pk_bf16_f32 v196, v216, v217
  v_exp_f32 v219, v39
  v_exp_f32 v212, v40
  v_cvt_pk_bf16_f32 v197, v218, v219
  v_exp_f32 v213, v41
  v_exp_f32 v214, v42
  v_cvt_pk_bf16_f32 v194, v212, v213
  v_exp_f32 v215, v43
  v_exp_f32 v216, v44
  v_cvt_pk_bf16_f32 v195, v214, v215
  v_exp_f32 v217, v45
  v_exp_f32 v218, v46
  v_cvt_pk_bf16_f32 v198, v216, v217
  v_exp_f32 v219, v47
  s_nop 0
  v_cvt_pk_bf16_f32 v199, v218, v219
  s_nop 1
  s_branch L_back1_front_kernel
L_rare2_front_kernel:
  v_max3_f32 v10, v32, v33, v34
  v_max3_f32 v12, v35, v40, v41
  v_max3_f32 v10, v10, v42, v43
  v_max_f32 v10, v10, v12
  v_max3_f32 v24, v36, v37, v38
  v_max3_f32 v12, v39, v44, v45
  v_max3_f32 v24, v24, v46, v47
  v_max_f32 v24, v24, v12
  v_mov_b32 v12, v10
  s_nop 1
  v_permlane16_swap_b32 v12, v10
  v_max_f32 v10, v10, v12
  v_mov_b32 v12, v10
  s_nop 1
  v_permlane32_swap_b32 v12, v10
  v_max_f32 v10, v10, v12
  v_mov_b32 v12, v24
  s_nop 1
  v_permlane16_swap_b32 v12, v24
  v_max_f32 v24, v24, v12
  v_mov_b32 v12, v24
  s_nop 1
  v_permlane32_swap_b32 v12, v24
  v_max_f32 v24, v24, v12
  v_add_f32 v10, s41, v10
  v_add_f32 v24, s41, v24
  s_cmp_lg_u64 s[34:35], 0
  s_mov_b64 s[34:35], 0
  s_cbranch_scc1 L_ra2_front_kernel
  v_max_f32 v10, 0, v10
  v_sub_f32 v25, 0, v10
  v_exp_f32 v25, v25
  v_max_f32 v24, 0, v24
  v_sub_f32 v26, 0, v24
  v_exp_f32 v26, v26
  s_nop 15
  v_mul_f32 v64, v64, v25
  v_mul_f32 v65, v65, v25
  v_mul_f32 v66, v66, v25
  v_mul_f32 v67, v67, v25
  v_mul_f32 v68, v68, v26
  v_mul_f32 v69, v69, v26
  v_mul_f32 v70, v70, v26
  v_mul_f32 v71, v71, v26
  v_mul_f32 v72, v72, v25
  v_mul_f32 v73, v73, v25
  v_mul_f32 v74, v74, v25
  v_mul_f32 v75, v75, v25
  v_mul_f32 v76, v76, v26
  v_mul_f32 v77, v77, v26
  v_mul_f32 v78, v78, v26
  v_mul_f32 v79, v79, v26
  v_mul_f32 v80, v80, v25
  v_mul_f32 v81, v81, v25
  v_mul_f32 v82, v82, v25
  v_mul_f32 v83, v83, v25
  v_mul_f32 v84, v84, v26
  v_mul_f32 v85, v85, v26
  v_mul_f32 v86, v86, v26
  v_mul_f32 v87, v87, v26
  v_mul_f32 v88, v88, v25
  v_mul_f32 v89, v89, v25
  v_mul_f32 v90, v90, v25
  v_mul_f32 v91, v91, v25
  v_mul_f32 v92, v92, v26
  v_mul_f32 v93, v93, v26
  v_mul_f32 v94, v94, v26
  v_mul_f32 v95, v95, v26
  v_mul_f32 v96, v96, v25
  v_mul_f32 v97, v97, v25
  v_mul_f32 v98, v98, v25
  v_mul_f32 v99, v99, v25
  v_mul_f32 v100, v100, v26
  v_mul_f32 v101, v101, v26
  v_mul_f32 v102, v102, v26
  v_mul_f32 v103, v103, v26
  v_mul_f32 v104, v104, v25
  v_mul_f32 v105, v105, v25
  v_mul_f32 v106, v106, v25
  v_mul_f32 v107, v107, v25
  v_mul_f32 v108, v108, v26
  v_mul_f32 v109, v109, v26
  v_mul_f32 v110, v110, v26
  v_mul_f32 v111, v111, v26
  v_mul_f32 v112, v112, v25
  v_mul_f32 v113, v113, v25
  v_mul_f32 v114, v114, v25
  v_mul_f32 v115, v115, v25
  v_mul_f32 v116, v116, v26
  v_mul_f32 v117, v117, v26
  v_mul_f32 v118, v118, v26
  v_mul_f32 v119, v119, v26
  v_mul_f32 v120, v120, v25
  v_mul_f32 v121, v121, v25
  v_mul_f32 v122, v122, v25
  v_mul_f32 v123, v123, v25
  v_mul_f32 v124, v124, v26
  v_mul_f32 v125, v125, v26
  v_mul_f32 v126, v126, v26
  v_mul_f32 v127, v127, v26
  v_mul_f32 v220, v220, v25
  v_mul_f32 v221, v221, v25
  v_mul_f32 v222, v222, v25
  v_mul_f32 v223, v223, v25
  v_mul_f32 v224, v224, v26
  v_mul_f32 v225, v225, v26
  v_mul_f32 v226, v226, v26
  v_mul_f32 v227, v227, v26
L_ra2_front_kernel:
  v_sub_f32 v32, v32, v10
  v_sub_f32 v33, v33, v10
  v_sub_f32 v34, v34, v10
  v_sub_f32 v35, v35, v10
  v_sub_f32 v36, v36, v24
  v_sub_f32 v37, v37, v24
  v_sub_f32 v38, v38, v24
  v_sub_f32 v39, v39, v24
  v_sub_f32 v40, v40, v10
  v_sub_f32 v41, v41, v10
  v_sub_f32 v42, v42, v10
  v_sub_f32 v43, v43, v10
  v_sub_f32 v44, v44, v24
  v_sub_f32 v45, v45, v24
  v_sub_f32 v46, v46, v24
  v_sub_f32 v47, v47, v24
  v_sub_f32 v48, v48, v10
  v_sub_f32 v49, v49, v10
  v_sub_f32 v50, v50, v10
  v_sub_f32 v51, v51, v10
  v_sub_f32 v52, v52, v24
  v_sub_f32 v53, v53, v24
  v_sub_f32 v54, v54, v24
  v_sub_f32 v55, v55, v24
  v_sub_f32 v56, v56, v10
  v_sub_f32 v57, v57, v10
  v_sub_f32 v58, v58, v10
  v_sub_f32 v59, v59, v10
  v_sub_f32 v60, v60, v24
  v_sub_f32 v61, v61, v24
  v_sub_f32 v62, v62, v24
  v_sub_f32 v63, v63, v24
  v_sub_f32 v16, v16, v10
  v_sub_f32 v17, v17, v10
  v_sub_f32 v18, v18, v10
  v_sub_f32 v19, v19, v10
  v_sub_f32 v20, v20, v24
  v_sub_f32 v21, v21, v24
  v_sub_f32 v22, v22, v24
  v_sub_f32 v23, v23, v24
  v_exp_f32 v212, v32
  v_exp_f32 v213, v33
  v_exp_f32 v214, v34
  v_cvt_pk_bf16_f32 v192, v212, v213
  v_exp_f32 v215, v35
  v_exp_f32 v216, v36
  v_cvt_pk_bf16_f32 v193, v214, v215
  v_exp_f32 v217, v37
  v_exp_f32 v218, v38
  v_cvt_pk_bf16_f32 v196, v216, v217
  v_exp_f32 v219, v39
  v_exp_f32 v212, v40
  v_cvt_pk_bf16_f32 v197, v218, v219
  v_exp_f32 v213, v41
  v_exp_f32 v214, v42
  v_cvt_pk_bf16_f32 v194, v212, v213
  v_exp_f32 v215, v43
  v_exp_f32 v216, v44
  v_cvt_pk_bf16_f32 v195, v214, v215
  v_exp_f32 v217, v45
  v_exp_f32 v218, v46
  v_cvt_pk_bf16_f32 v198, v216, v217
  v_exp_f32 v219, v47
  s_nop 0
  v_cvt_pk_bf16_f32 v199, v218, v219
  s_nop 1
  s_branch L_back2_front_kernel
L_rare3_front_kernel:
  v_max3_f32 v10, v48, v49, v50
  v_max3_f32 v12, v51, v56, v57
  v_max3_f32 v10, v10, v58, v59
  v_max_f32 v10, v10, v12
  v_max3_f32 v24, v52, v53, v54
  v_max3_f32 v12, v55, v60, v61
  v_max3_f32 v24, v24, v62, v63
  v_max_f32 v24, v24, v12
  v_mov_b32 v12, v10
  s_nop 1
  v_permlane16_swap_b32 v12, v10
  v_max_f32 v10, v10, v12
  v_mov_b32 v12, v10
  s_nop 1
  v_permlane32_swap_b32 v12, v10
  v_max_f32 v10, v10, v12
  v_mov_b32 v12, v24
  s_nop 1
  v_permlane16_swap_b32 v12, v24
  v_max_f32 v24, v24, v12
  v_mov_b32 v12, v24
  s_nop 1
  v_permlane32_swap_b32 v12, v24
  v_max_f32 v24, v24, v12
  v_add_f32 v10, s41, v10
  v_add_f32 v24, s41, v24
  s_cmp_lg_u64 s[34:35], 0
  s_mov_b64 s[34:35], 0
  s_cbranch_scc1 L_ra3_front_kernel
  v_max_f32 v10, 0, v10
  v_sub_f32 v25, 0, v10
  v_exp_f32 v25, v25
  v_max_f32 v24, 0, v24
  v_sub_f32 v26, 0, v24
  v_exp_f32 v26, v26
  s_nop 15
  v_mul_f32 v64, v64, v25
  v_mul_f32 v65, v65, v25
  v_mul_f32 v66, v66, v25
  v_mul_f32 v67, v67, v25
  v_mul_f32 v68, v68, v26
  v_mul_f32 v69, v69, v26
  v_mul_f32 v70, v70, v26
  v_mul_f32 v71, v71, v26
  v_mul_f32 v72, v72, v25
  v_mul_f32 v73, v73, v25
  v_mul_f32 v74, v74, v25
  v_mul_f32 v75, v75, v25
  v_mul_f32 v76, v76, v26
  v_mul_f32 v77, v77, v26
  v_mul_f32 v78, v78, v26
  v_mul_f32 v79, v79, v26
  v_mul_f32 v80, v80, v25
  v_mul_f32 v81, v81, v25
  v_mul_f32 v82, v82, v25
  v_mul_f32 v83, v83, v25
  v_mul_f32 v84, v84, v26
  v_mul_f32 v85, v85, v26
  v_mul_f32 v86, v86, v26
  v_mul_f32 v87, v87, v26
  v_mul_f32 v88, v88, v25
  v_mul_f32 v89, v89, v25
  v_mul_f32 v90, v90, v25
  v_mul_f32 v91, v91, v25
  v_mul_f32 v92, v92, v26
  v_mul_f32 v93, v93, v26
  v_mul_f32 v94, v94, v26
  v_mul_f32 v95, v95, v26
  v_mul_f32 v96, v96, v25
  v_mul_f32 v97, v97, v25
  v_mul_f32 v98, v98, v25
  v_mul_f32 v99, v99, v25
  v_mul_f32 v100, v100, v26
  v_mul_f32 v101, v101, v26
  v_mul_f32 v102, v102, v26
  v_mul_f32 v103, v103, v26
  v_mul_f32 v104, v104, v25
  v_mul_f32 v105, v105, v25
  v_mul_f32 v106, v106, v25
  v_mul_f32 v107, v107, v25
  v_mul_f32 v108, v108, v26
  v_mul_f32 v109, v109, v26
  v_mul_f32 v110, v110, v26
  v_mul_f32 v111, v111, v26
  v_mul_f32 v112, v112, v25
  v_mul_f32 v113, v113, v25
  v_mul_f32 v114, v114, v25
  v_mul_f32 v115, v115, v25
  v_mul_f32 v116, v116, v26
  v_mul_f32 v117, v117, v26
  v_mul_f32 v118, v118, v26
  v_mul_f32 v119, v119, v26
  v_mul_f32 v120, v120, v25
  v_mul_f32 v121, v121, v25
  v_mul_f32 v122, v122, v25
  v_mul_f32 v123, v123, v25
  v_mul_f32 v124, v124, v26
  v_mul_f32 v125, v125, v26
  v_mul_f32 v126, v126, v26
  v_mul_f32 v127, v127, v26
  v_mul_f32 v220, v220, v25
  v_mul_f32 v221, v221, v25
  v_mul_f32 v222, v222, v25
  v_mul_f32 v223, v223, v25
  v_mul_f32 v224, v224, v26
  v_mul_f32 v225, v225, v26
  v_mul_f32 v226, v226, v26
  v_mul_f32 v227, v227, v26
L_ra3_front_kernel:
  v_sub_f32 v48, v48, v10
  v_sub_f32 v49, v49, v10
  v_sub_f32 v50, v50, v10
  v_sub_f32 v51, v51, v10
  v_sub_f32 v52, v52, v24
  v_sub_f32 v53, v53, v24
  v_sub_f32 v54, v54, v24
  v_sub_f32 v55, v55, v24
  v_sub_f32 v56, v56, v10
  v_sub_f32 v57, v57, v10
  v_sub_f32 v58, v58, v10
  v_sub_f32 v59, v59, v10
  v_sub_f32 v60, v60, v24
  v_sub_f32 v61, v61, v24
  v_sub_f32 v62, v62, v24
  v_sub_f32 v63, v63, v24
  v_sub_f32 v16, v16, v10
  v_sub_f32 v17, v17, v10
  v_sub_f32 v18, v18, v10
  v_sub_f32 v19, v19, v10
  v_sub_f32 v20, v20, v24
  v_sub_f32 v21, v21, v24
  v_sub_f32 v22, v22, v24
  v_sub_f32 v23, v23, v24
  v_exp_f32 v212, v48
  v_exp_f32 v213, v49
  v_exp_f32 v214, v50
  v_cvt_pk_bf16_f32 v200, v212, v213
  v_exp_f32 v215, v51
  v_exp_f32 v216, v52
  v_cvt_pk_bf16_f32 v201, v214, v215
  v_exp_f32 v217, v53
  v_exp_f32 v218, v54
  v_cvt_pk_bf16_f32 v204, v216, v217
  v_exp_f32 v219, v55
  v_exp_f32 v212, v56
  v_cvt_pk_bf16_f32 v205, v218, v219
  v_exp_f32 v213, v57
  v_exp_f32 v214, v58
  v_cvt_pk_bf16_f32 v202, v212, v213
  v_exp_f32 v215, v59
  v_exp_f32 v216, v60
  v_cvt_pk_bf16_f32 v203, v214, v215
  v_exp_f32 v217, v61
  v_exp_f32 v218, v62
  v_cvt_pk_bf16_f32 v206, v216, v217
  v_exp_f32 v219, v63
  s_nop 0
  v_cvt_pk_bf16_f32 v207, v218, v219
  s_nop 1
  s_branch L_back3_front_kernel
L_tail_front_kernel:
  v_readfirstlane_b32 s45, v244
  s_mov_b64 s[92:93], s[52:53]
  s_mov_b32 s94, s54
  s_mov_b32 s95, 0x00020000
  s_and_b32 s30, s2, 7
  s_mul_i32 s32, s45, 171
  s_lshr_b32 s32, s32, 9
  s_mul_i32 s41, s32, 3
  s_sub_u32 s41, s45, s41
  s_and_b32 s31, s30, 1
  s_lshl_b32 s31, s31, 3
  s_add_u32 s32, s32, s31
  s_lshr_b32 s30, s30, 1
  s_lshl_b32 s43, s32, 2
  s_add_u32 s43, s43, s30
  s_lshl_b32 s43, s43, 7
  s_add_u32 s43, s43, 38912
  s_lshl_b32 s96, s32, 7
  s_add_u32 s96, s96, 47104
  s_mov_b32 s97, 1
  v_mov_b32 v245, 0
  v_mov_b32 v246, 163584
  s_mul_i32 s36, s32, 1048576
  s_lshl_b32 s31, s30, 15
  s_add_u32 s36, s36, s31
  s_add_u32 s36, s36, 67108864
  s_mul_i32 s37, s30, 1179648
  s_mul_i32 s31, s41, 384
  s_add_u32 s37, s37, s31
  s_mul_i32 s27, s30, 2359296
  s_mul_i32 s25, s32, 147456
  s_add_u32 s27, s27, s25
  s_add_u32 s27, s27, s31
  s_add_u32 s27, s27, 83886080
  s_mov_b64 s[8:9], s[60:61]
  s_mov_b32 s10, s62
  s_mov_b32 s11, 0x00020000
  s_mov_b64 s[12:13], s[4:5]
  s_mov_b32 s14, s6
  s_mov_b32 s15, 0x00020000
  s_waitcnt vmcnt(0)
  s_barrier
  s_cmp_lg_u32 s20, 2
  s_cbranch_scc1 L_o18_front_kernel
  s_lshr_b32 s38, s33, 3
  s_lshl_b32 s39, s101, 2
  s_add_u32 s39, s39, s38
  s_lshl_b32 s39, s39, 7
  s_add_u32 s39, s39, 38912
  s_and_b32 s38, s33, 7
  s_lshl_b32 s38, 1, s38
  v_mov_b32 v251, 0
  v_mov_b32 v250, s38
  s_mov_b64 exec, 1
  buffer_atomic_add v250, v251, s[4:7], s39 offen sc1
  s_mov_b64 exec, -1
L_o18_front_kernel:
  s_cmp_ge_u32 s45, 24
  s_cbranch_scc1 L_side_front_kernel
  s_cmp_lg_u32 s20, 4
  s_cbranch_scc1 L_o19_front_kernel
  buffer_load_dword v248, v245, s[4:7], s43 offen sc1
L_o19_front_kernel:
  s_cmp_ge_u32 s20, 4
  s_cbranch_scc0 L_cons_oprj
  s_sub_u32 s20, s20, 4
  s_lshl_b32 s23, s20, 10
  s_lshr_b32 s30, s20, 1
  s_and_b32 s31, s20, 1
  s_mul_i32 s30, s30, 131072
  s_lshl_b32 s31, s31, 10
  s_add_u32 s30, s30, s31
  v_lshlrev_b32 v2, 4, v1
  v_add_u32 v2, s30, v2
  s_mov_b32 s50, 0
  s_mul_i32 s30, s50, 262144
  s_lshl_b32 s50, s50, 12
  v_add_u32 v8, s30, v2
  s_mov_b32 s51, 1
  s_mul_i32 s30, s51, 262144
  s_lshl_b32 s51, s51, 12
  v_add_u32 v9, s30, v2
  s_mov_b32 s52, 2
  s_mul_i32 s30, s52, 262144
  s_lshl_b32 s52, s52, 12
  v_add_u32 v10, s30, v2
  s_mov_b32 s53, 3
  s_mul_i32 s30, s53, 262144
  s_lshl_b32 s53, s53, 12
  v_add_u32 v11, s30, v2
  s_waitcnt lgkmcnt(0)
  s_mov_b32 s31, 0
  v_lshrrev_b32 v2, 3, v1
  v_bfe_u32 v3, v2, 2, 1
  v_bfe_u32 v4, v2, 1, 1
  v_lshl_add_u32 v3, v3, 1, v4
  v_bfe_u32 v4, v1, 1, 2
  v_xor_b32 v3, v3, v4
  v_and_b32 v4, 1, v1
  v_lshlrev_b32 v4, 4, v4
  v_lshl_add_u32 v3, v3, 5, v4
  s_mov_b32 s30, 1152
  v_mad_u32_u24 v5, v2, s30, v3
  v_xor_b32 v2, 64, v5
  s_mov_b32 s54, 0
  s_lshl_b32 s24, s54, 2
  s_add_u32 s24, s24, s20
  s_lshl_b32 s54, s54, 12
  s_add_u32 s54, s54, 16384
  s_mul_i32 s25, s24, 171
  s_lshr_b32 s25, s25, 9
  s_mul_i32 s26, s25, 3
  s_sub_u32 s26, s24, s26
  s_mul_i32 s30, s25, 9216
  s_lshl_b32 s26, s26, 7
  s_add_u32 s30, s30, s26
  s_bitcmp1_b32 s25, 0
  s_cselect_b64 vcc, -1, 0
  v_cndmask_b32 v12, v5, v2, vcc
  v_add_u32 v12, s30, v12
  s_mov_b32 s55, 1
  s_lshl_b32 s24, s55, 2
  s_add_u32 s24, s24, s20
  s_lshl_b32 s55, s55, 12
  s_add_u32 s55, s55, 16384
  s_mul_i32 s25, s24, 171
  s_lshr_b32 s25, s25, 9
  s_mul_i32 s26, s25, 3
  s_sub_u32 s26, s24, s26
  s_mul_i32 s30, s25, 9216
  s_lshl_b32 s26, s26, 7
  s_add_u32 s30, s30, s26
  s_bitcmp1_b32 s25, 0
  s_cselect_b64 vcc, -1, 0
  v_cndmask_b32 v13, v5, v2, vcc
  v_add_u32 v13, s30, v13
  s_mov_b32 s56, 2
  s_lshl_b32 s24, s56, 2
  s_add_u32 s24, s24, s20
  s_lshl_b32 s56, s56, 12
  s_add_u32 s56, s56, 16384
  s_mul_i32 s25, s24, 171
  s_lshr_b32 s25, s25, 9
  s_mul_i32 s26, s25, 3
  s_sub_u32 s26, s24, s26
  s_mul_i32 s30, s25, 9216
  s_lshl_b32 s26, s26, 7
  s_add_u32 s30, s30, s26
  s_bitcmp1_b32 s25, 0
  s_cselect_b64 vcc, -1, 0
  v_cndmask_b32 v14, v5, v2, vcc
  v_add_u32 v14, s30, v14
  s_mov_b32 s57, 3
  s_lshl_b32 s24, s57, 2
  s_add_u32 s24, s24, s20
  s_lshl_b32 s57, s57, 12
  s_add_u32 s57, s57, 16384
  s_mul_i32 s25, s24, 171
  s_lshr_b32 s25, s25, 9
  s_mul_i32 s26, s25, 3
  s_sub_u32 s26, s24, s26
  s_mul_i32 s30, s25, 9216
  s_lshl_b32 s26, s26, 7
  s_add_u32 s30, s30, s26
  s_bitcmp1_b32 s25, 0
  s_cselect_b64 vcc, -1, 0
  v_cndmask_b32 v15, v5, v2, vcc
  v_add_u32 v15, s30, v15
  s_mov_b32 s58, 4
  s_lshl_b32 s24, s58, 2
  s_add_u32 s24, s24, s20
  s_lshl_b32 s58, s58, 12
  s_add_u32 s58, s58, 16384
  s_mul_i32 s25, s24, 171
  s_lshr_b32 s25, s25, 9
  s_mul_i32 s26, s25, 3
  s_sub_u32 s26, s24, s26
  s_mul_i32 s30, s25, 9216
  s_lshl_b32 s26, s26, 7
  s_add_u32 s30, s30, s26
  s_bitcmp1_b32 s25, 0
  s_cselect_b64 vcc, -1, 0
  v_cndmask_b32 v16, v5, v2, vcc
  v_add_u32 v16, s30, v16
  s_mov_b32 s59, 5
  s_lshl_b32 s24, s59, 2
  s_add_u32 s24, s24, s20
  s_lshl_b32 s59, s59, 12
  s_add_u32 s59, s59, 16384
  s_mul_i32 s25, s24, 171
  s_lshr_b32 s25, s25, 9
  s_mul_i32 s26, s25, 3
  s_sub_u32 s26, s24, s26
  s_mul_i32 s30, s25, 9216
  s_lshl_b32 s26, s26, 7
  s_add_u32 s30, s30, s26
  s_bitcmp1_b32 s25, 0
  s_cselect_b64 vcc, -1, 0
  v_cndmask_b32 v17, v5, v2, vcc
  v_add_u32 v17, s30, v17
  s_mov_b32 s38, 0
  v_mov_b32 v30, 0
  v_mov_b32 v31, 163584
  s_cmp_lg_u32 s20, 0
  s_cbranch_scc1 L_s1_oprj
  s_waitcnt vmcnt(0)
  v_readfirstlane_b32 s30, v248
L_s0_oprj:
  s_nop 0
  s_and_b32 s31, s30, 3
  s_bcnt1_i32_b32 s31, s31
  s_cmp_ge_u32 s31, 2
  s_cbranch_scc1 L_s2_oprj
  s_add_u32 s100, s100, 1
  s_cmp_gt_u32 s100, 0x20000
  s_cbranch_scc1 L_end_front_kernel
  s_sleep 2
  buffer_load_dword v24, v30, s[4:7], s43 offen sc1
  s_waitcnt vmcnt(0)
  v_readfirstlane_b32 s30, v24
  s_branch L_s0_oprj
L_s2_oprj:
  s_nop 0
  v_mov_b32 v29, s30
  ds_write_b32 v31, v29
  s_waitcnt lgkmcnt(0)
L_s1_oprj:
  s_barrier
  ds_read_b32 v28, v31
  s_waitcnt lgkmcnt(0)
  v_readfirstlane_b32 s39, v28
  s_ff0_i32_b32 s31, s38
  s_bitset1_b32 s38, s31
  s_lshl_b32 s30, s31, 12
  s_add_u32 s21, s36, s30
  s_mul_i32 s30, s31, 147456
  s_add_u32 s22, s37, s30
  s_add_u32 m0, s23, s50
  s_nop 0
  buffer_load_dwordx4 v8, s[4:7], s21 offen lds
  s_add_u32 m0, s23, s51
  s_nop 0
  buffer_load_dwordx4 v9, s[4:7], s21 offen lds
  s_add_u32 m0, s23, s52
  s_nop 0
  buffer_load_dwordx4 v10, s[4:7], s21 offen lds
  s_add_u32 m0, s23, s53
  s_nop 0
  buffer_load_dwordx4 v11, s[4:7], s21 offen lds
  s_add_u32 m0, s23, s54
  s_nop 0
  buffer_load_dwordx4 v12, s[8:11], s22 offen lds
  s_add_u32 m0, s23, s55
  s_nop 0
  buffer_load_dwordx4 v13, s[8:11], s22 offen lds
  s_add_u32 m0, s23, s56
  s_nop 0
  buffer_load_dwordx4 v14, s[8:11], s22 offen lds
  s_add_u32 m0, s23, s57
  s_nop 0
  buffer_load_dwordx4 v15, s[8:11], s22 offen lds
  s_add_u32 m0, s23, s58
  s_nop 0
  buffer_load_dwordx4 v16, s[8:11], s22 offen lds
  s_add_u32 m0, s23, s59
  s_nop 0
  buffer_load_dwordx4 v17, s[8:11], s22 offen lds
  s_add_u32 s21, s21, 2048
  s_add_u32 s22, s22, 73728
  s_add_u32 s23, s23, 40960
  s_sub_u32 s30, s23, 122880
  s_cmp_ge_u32 s23, 122880
  s_cselect_b32 s23, s30, s23
  s_waitcnt vmcnt(0)
  s_barrier
  s_mov_b32 s28, 15
  s_mov_b32 s29, 1
L_lloop_oprj:
  s_bitcmp0_b32 s28, 0
  s_cbranch_scc0 L_np_oprj
  s_cmp_eq_u32 s39, 0xff
  s_cbranch_scc1 L_nf_oprj
  s_cmp_lg_u32 s20, 0
  s_cbranch_scc1 L_nf_oprj
  buffer_load_dword v24, v30, s[4:7], s43 offen sc1
L_nf_oprj:
  s_ff0_i32_b32 s31, s38
  s_bitset1_b32 s38, s31
  s_lshl_b32 s30, s31, 12
  s_add_u32 s21, s36, s30
  s_mul_i32 s30, s31, 147456
  s_add_u32 s22, s37, s30
L_np_oprj:
  s_add_u32 m0, s23, s54
  s_nop 0
  buffer_load_dwordx4 v12, s[8:11], s22 offen lds
  s_add_u32 m0, s23, s55
  s_nop 0
  buffer_load_dwordx4 v13, s[8:11], s22 offen lds
  s_add_u32 m0, s23, s56
  s_nop 0
  buffer_load_dwordx4 v14, s[8:11], s22 offen lds
  s_add_u32 m0, s23, s57
  s_nop 0
  buffer_load_dwordx4 v15, s[8:11], s22 offen lds
  s_add_u32 m0, s23, s58
  s_nop 0
  buffer_load_dwordx4 v16, s[8:11], s22 offen lds
  s_add_u32 m0, s23, s59
  s_nop 0
  buffer_load_dwordx4 v17, s[8:11], s22 offen lds
  s_add_u32 m0, s23, s50
  s_nop 0
  buffer_load_dwordx4 v8, s[4:7], s21 offen lds
  s_add_u32 m0, s23, s51
  s_nop 0
  buffer_load_dwordx4 v9, s[4:7], s21 offen lds
  s_add_u32 m0, s23, s52
  s_nop 0
  buffer_load_dwordx4 v10, s[4:7], s21 offen lds
  s_add_u32 m0, s23, s53
  s_nop 0
  buffer_load_dwordx4 v11, s[4:7], s21 offen lds
  s_add_u32 s21, s21, 2048
  s_add_u32 s22, s22, 73728
  s_add_u32 s23, s23, 40960
  s_sub_u32 s30, s23, 122880
  s_cmp_ge_u32 s23, 122880
  s_cselect_b32 s23, s30, s23
  s_sub_u32 s28, s28, 1
  s_sub_u32 s29, s29, 1
  s_cmp_ge_i32 s29, 0
  s_cbranch_scc1 L_lloop_oprj
  s_waitcnt vmcnt(10)
  s_cmp_eq_u32 s39, 0xff
  s_cbranch_scc1 L_pb_oprj
  s_bitcmp0_b32 s28, 0
  s_cbranch_scc0 L_pb_oprj
  s_cmp_eq_u32 s28, 0
  s_cbranch_scc1 L_pb_oprj
  s_cmp_lg_u32 s20, 0
  s_cbranch_scc1 L_rb_oprj
L_ck_oprj:
  v_readfirstlane_b32 s30, v24
  s_ff0_i32_b32 s31, s38
  s_bitcmp1_b32 s30, s31
  s_cbranch_scc1 L_pub_oprj
  s_add_u32 s100, s100, 1
  s_cmp_gt_u32 s100, 0x20000
  s_cbranch_scc1 L_end_front_kernel
  s_sleep 2
  buffer_load_dword v24, v30, s[4:7], s43 offen sc1
  s_waitcnt vmcnt(0)
  s_branch L_ck_oprj
L_pub_oprj:
  v_mov_b32 v29, s30
  ds_write_b32 v31, v29
  s_waitcnt lgkmcnt(0)
L_rb_oprj:
  s_barrier
  ds_read_b32 v28, v31
  s_waitcnt lgkmcnt(0)
  v_readfirstlane_b32 s39, v28
  s_branch L_lloop_oprj
L_pb_oprj:
  s_barrier
  s_cmp_lg_u32 s28, 0
  s_cbranch_scc1 L_lloop_oprj
  s_mov_b32 s34, 40960
  s_lshl_b32 s30, s20, 6
  s_add_u32 s30, s30, 256
  v_add_u32 v32, s30, v1
  s_movk_i32 s30, 2731
  s_movk_i32 s31, 1152
  v_add_u32 v37, 1024, v32
  v_mul_u32_u24 v34, s30, v37
  v_lshrrev_b32 v34, 16, v34
  v_mul_u32_u24 v3, 24, v34
  v_sub_u32 v3, v37, v3
  v_lshlrev_b32 v3, 4, v3
  v_mad_u32_u24 v37, v34, s31, v3
  v_mul_u32_u24 v34, 400, v34
  v_add3_u32 v34, v34, v3, s34
  v_add_u32 v36, 512, v32
  v_mul_u32_u24 v33, s30, v36
  v_lshrrev_b32 v33, 16, v33
  v_mul_u32_u24 v3, 24, v33
  v_sub_u32 v3, v36, v3
  v_lshlrev_b32 v3, 4, v3
  v_mad_u32_u24 v36, v33, s31, v3
  v_mul_u32_u24 v33, 400, v33
  v_add3_u32 v33, v33, v3, s34
  v_mov_b32 v35, v32
  v_mul_u32_u24 v32, s30, v35
  v_lshrrev_b32 v32, 16, v32
  v_mul_u32_u24 v3, 24, v32
  v_sub_u32 v3, v35, v3
  v_lshlrev_b32 v3, 4, v3
  v_mad_u32_u24 v35, v32, s31, v3
  v_mul_u32_u24 v32, 400, v32
  v_add3_u32 v32, v32, v3, s34
  s_waitcnt vmcnt(0)
  s_barrier
  s_waitcnt vmcnt(0)
  s_barrier
  s_add_u32 s34, s27, 73728
  s_barrier
  ds_read_b128 v[48:51], v32 offset:0
  ds_read_b128 v[52:55], v33 offset:0
  ds_read_b128 v[56:59], v34 offset:0
  ds_read_b128 v[60:63], v32 offset:25600
  ds_read_b128 v[64:67], v33 offset:25600
  ds_read_b128 v[68:71], v34 offset:25600
  s_waitcnt lgkmcnt(5)
  buffer_store_dwordx4 v[48:51], v35, s[12:15], s27 offen sc1
  s_waitcnt lgkmcnt(4)
  buffer_store_dwordx4 v[52:55], v36, s[12:15], s27 offen sc1
  s_waitcnt lgkmcnt(3)
  buffer_store_dwordx4 v[56:59], v37, s[12:15], s27 offen sc1
  s_waitcnt lgkmcnt(2)
  buffer_store_dwordx4 v[60:63], v35, s[12:15], s34 offen sc1
  s_waitcnt lgkmcnt(1)
  buffer_store_dwordx4 v[64:67], v36, s[12:15], s34 offen sc1
  s_waitcnt lgkmcnt(0)
  buffer_store_dwordx4 v[68:71], v37, s[12:15], s34 offen sc1
  s_add_u32 s20, s20, 4
  s_branch L_phL_front_kernel
L_cons_oprj:
  s_and_b32 s28, s20, 1
  s_lshr_b32 s29, s20, 1
  s_mul_i32 s30, s28, 8192
  v_lshlrev_b32 v2, 4, v1
  v_add_u32 v6, s30, v2
  v_lshrrev_b32 v2, 4, v1
  v_bfe_u32 v3, v1, 2, 2
  v_lshl_add_u32 v3, v2, 2, v3
  v_lshrrev_b32 v2, 1, v3
  v_xor_b32 v2, v2, v3
  v_bfe_u32 v2, v2, 2, 1
  v_bfe_u32 v4, v3, 1, 1
  v_lshl_add_u32 v2, v2, 1, v4
  v_lshrrev_b32 v4, 3, v3
  v_mul_u32_u24 v4, 3072, v4
  v_and_b32 v3, 7, v3
  v_lshl_add_u32 v4, v3, 7, v4
  v_and_b32 v3, 3, v1
  v_lshl_add_u32 v4, v3, 3, v4
  v_xor_b32 v3, 0, v2
  v_lshl_add_u32 v7, v3, 5, v4
  v_xor_b32 v3, 1, v2
  v_lshl_add_u32 v8, v3, 5, v4
  v_xor_b32 v3, 2, v2
  v_lshl_add_u32 v9, v3, 5, v4
  v_xor_b32 v3, 3, v2
  v_lshl_add_u32 v10, v3, 5, v4
  s_mul_i32 s31, s29, 96
  s_lshl_b32 s30, s29, 11
  s_add_u32 s30, s30, 16384
  v_xor_b32 v7, s31, v7
  v_add_u32 v7, s30, v7
  v_xor_b32 v8, s31, v8
  v_add_u32 v8, s30, v8
  v_xor_b32 v9, s31, v9
  v_add_u32 v9, s30, v9
  v_xor_b32 v10, s31, v10
  v_add_u32 v10, s30, v10
  s_mul_i32 s35, s29, -2048
  s_add_u32 s35, s35, 1024
  s_mov_b32 s24, 0
  s_mov_b32 s34, 40960
  s_lshl_b32 s30, s20, 6
  v_add_u32 v36, s30, v1
  s_movk_i32 s30, 2731
  s_movk_i32 s31, 1152
  v_add_u32 v41, 1024, v36
  v_mul_u32_u24 v38, s30, v41
  v_lshrrev_b32 v38, 16, v38
  v_mul_u32_u24 v3, 24, v38
  v_sub_u32 v3, v41, v3
  v_lshlrev_b32 v3, 4, v3
  v_mad_u32_u24 v41, v38, s31, v3
  v_mul_u32_u24 v38, 400, v38
  v_add3_u32 v38, v38, v3, s34
  v_add_u32 v40, 512, v36
  v_mul_u32_u24 v37, s30, v40
  v_lshrrev_b32 v37, 16, v37
  v_mul_u32_u24 v3, 24, v37
  v_sub_u32 v3, v40, v3
  v_lshlrev_b32 v3, 4, v3
  v_mad_u32_u24 v40, v37, s31, v3
  v_mul_u32_u24 v37, 400, v37
  v_add3_u32 v37, v37, v3, s34
  v_mov_b32 v39, v36
  v_mul_u32_u24 v36, s30, v39
  v_lshrrev_b32 v36, 16, v36
  v_mul_u32_u24 v3, 24, v36
  v_sub_u32 v3, v39, v3
  v_lshlrev_b32 v3, 4, v3
  v_mad_u32_u24 v39, v36, s31, v3
  v_mul_u32_u24 v36, 400, v36
  v_add3_u32 v36, v36, v3, s34
  v_mov_b32 v16, 0
  v_mov_b32 v17, 0
  v_mov_b32 v18, 0
  v_mov_b32 v19, 0
  s_nop 1
  v_mfma_f32_32x32x16_bf16 v[136:151], v[16:19], v[16:19], 0
  v_mfma_f32_32x32x16_bf16 v[152:167], v[16:19], v[16:19], 0
  v_mfma_f32_32x32x16_bf16 v[168:183], v[16:19], v[16:19], 0
  v_mfma_f32_32x32x16_bf16 v[184:199], v[16:19], v[16:19], 0
  v_mfma_f32_32x32x16_bf16 v[200:215], v[16:19], v[16:19], 0
  v_mfma_f32_32x32x16_bf16 v[216:231], v[16:19], v[16:19], 0
  v_add_u32 v11, s24, v6
  v_add_u32 v12, s24, v7
  v_add_u32 v13, s24, v8
  v_add_u32 v14, s24, v9
  v_add_u32 v15, s24, v10
  s_add_u32 s31, s24, s35
  v_add_u32 v28, s31, v7
  v_add_u32 v29, s31, v8
  v_add_u32 v30, s31, v9
  v_add_u32 v31, s31, v10
  s_barrier
  s_barrier
  ds_read_b128 v[48:51], v11 offset:0
  ds_read_b128 v[52:55], v11 offset:1024
  ds_read_b128 v[56:59], v11 offset:2048
  ds_read_b128 v[60:63], v11 offset:3072
  ds_read_b128 v[64:67], v11 offset:4096
  ds_read_b128 v[68:71], v11 offset:5120
  ds_read_b128 v[72:75], v11 offset:6144
  ds_read_b128 v[76:79], v11 offset:7168
  ds_read_b64_tr_b16 v[112:113], v12 offset:0
  ds_read_b64_tr_b16 v[114:115], v12 offset:6144
  ds_read_b64_tr_b16 v[116:117], v12 offset:12288
  ds_read_b64_tr_b16 v[118:119], v12 offset:18432
  s_waitcnt lgkmcnt(6)
  ds_read_b64_tr_b16 v[120:121], v13 offset:0
  ds_read_b64_tr_b16 v[122:123], v13 offset:6144
  ds_read_b64_tr_b16 v[124:125], v13 offset:12288
  ds_read_b64_tr_b16 v[126:127], v13 offset:18432
  s_mov_b32 s25, 8
.p2align 3
L_loop_oprj:
  s_waitcnt lgkmcnt(4)
  v_mfma_f32_16x16x32_bf16 v[136:139], v[112:115], v[48:51], v[136:139]
  ds_read_b64_tr_b16 v[128:129], v14 offset:0
  v_mfma_f32_16x16x32_bf16 v[136:139], v[116:119], v[52:55], v[136:139]
  ds_read_b64_tr_b16 v[130:131], v14 offset:6144
  v_mfma_f32_16x16x32_bf16 v[160:163], v[112:115], v[56:59], v[160:163]
  ds_read_b64_tr_b16 v[132:133], v14 offset:12288
  v_mfma_f32_16x16x32_bf16 v[160:163], v[116:119], v[60:63], v[160:163]
  ds_read_b64_tr_b16 v[134:135], v14 offset:18432
  v_mfma_f32_16x16x32_bf16 v[184:187], v[112:115], v[64:67], v[184:187]
  v_mfma_f32_16x16x32_bf16 v[184:187], v[116:119], v[68:71], v[184:187]
  v_mfma_f32_16x16x32_bf16 v[208:211], v[112:115], v[72:75], v[208:211]
  v_mfma_f32_16x16x32_bf16 v[208:211], v[116:119], v[76:79], v[208:211]
  s_waitcnt lgkmcnt(4)
  v_mfma_f32_16x16x32_bf16 v[140:143], v[120:123], v[48:51], v[140:143]
  ds_read_b64_tr_b16 v[112:113], v15 offset:0
  v_mfma_f32_16x16x32_bf16 v[140:143], v[124:127], v[52:55], v[140:143]
  ds_read_b64_tr_b16 v[114:115], v15 offset:6144
  v_mfma_f32_16x16x32_bf16 v[164:167], v[120:123], v[56:59], v[164:167]
  ds_read_b64_tr_b16 v[116:117], v15 offset:12288
  v_mfma_f32_16x16x32_bf16 v[164:167], v[124:127], v[60:63], v[164:167]
  ds_read_b64_tr_b16 v[118:119], v15 offset:18432
  v_mfma_f32_16x16x32_bf16 v[188:191], v[120:123], v[64:67], v[188:191]
  v_mfma_f32_16x16x32_bf16 v[188:191], v[124:127], v[68:71], v[188:191]
  v_mfma_f32_16x16x32_bf16 v[212:215], v[120:123], v[72:75], v[212:215]
  v_mfma_f32_16x16x32_bf16 v[212:215], v[124:127], v[76:79], v[212:215]
  s_waitcnt lgkmcnt(4)
  v_mfma_f32_16x16x32_bf16 v[144:147], v[128:131], v[48:51], v[144:147]
  ds_read_b64_tr_b16 v[120:121], v28 offset:0
  v_mfma_f32_16x16x32_bf16 v[144:147], v[132:135], v[52:55], v[144:147]
  ds_read_b64_tr_b16 v[122:123], v28 offset:6144
  v_mfma_f32_16x16x32_bf16 v[168:171], v[128:131], v[56:59], v[168:171]
  ds_read_b64_tr_b16 v[124:125], v28 offset:12288
  v_mfma_f32_16x16x32_bf16 v[168:171], v[132:135], v[60:63], v[168:171]
  ds_read_b64_tr_b16 v[126:127], v28 offset:18432
  v_mfma_f32_16x16x32_bf16 v[192:195], v[128:131], v[64:67], v[192:195]
  v_mfma_f32_16x16x32_bf16 v[192:195], v[132:135], v[68:71], v[192:195]
  v_mfma_f32_16x16x32_bf16 v[216:219], v[128:131], v[72:75], v[216:219]
  v_mfma_f32_16x16x32_bf16 v[216:219], v[132:135], v[76:79], v[216:219]
  s_waitcnt lgkmcnt(4)
  v_mfma_f32_16x16x32_bf16 v[148:151], v[112:115], v[48:51], v[148:151]
  ds_read_b64_tr_b16 v[128:129], v29 offset:0
  v_mfma_f32_16x16x32_bf16 v[148:151], v[116:119], v[52:55], v[148:151]
  ds_read_b64_tr_b16 v[130:131], v29 offset:6144
  v_mfma_f32_16x16x32_bf16 v[172:175], v[112:115], v[56:59], v[172:175]
  ds_read_b64_tr_b16 v[132:133], v29 offset:12288
  v_mfma_f32_16x16x32_bf16 v[172:175], v[116:119], v[60:63], v[172:175]
  ds_read_b64_tr_b16 v[134:135], v29 offset:18432
  v_mfma_f32_16x16x32_bf16 v[196:199], v[112:115], v[64:67], v[196:199]
  v_mfma_f32_16x16x32_bf16 v[196:199], v[116:119], v[68:71], v[196:199]
  v_mfma_f32_16x16x32_bf16 v[220:223], v[112:115], v[72:75], v[220:223]
  v_mfma_f32_16x16x32_bf16 v[220:223], v[116:119], v[76:79], v[220:223]
  s_waitcnt lgkmcnt(4)
  v_mfma_f32_16x16x32_bf16 v[152:155], v[120:123], v[48:51], v[152:155]
  s_add_u32 s24, s24, 40960
  s_cmp_eq_u32 s24, 122880
  s_cselect_b32 s24, 0, s24
  v_add_u32 v11, s24, v6
  v_mfma_f32_16x16x32_bf16 v[152:155], v[124:127], v[52:55], v[152:155]
  v_add_u32 v12, s24, v7
  v_add_u32 v13, s24, v8
  v_add_u32 v14, s24, v9
  v_add_u32 v15, s24, v10
  v_mfma_f32_16x16x32_bf16 v[176:179], v[120:123], v[56:59], v[176:179]
  s_add_u32 s31, s24, s35
  v_add_u32 v28, s31, v7
  v_add_u32 v29, s31, v8
  v_add_u32 v30, s31, v9
  v_add_u32 v31, s31, v10
  s_waitcnt lgkmcnt(0)
  s_barrier
  v_mfma_f32_16x16x32_bf16 v[176:179], v[124:127], v[60:63], v[176:179]
  ds_read_b128 v[80:83], v11 offset:0
  v_mfma_f32_16x16x32_bf16 v[200:203], v[120:123], v[64:67], v[200:203]
  ds_read_b128 v[84:87], v11 offset:1024
  v_mfma_f32_16x16x32_bf16 v[200:203], v[124:127], v[68:71], v[200:203]
  ds_read_b128 v[88:91], v11 offset:2048
  v_mfma_f32_16x16x32_bf16 v[224:227], v[120:123], v[72:75], v[224:227]
  ds_read_b128 v[92:95], v11 offset:3072
  v_mfma_f32_16x16x32_bf16 v[224:227], v[124:127], v[76:79], v[224:227]
  ds_read_b128 v[96:99], v11 offset:4096
  v_mfma_f32_16x16x32_bf16 v[156:159], v[128:131], v[48:51], v[156:159]
  ds_read_b128 v[100:103], v11 offset:5120
  v_mfma_f32_16x16x32_bf16 v[156:159], v[132:135], v[52:55], v[156:159]
  ds_read_b128 v[104:107], v11 offset:6144
  v_mfma_f32_16x16x32_bf16 v[180:183], v[128:131], v[56:59], v[180:183]
  ds_read_b128 v[108:111], v11 offset:7168
  v_mfma_f32_16x16x32_bf16 v[180:183], v[132:135], v[60:63], v[180:183]
  ds_read_b64_tr_b16 v[112:113], v12 offset:0
  ds_read_b64_tr_b16 v[114:115], v12 offset:6144
  ds_read_b64_tr_b16 v[116:117], v12 offset:12288
  ds_read_b64_tr_b16 v[118:119], v12 offset:18432
  v_mfma_f32_16x16x32_bf16 v[204:207], v[128:131], v[64:67], v[204:207]
  s_waitcnt lgkmcnt(6)
  ds_read_b64_tr_b16 v[120:121], v13 offset:0
  ds_read_b64_tr_b16 v[122:123], v13 offset:6144
  ds_read_b64_tr_b16 v[124:125], v13 offset:12288
  ds_read_b64_tr_b16 v[126:127], v13 offset:18432
  v_mfma_f32_16x16x32_bf16 v[204:207], v[132:135], v[68:71], v[204:207]
  v_mfma_f32_16x16x32_bf16 v[228:231], v[128:131], v[72:75], v[228:231]
  v_mfma_f32_16x16x32_bf16 v[228:231], v[132:135], v[76:79], v[228:231]
  s_waitcnt lgkmcnt(4)
  v_mfma_f32_16x16x32_bf16 v[136:139], v[112:115], v[80:83], v[136:139]
  ds_read_b64_tr_b16 v[128:129], v14 offset:0
  v_mfma_f32_16x16x32_bf16 v[136:139], v[116:119], v[84:87], v[136:139]
  ds_read_b64_tr_b16 v[130:131], v14 offset:6144
  v_mfma_f32_16x16x32_bf16 v[160:163], v[112:115], v[88:91], v[160:163]
  ds_read_b64_tr_b16 v[132:133], v14 offset:12288
  v_mfma_f32_16x16x32_bf16 v[160:163], v[116:119], v[92:95], v[160:163]
  ds_read_b64_tr_b16 v[134:135], v14 offset:18432
  v_mfma_f32_16x16x32_bf16 v[184:187], v[112:115], v[96:99], v[184:187]
  v_mfma_f32_16x16x32_bf16 v[184:187], v[116:119], v[100:103], v[184:187]
  v_mfma_f32_16x16x32_bf16 v[208:211], v[112:115], v[104:107], v[208:211]
  v_mfma_f32_16x16x32_bf16 v[208:211], v[116:119], v[108:111], v[208:211]
  s_waitcnt lgkmcnt(4)
  v_mfma_f32_16x16x32_bf16 v[140:143], v[120:123], v[80:83], v[140:143]
  ds_read_b64_tr_b16 v[112:113], v15 offset:0
  v_mfma_f32_16x16x32_bf16 v[140:143], v[124:127], v[84:87], v[140:143]
  ds_read_b64_tr_b16 v[114:115], v15 offset:6144
  v_mfma_f32_16x16x32_bf16 v[164:167], v[120:123], v[88:91], v[164:167]
  ds_read_b64_tr_b16 v[116:117], v15 offset:12288
  v_mfma_f32_16x16x32_bf16 v[164:167], v[124:127], v[92:95], v[164:167]
  ds_read_b64_tr_b16 v[118:119], v15 offset:18432
  v_mfma_f32_16x16x32_bf16 v[188:191], v[120:123], v[96:99], v[188:191]
  v_mfma_f32_16x16x32_bf16 v[188:191], v[124:127], v[100:103], v[188:191]
  v_mfma_f32_16x16x32_bf16 v[212:215], v[120:123], v[104:107], v[212:215]
  v_mfma_f32_16x16x32_bf16 v[212:215], v[124:127], v[108:111], v[212:215]
  s_waitcnt lgkmcnt(4)
  v_mfma_f32_16x16x32_bf16 v[144:147], v[128:131], v[80:83], v[144:147]
  ds_read_b64_tr_b16 v[120:121], v28 offset:0
  v_mfma_f32_16x16x32_bf16 v[144:147], v[132:135], v[84:87], v[144:147]
  ds_read_b64_tr_b16 v[122:123], v28 offset:6144
  v_mfma_f32_16x16x32_bf16 v[168:171], v[128:131], v[88:91], v[168:171]
  ds_read_b64_tr_b16 v[124:125], v28 offset:12288
  v_mfma_f32_16x16x32_bf16 v[168:171], v[132:135], v[92:95], v[168:171]
  ds_read_b64_tr_b16 v[126:127], v28 offset:18432
  v_mfma_f32_16x16x32_bf16 v[192:195], v[128:131], v[96:99], v[192:195]
  v_mfma_f32_16x16x32_bf16 v[192:195], v[132:135], v[100:103], v[192:195]
  v_mfma_f32_16x16x32_bf16 v[216:219], v[128:131], v[104:107], v[216:219]
  v_mfma_f32_16x16x32_bf16 v[216:219], v[132:135], v[108:111], v[216:219]
  s_waitcnt lgkmcnt(4)
  v_mfma_f32_16x16x32_bf16 v[148:151], v[112:115], v[80:83], v[148:151]
  ds_read_b64_tr_b16 v[128:129], v29 offset:0
  v_mfma_f32_16x16x32_bf16 v[148:151], v[116:119], v[84:87], v[148:151]
  ds_read_b64_tr_b16 v[130:131], v29 offset:6144
  v_mfma_f32_16x16x32_bf16 v[172:175], v[112:115], v[88:91], v[172:175]
  ds_read_b64_tr_b16 v[132:133], v29 offset:12288
  v_mfma_f32_16x16x32_bf16 v[172:175], v[116:119], v[92:95], v[172:175]
  ds_read_b64_tr_b16 v[134:135], v29 offset:18432
  v_mfma_f32_16x16x32_bf16 v[196:199], v[112:115], v[96:99], v[196:199]
  v_mfma_f32_16x16x32_bf16 v[196:199], v[116:119], v[100:103], v[196:199]
  v_mfma_f32_16x16x32_bf16 v[220:223], v[112:115], v[104:107], v[220:223]
  v_mfma_f32_16x16x32_bf16 v[220:223], v[116:119], v[108:111], v[220:223]
  s_waitcnt lgkmcnt(4)
  v_mfma_f32_16x16x32_bf16 v[152:155], v[120:123], v[80:83], v[152:155]
  s_add_u32 s24, s24, 40960
  s_cmp_eq_u32 s24, 122880
  s_cselect_b32 s24, 0, s24
  v_add_u32 v11, s24, v6
  v_mfma_f32_16x16x32_bf16 v[152:155], v[124:127], v[84:87], v[152:155]
  v_add_u32 v12, s24, v7
  v_add_u32 v13, s24, v8
  v_add_u32 v14, s24, v9
  v_add_u32 v15, s24, v10
  v_mfma_f32_16x16x32_bf16 v[176:179], v[120:123], v[88:91], v[176:179]
  s_add_u32 s31, s24, s35
  v_add_u32 v28, s31, v7
  v_add_u32 v29, s31, v8
  v_add_u32 v30, s31, v9
  v_add_u32 v31, s31, v10
  s_waitcnt lgkmcnt(0)
  s_barrier
  v_mfma_f32_16x16x32_bf16 v[176:179], v[124:127], v[92:95], v[176:179]
  ds_read_b128 v[48:51], v11 offset:0
  v_mfma_f32_16x16x32_bf16 v[200:203], v[120:123], v[96:99], v[200:203]
  ds_read_b128 v[52:55], v11 offset:1024
  v_mfma_f32_16x16x32_bf16 v[200:203], v[124:127], v[100:103], v[200:203]
  ds_read_b128 v[56:59], v11 offset:2048
  v_mfma_f32_16x16x32_bf16 v[224:227], v[120:123], v[104:107], v[224:227]
  ds_read_b128 v[60:63], v11 offset:3072
  v_mfma_f32_16x16x32_bf16 v[224:227], v[124:127], v[108:111], v[224:227]
  ds_read_b128 v[64:67], v11 offset:4096
  v_mfma_f32_16x16x32_bf16 v[156:159], v[128:131], v[80:83], v[156:159]
  ds_read_b128 v[68:71], v11 offset:5120
  v_mfma_f32_16x16x32_bf16 v[156:159], v[132:135], v[84:87], v[156:159]
  ds_read_b128 v[72:75], v11 offset:6144
  v_mfma_f32_16x16x32_bf16 v[180:183], v[128:131], v[88:91], v[180:183]
  ds_read_b128 v[76:79], v11 offset:7168
  v_mfma_f32_16x16x32_bf16 v[180:183], v[132:135], v[92:95], v[180:183]
  ds_read_b64_tr_b16 v[112:113], v12 offset:0
  ds_read_b64_tr_b16 v[114:115], v12 offset:6144
  ds_read_b64_tr_b16 v[116:117], v12 offset:12288
  ds_read_b64_tr_b16 v[118:119], v12 offset:18432
  v_mfma_f32_16x16x32_bf16 v[204:207], v[128:131], v[96:99], v[204:207]
  s_waitcnt lgkmcnt(6)
  ds_read_b64_tr_b16 v[120:121], v13 offset:0
  ds_read_b64_tr_b16 v[122:123], v13 offset:6144
  ds_read_b64_tr_b16 v[124:125], v13 offset:12288
  ds_read_b64_tr_b16 v[126:127], v13 offset:18432
  v_mfma_f32_16x16x32_bf16 v[204:207], v[132:135], v[100:103], v[204:207]
  v_mfma_f32_16x16x32_bf16 v[228:231], v[128:131], v[104:107], v[228:231]
  v_mfma_f32_16x16x32_bf16 v[228:231], v[132:135], v[108:111], v[228:231]
  s_sub_u32 s25, s25, 1
  s_cmp_lg_u32 s25, 0
  s_cbranch_scc1 L_loop_oprj
  s_waitcnt lgkmcnt(0)
  s_mul_i32 s30, s28, 25600
  s_mul_i32 s31, s29, 352
  s_add_u32 s30, s30, s31
  s_add_u32 s30, s30, 40960
  v_and_b32 v2, 15, v1
  v_mul_u32_u24 v2, 400, v2
  v_lshrrev_b32 v3, 4, v1
  v_lshl_add_u32 v2, v3, 3, v2
  v_add_u32 v2, s30, v2
  s_mul_i32 s31, s29, -64
  s_add_u32 s31, s31, 32
  v_cvt_pk_bf16_f32 v16, v136, v137
  v_cvt_pk_bf16_f32 v17, v138, v139
  ds_write_b64 v2, v[16:17] offset:0
  v_cvt_pk_bf16_f32 v18, v160, v161
  v_cvt_pk_bf16_f32 v19, v162, v163
  ds_write_b64 v2, v[18:19] offset:6400
  v_cvt_pk_bf16_f32 v20, v184, v185
  v_cvt_pk_bf16_f32 v21, v186, v187
  ds_write_b64 v2, v[20:21] offset:12800
  v_cvt_pk_bf16_f32 v22, v208, v209
  v_cvt_pk_bf16_f32 v23, v210, v211
  ds_write_b64 v2, v[22:23] offset:19200
  v_add_u32 v2, s31, v2
  v_cvt_pk_bf16_f32 v16, v140, v141
  v_cvt_pk_bf16_f32 v17, v142, v143
  ds_write_b64 v2, v[16:17] offset:0
  v_cvt_pk_bf16_f32 v18, v164, v165
  v_cvt_pk_bf16_f32 v19, v166, v167
  ds_write_b64 v2, v[18:19] offset:6400
  v_cvt_pk_bf16_f32 v20, v188, v189
  v_cvt_pk_bf16_f32 v21, v190, v191
  ds_write_b64 v2, v[20:21] offset:12800
  v_cvt_pk_bf16_f32 v22, v212, v213
  v_cvt_pk_bf16_f32 v23, v214, v215
  ds_write_b64 v2, v[22:23] offset:19200
  v_add_u32 v2, s31, v2
  v_cvt_pk_bf16_f32 v16, v144, v145
  v_cvt_pk_bf16_f32 v17, v146, v147
  ds_write_b64 v2, v[16:17] offset:0
  v_cvt_pk_bf16_f32 v18, v168, v169
  v_cvt_pk_bf16_f32 v19, v170, v171
  ds_write_b64 v2, v[18:19] offset:6400
  v_cvt_pk_bf16_f32 v20, v192, v193
  v_cvt_pk_bf16_f32 v21, v194, v195
  ds_write_b64 v2, v[20:21] offset:12800
  v_cvt_pk_bf16_f32 v22, v216, v217
  v_cvt_pk_bf16_f32 v23, v218, v219
  ds_write_b64 v2, v[22:23] offset:19200
  v_add_u32 v2, s31, v2
  v_cvt_pk_bf16_f32 v16, v148, v149
  v_cvt_pk_bf16_f32 v17, v150, v151
  ds_write_b64 v2, v[16:17] offset:0
  v_cvt_pk_bf16_f32 v18, v172, v173
  v_cvt_pk_bf16_f32 v19, v174, v175
  ds_write_b64 v2, v[18:19] offset:6400
  v_cvt_pk_bf16_f32 v20, v196, v197
  v_cvt_pk_bf16_f32 v21, v198, v199
  ds_write_b64 v2, v[20:21] offset:12800
  v_cvt_pk_bf16_f32 v22, v220, v221
  v_cvt_pk_bf16_f32 v23, v222, v223
  ds_write_b64 v2, v[22:23] offset:19200
  v_add_u32 v2, s31, v2
  v_cvt_pk_bf16_f32 v16, v152, v153
  v_cvt_pk_bf16_f32 v17, v154, v155
  ds_write_b64 v2, v[16:17] offset:0
  v_cvt_pk_bf16_f32 v18, v176, v177
  v_cvt_pk_bf16_f32 v19, v178, v179
  ds_write_b64 v2, v[18:19] offset:6400
  v_cvt_pk_bf16_f32 v20, v200, v201
  v_cvt_pk_bf16_f32 v21, v202, v203
  ds_write_b64 v2, v[20:21] offset:12800
  v_cvt_pk_bf16_f32 v22, v224, v225
  v_cvt_pk_bf16_f32 v23, v226, v227
  ds_write_b64 v2, v[22:23] offset:19200
  v_add_u32 v2, s31, v2
  v_cvt_pk_bf16_f32 v16, v156, v157
  v_cvt_pk_bf16_f32 v17, v158, v159
  ds_write_b64 v2, v[16:17] offset:0
  v_cvt_pk_bf16_f32 v18, v180, v181
  v_cvt_pk_bf16_f32 v19, v182, v183
  ds_write_b64 v2, v[18:19] offset:6400
  v_cvt_pk_bf16_f32 v20, v204, v205
  v_cvt_pk_bf16_f32 v21, v206, v207
  ds_write_b64 v2, v[20:21] offset:12800
  v_cvt_pk_bf16_f32 v22, v228, v229
  v_cvt_pk_bf16_f32 v23, v230, v231
  ds_write_b64 v2, v[22:23] offset:19200
  s_waitcnt lgkmcnt(0)
  s_add_u32 s34, s27, 73728
  s_barrier
  ds_read_b128 v[136:139], v36 offset:0
  ds_read_b128 v[140:143], v37 offset:0
  ds_read_b128 v[144:147], v38 offset:0
  ds_read_b128 v[148:151], v36 offset:25600
  ds_read_b128 v[152:155], v37 offset:25600
  ds_read_b128 v[156:159], v38 offset:25600
  s_waitcnt lgkmcnt(5)
  buffer_store_dwordx4 v[136:139], v39, s[12:15], s27 offen sc1
  s_waitcnt lgkmcnt(4)
  buffer_store_dwordx4 v[140:143], v40, s[12:15], s27 offen sc1
  s_waitcnt lgkmcnt(3)
  buffer_store_dwordx4 v[144:147], v41, s[12:15], s27 offen sc1
  s_waitcnt lgkmcnt(2)
  buffer_store_dwordx4 v[148:151], v39, s[12:15], s34 offen sc1
  s_waitcnt lgkmcnt(1)
  buffer_store_dwordx4 v[152:155], v40, s[12:15], s34 offen sc1
  s_waitcnt lgkmcnt(0)
  buffer_store_dwordx4 v[156:159], v41, s[12:15], s34 offen sc1
  s_branch L_phL_front_kernel
L_side_front_kernel:
  s_mov_b32 s99, s2
  s_mov_b32 s98, s20
  s_mov_b64 s[56:57], s[4:5]
  s_and_b32 s2, s2, 7
  s_mul_i32 s2, s2, 9
  s_add_u32 s2, s2, s45
  s_add_u32 s2, s2, 12
  s_mov_b32 s96, 49152
  s_cmp_eq_u32 s45, 31
  s_cselect_b32 s97, 2, 1
L_sd_front_kernel:
  s_cmp_ge_u32 s98, 4
  s_cbranch_scc1 L_sdb_front_kernel
  s_add_u32 s2, s2, 0
  s_sub_u32 s44, s2, 36
  s_load_dwordx2 s[4:5], s[0:1], 96
  s_mov_b32 s6, 0x3cc000
  s_mov_b32 s7, 0x00020000
  s_load_dwordx2 s[8:9], s[0:1], 88
  s_mov_b32 s10, 0x480
  s_mov_b32 s11, 0x00020000
  s_load_dwordx2 s[12:13], s[0:1], 120
  s_mov_b32 s14, 0x10000000
  s_mov_b32 s15, 0x00020000
  v_lshrrev_b32 v1, 2, v0
  v_and_b32 v2, 3, v0
  v_lshlrev_b32 v2, 4, v2
  s_mov_b32 s20, 6912
  v_mad_u32_u24 v3, v1, s20, v2
  v_lshlrev_b32 v4, 1, v1
  s_lshl_b32 s21, s2, 6
  s_waitcnt lgkmcnt(0)
  buffer_load_ushort v8, v4, s[8:11], 0 offen offset:0
  buffer_load_ushort v9, v4, s[8:11], 0 offen offset:128
  buffer_load_ushort v10, v4, s[8:11], 0 offen offset:256
  buffer_load_ushort v11, v4, s[8:11], 0 offen offset:384
  buffer_load_ushort v12, v4, s[8:11], 0 offen offset:512
  buffer_load_ushort v13, v4, s[8:11], 0 offen offset:640
  buffer_load_ushort v14, v4, s[8:11], 0 offen offset:768
  buffer_load_ushort v15, v4, s[8:11], 0 offen offset:896
  buffer_load_ushort v16, v4, s[8:11], 0 offen offset:1024
  s_add_u32 s22, s21, 0
  buffer_load_dwordx4 v[20:23], v3, s[4:7], s22 offen
  s_add_u32 s22, s21, 442368
  buffer_load_dwordx4 v[24:27], v3, s[4:7], s22 offen
  s_add_u32 s22, s21, 884736
  buffer_load_dwordx4 v[28:31], v3, s[4:7], s22 offen
  s_add_u32 s22, s21, 1327104
  buffer_load_dwordx4 v[32:35], v3, s[4:7], s22 offen
  s_add_u32 s22, s21, 1769472
  buffer_load_dwordx4 v[36:39], v3, s[4:7], s22 offen
  s_add_u32 s22, s21, 2211840
  buffer_load_dwordx4 v[40:43], v3, s[4:7], s22 offen
  s_add_u32 s22, s21, 2654208
  buffer_load_dwordx4 v[44:47], v3, s[4:7], s22 offen
  s_add_u32 s22, s21, 3096576
  buffer_load_dwordx4 v[48:51], v3, s[4:7], s22 offen
  s_add_u32 s22, s21, 3538944
  buffer_load_dwordx4 v[52:55], v3, s[4:7], s22 offen
  v_mov_b32 v60, 0
  v_mov_b32 v61, 0
  v_mov_b32 v62, 0
  v_mov_b32 v63, 0
  v_mov_b32 v64, 0
  v_mov_b32 v65, 0
  v_mov_b32 v66, 0
  v_mov_b32 v67, 0
  s_mov_b32 s23, 0xbfb8aa3b
  s_waitcnt vmcnt(9)
  v_lshlrev_b32 v8, 16, v8
  v_mul_f32 v5, s23, v8
  v_exp_f32 v5, v5
  s_nop 0
  v_add_f32 v5, 1.0, v5
  v_rcp_f32 v5, v5
  s_nop 0
  v_mul_f32 v8, v8, v5
  v_cvt_pk_bf16_f32 v8, v8, v8
  v_lshlrev_b32 v8, 16, v8
  v_lshlrev_b32 v9, 16, v9
  v_mul_f32 v5, s23, v9
  v_exp_f32 v5, v5
  s_nop 0
  v_add_f32 v5, 1.0, v5
  v_rcp_f32 v5, v5
  s_nop 0
  v_mul_f32 v9, v9, v5
  v_cvt_pk_bf16_f32 v9, v9, v9
  v_lshlrev_b32 v9, 16, v9
  v_lshlrev_b32 v10, 16, v10
  v_mul_f32 v5, s23, v10
  v_exp_f32 v5, v5
  s_nop 0
  v_add_f32 v5, 1.0, v5
  v_rcp_f32 v5, v5
  s_nop 0
  v_mul_f32 v10, v10, v5
  v_cvt_pk_bf16_f32 v10, v10, v10
  v_lshlrev_b32 v10, 16, v10
  v_lshlrev_b32 v11, 16, v11
  v_mul_f32 v5, s23, v11
  v_exp_f32 v5, v5
  s_nop 0
  v_add_f32 v5, 1.0, v5
  v_rcp_f32 v5, v5
  s_nop 0
  v_mul_f32 v11, v11, v5
  v_cvt_pk_bf16_f32 v11, v11, v11
  v_lshlrev_b32 v11, 16, v11
  v_lshlrev_b32 v12, 16, v12
  v_mul_f32 v5, s23, v12
  v_exp_f32 v5, v5
  s_nop 0
  v_add_f32 v5, 1.0, v5
  v_rcp_f32 v5, v5
  s_nop 0
  v_mul_f32 v12, v12, v5
  v_cvt_pk_bf16_f32 v12, v12, v12
  v_lshlrev_b32 v12, 16, v12
  v_lshlrev_b32 v13, 16, v13
  v_mul_f32 v5, s23, v13
  v_exp_f32 v5, v5
  s_nop 0
  v_add_f32 v5, 1.0, v5
  v_rcp_f32 v5, v5
  s_nop 0
  v_mul_f32 v13, v13, v5
  v_cvt_pk_bf16_f32 v13, v13, v13
  v_lshlrev_b32 v13, 16, v13
  v_lshlrev_b32 v14, 16, v14
  v_mul_f32 v5, s23, v14
  v_exp_f32 v5, v5
  s_nop 0
  v_add_f32 v5, 1.0, v5
  v_rcp_f32 v5, v5
  s_nop 0
  v_mul_f32 v14, v14, v5
  v_cvt_pk_bf16_f32 v14, v14, v14
  v_lshlrev_b32 v14, 16, v14
  v_lshlrev_b32 v15, 16, v15
  v_mul_f32 v5, s23, v15
  v_exp_f32 v5, v5
  s_nop 0
  v_add_f32 v5, 1.0, v5
  v_rcp_f32 v5, v5
  s_nop 0
  v_mul_f32 v15, v15, v5
  v_cvt_pk_bf16_f32 v15, v15, v15
  v_lshlrev_b32 v15, 16, v15
  v_lshlrev_b32 v16, 16, v16
  v_mul_f32 v5, s23, v16
  v_exp_f32 v5, v5
  s_nop 0
  v_add_f32 v5, 1.0, v5
  v_rcp_f32 v5, v5
  s_nop 0
  v_mul_f32 v16, v16, v5
  v_cvt_pk_bf16_f32 v16, v16, v16
  v_lshlrev_b32 v16, 16, v16
  s_waitcnt vmcnt(8)
  v_lshlrev_b32 v5, 16, v20
  v_and_b32 v6, 0xffff0000, v20
  v_fmac_f32 v60, v5, v8
  v_fmac_f32 v61, v6, v8
  v_lshlrev_b32 v5, 16, v21
  v_and_b32 v6, 0xffff0000, v21
  v_fmac_f32 v62, v5, v8
  v_fmac_f32 v63, v6, v8
  v_lshlrev_b32 v5, 16, v22
  v_and_b32 v6, 0xffff0000, v22
  v_fmac_f32 v64, v5, v8
  v_fmac_f32 v65, v6, v8
  v_lshlrev_b32 v5, 16, v23
  v_and_b32 v6, 0xffff0000, v23
  v_fmac_f32 v66, v5, v8
  v_fmac_f32 v67, v6, v8
  s_waitcnt vmcnt(7)
  v_lshlrev_b32 v5, 16, v24
  v_and_b32 v6, 0xffff0000, v24
  v_fmac_f32 v60, v5, v9
  v_fmac_f32 v61, v6, v9
  v_lshlrev_b32 v5, 16, v25
  v_and_b32 v6, 0xffff0000, v25
  v_fmac_f32 v62, v5, v9
  v_fmac_f32 v63, v6, v9
  v_lshlrev_b32 v5, 16, v26
  v_and_b32 v6, 0xffff0000, v26
  v_fmac_f32 v64, v5, v9
  v_fmac_f32 v65, v6, v9
  v_lshlrev_b32 v5, 16, v27
  v_and_b32 v6, 0xffff0000, v27
  v_fmac_f32 v66, v5, v9
  v_fmac_f32 v67, v6, v9
  s_waitcnt vmcnt(6)
  v_lshlrev_b32 v5, 16, v28
  v_and_b32 v6, 0xffff0000, v28
  v_fmac_f32 v60, v5, v10
  v_fmac_f32 v61, v6, v10
  v_lshlrev_b32 v5, 16, v29
  v_and_b32 v6, 0xffff0000, v29
  v_fmac_f32 v62, v5, v10
  v_fmac_f32 v63, v6, v10
  v_lshlrev_b32 v5, 16, v30
  v_and_b32 v6, 0xffff0000, v30
  v_fmac_f32 v64, v5, v10
  v_fmac_f32 v65, v6, v10
  v_lshlrev_b32 v5, 16, v31
  v_and_b32 v6, 0xffff0000, v31
  v_fmac_f32 v66, v5, v10
  v_fmac_f32 v67, v6, v10
  s_waitcnt vmcnt(5)
  v_lshlrev_b32 v5, 16, v32
  v_and_b32 v6, 0xffff0000, v32
  v_fmac_f32 v60, v5, v11
  v_fmac_f32 v61, v6, v11
  v_lshlrev_b32 v5, 16, v33
  v_and_b32 v6, 0xffff0000, v33
  v_fmac_f32 v62, v5, v11
  v_fmac_f32 v63, v6, v11
  v_lshlrev_b32 v5, 16, v34
  v_and_b32 v6, 0xffff0000, v34
  v_fmac_f32 v64, v5, v11
  v_fmac_f32 v65, v6, v11
  v_lshlrev_b32 v5, 16, v35
  v_and_b32 v6, 0xffff0000, v35
  v_fmac_f32 v66, v5, v11
  v_fmac_f32 v67, v6, v11
  s_waitcnt vmcnt(4)
  v_lshlrev_b32 v5, 16, v36
  v_and_b32 v6, 0xffff0000, v36
  v_fmac_f32 v60, v5, v12
  v_fmac_f32 v61, v6, v12
  v_lshlrev_b32 v5, 16, v37
  v_and_b32 v6, 0xffff0000, v37
  v_fmac_f32 v62, v5, v12
  v_fmac_f32 v63, v6, v12
  v_lshlrev_b32 v5, 16, v38
  v_and_b32 v6, 0xffff0000, v38
  v_fmac_f32 v64, v5, v12
  v_fmac_f32 v65, v6, v12
  v_lshlrev_b32 v5, 16, v39
  v_and_b32 v6, 0xffff0000, v39
  v_fmac_f32 v66, v5, v12
  v_fmac_f32 v67, v6, v12
  s_waitcnt vmcnt(3)
  v_lshlrev_b32 v5, 16, v40
  v_and_b32 v6, 0xffff0000, v40
  v_fmac_f32 v60, v5, v13
  v_fmac_f32 v61, v6, v13
  v_lshlrev_b32 v5, 16, v41
  v_and_b32 v6, 0xffff0000, v41
  v_fmac_f32 v62, v5, v13
  v_fmac_f32 v63, v6, v13
  v_lshlrev_b32 v5, 16, v42
  v_and_b32 v6, 0xffff0000, v42
  v_fmac_f32 v64, v5, v13
  v_fmac_f32 v65, v6, v13
  v_lshlrev_b32 v5, 16, v43
  v_and_b32 v6, 0xffff0000, v43
  v_fmac_f32 v66, v5, v13
  v_fmac_f32 v67, v6, v13
  s_waitcnt vmcnt(2)
  v_lshlrev_b32 v5, 16, v44
  v_and_b32 v6, 0xffff0000, v44
  v_fmac_f32 v60, v5, v14
  v_fmac_f32 v61, v6, v14
  v_lshlrev_b32 v5, 16, v45
  v_and_b32 v6, 0xffff0000, v45
  v_fmac_f32 v62, v5, v14
  v_fmac_f32 v63, v6, v14
  v_lshlrev_b32 v5, 16, v46
  v_and_b32 v6, 0xffff0000, v46
  v_fmac_f32 v64, v5, v14
  v_fmac_f32 v65, v6, v14
  v_lshlrev_b32 v5, 16, v47
  v_and_b32 v6, 0xffff0000, v47
  v_fmac_f32 v66, v5, v14
  v_fmac_f32 v67, v6, v14
  s_waitcnt vmcnt(1)
  v_lshlrev_b32 v5, 16, v48
  v_and_b32 v6, 0xffff0000, v48
  v_fmac_f32 v60, v5, v15
  v_fmac_f32 v61, v6, v15
  v_lshlrev_b32 v5, 16, v49
  v_and_b32 v6, 0xffff0000, v49
  v_fmac_f32 v62, v5, v15
  v_fmac_f32 v63, v6, v15
  v_lshlrev_b32 v5, 16, v50
  v_and_b32 v6, 0xffff0000, v50
  v_fmac_f32 v64, v5, v15
  v_fmac_f32 v65, v6, v15
  v_lshlrev_b32 v5, 16, v51
  v_and_b32 v6, 0xffff0000, v51
  v_fmac_f32 v66, v5, v15
  v_fmac_f32 v67, v6, v15
  s_waitcnt vmcnt(0)
  v_lshlrev_b32 v5, 16, v52
  v_and_b32 v6, 0xffff0000, v52
  v_fmac_f32 v60, v5, v16
  v_fmac_f32 v61, v6, v16
  v_lshlrev_b32 v5, 16, v53
  v_and_b32 v6, 0xffff0000, v53
  v_fmac_f32 v62, v5, v16
  v_fmac_f32 v63, v6, v16
  v_lshlrev_b32 v5, 16, v54
  v_and_b32 v6, 0xffff0000, v54
  v_fmac_f32 v64, v5, v16
  v_fmac_f32 v65, v6, v16
  v_lshlrev_b32 v5, 16, v55
  v_and_b32 v6, 0xffff0000, v55
  v_fmac_f32 v66, v5, v16
  v_fmac_f32 v67, v6, v16
  v_lshlrev_b32 v5, 7, v1
  v_lshl_add_u32 v5, v2, 1, v5
  ds_write_b128 v5, v[60:63]
  ds_write_b128 v5, v[64:67] offset:16
  s_waitcnt lgkmcnt(0)
  s_barrier
  v_and_b32 v6, 31, v0
  v_lshrrev_b32 v7, 5, v0
  v_lshlrev_b32 v7, 10, v7
  v_lshl_add_u32 v7, v6, 2, v7
  ds_read_b32 v20, v7 offset:0
  ds_read_b32 v21, v7 offset:128
  ds_read_b32 v22, v7 offset:256
  ds_read_b32 v23, v7 offset:384
  ds_read_b32 v24, v7 offset:512
  ds_read_b32 v25, v7 offset:640
  ds_read_b32 v26, v7 offset:768
  ds_read_b32 v27, v7 offset:896
  s_waitcnt lgkmcnt(0)
  v_add_f32 v20, v20, v21
  v_add_f32 v20, v20, v22
  v_add_f32 v20, v20, v23
  v_add_f32 v20, v20, v24
  v_add_f32 v20, v20, v25
  v_add_f32 v20, v20, v26
  v_add_f32 v20, v20, v27
  s_barrier
  v_lshlrev_b32 v7, 2, v0
  ds_write_b32 v7, v20
  s_waitcnt lgkmcnt(0)
  s_barrier
  v_lshlrev_b32 v7, 2, v6
  ds_read_b32 v20, v7 offset:0
  ds_read_b32 v21, v7 offset:128
  ds_read_b32 v22, v7 offset:256
  ds_read_b32 v23, v7 offset:384
  ds_read_b32 v24, v7 offset:512
  ds_read_b32 v25, v7 offset:640
  ds_read_b32 v26, v7 offset:768
  ds_read_b32 v27, v7 offset:896
  s_waitcnt lgkmcnt(0)
  v_add_f32 v20, v20, v21
  v_add_f32 v20, v20, v22
  v_add_f32 v20, v20, v23
  v_add_f32 v20, v20, v24
  v_add_f32 v20, v20, v25
  v_add_f32 v20, v20, v26
  v_add_f32 v20, v20, v27
  v_cvt_pk_bf16_f32 v20, v20, v20
  v_lshlrev_b32 v20, 16, v20
  s_lshl_b32 s22, s2, 7
  s_add_u32 s22, s22, 0
  buffer_store_dword v20, v7, s[12:15], s22 offen sc1
  s_branch L_sde_front_kernel
L_sdb_front_kernel:
  s_barrier
  s_barrier
  s_barrier
L_sde_front_kernel:
  s_cmp_lg_u32 s45, 31
  s_cbranch_scc1 L_sdx_front_kernel
  s_mov_b32 s45, 32
  s_add_u32 s2, s2, 1
  s_barrier
  s_branch L_sd_front_kernel
L_sdx_front_kernel:
  s_mov_b32 s2, s99
  s_mov_b32 s20, s98
  s_mov_b64 s[4:5], s[56:57]
  s_mov_b32 s6, 0x10000000
  s_mov_b32 s7, 0x00020000
  v_and_b32 v1, 63, v0
L_phL_front_kernel:
  v_mov_b32 v245, 0
  v_mov_b32 v246, 163328
  s_cmp_lg_u32 s20, 3
  s_cbranch_scc1 L_o20_front_kernel
  s_mov_b32 s30, 36
  v_mov_b32 v244, 1
  s_mov_b64 exec, 1
  buffer_atomic_add v244, v245, s[92:95], s30 offen sc0 sc1
  s_waitcnt vmcnt(0)
  ds_write_b32 v246, v244
  s_mov_b64 exec, -1
L_o20_front_kernel:
  s_waitcnt vmcnt(0) lgkmcnt(0)
  s_barrier
  ds_read_b32 v244, v246
  s_cmp_lg_u32 s20, 2
  s_cbranch_scc1 L_o21_front_kernel
  v_mov_b32 v250, s97
  s_mov_b64 exec, 1
  buffer_atomic_add v250, v245, s[4:7], s96 offen sc1
  s_mov_b64 exec, -1
L_o21_front_kernel:
  s_mov_b64 s[12:13], s[4:5]
  s_mov_b32 s14, s6
  s_mov_b32 s15, 0x00020000
  s_waitcnt lgkmcnt(0)
  v_readfirstlane_b32 s45, v244
  s_nop 0
  s_lshr_b32 s43, s45, 4
  s_lshl_b32 s43, s43, 7
  s_add_u32 s43, s43, 47104
  s_mov_b32 s42, 49152
  s_load_dwordx2 s[16:17], s[0:1], 0
  s_mov_b32 s18, 0x240000
  s_mov_b32 s19, 0x00020000
  v_lshrrev_b32 v3, 6, v0
  v_and_b32 v2, 63, v0
  v_readfirstlane_b32 s20, v3
  v_lshlrev_b32 v8, 4, v2
  v_lshlrev_b32 v9, 1, v2
  v_lshlrev_b32 v10, 5, v2
  v_lshlrev_b32 v11, 2, v2
  s_lshl_b32 s29, s45, 3
  s_add_u32 s29, s29, s20
  s_mul_i32 s21, s29, 1152
  s_mov_b32 s40, 0x3ae38e39
  s_mov_b32 s41, 0x3727c5ac
  s_add_u32 s24, s21, 83886080
  s_add_u32 s25, s21, 86245376
  s_add_u32 s26, s21, 88604672
  s_add_u32 s27, s21, 90963968
  s_add_u32 s23, s21, 2424832
  s_waitcnt lgkmcnt(0)
  buffer_load_dwordx4 v[16:19], v8, s[16:19], s21 offen
  buffer_load_ushort v20, v9, s[16:19], s21 offen offset:1024
  s_cmp_lg_u32 s20, 4
  s_cbranch_scc1 L_o22_front_kernel
  buffer_load_dword v248, v245, s[4:7], s43 offen sc1
  buffer_load_dword v249, v245, s[4:7], s42 offen sc1
L_wcl0_front_kernel:
  s_waitcnt vmcnt(0)
  v_readfirstlane_b32 s30, v248
  s_nop 0
  s_cmp_ge_u32 s30, 12
  s_cbranch_scc1 L_wol0_front_kernel
  s_add_u32 s100, s100, 1
  s_cmp_gt_u32 s100, 0x20000
  s_cbranch_scc1 L_end_front_kernel
  s_sleep 2
  buffer_load_dword v248, v245, s[4:7], s43 offen sc1
  s_branch L_wcl0_front_kernel
L_wol0_front_kernel:
L_wcl1_front_kernel:
  s_waitcnt vmcnt(0)
  v_readfirstlane_b32 s30, v249
  s_nop 0
  s_cmp_ge_u32 s30, 72
  s_cbranch_scc1 L_wol1_front_kernel
  s_add_u32 s100, s100, 1
  s_cmp_gt_u32 s100, 0x20000
  s_cbranch_scc1 L_end_front_kernel
  s_sleep 2
  buffer_load_dword v249, v245, s[4:7], s42 offen sc1
  s_branch L_wcl1_front_kernel
L_wol1_front_kernel:
L_o22_front_kernel:
  s_barrier
  buffer_load_dwordx4 v[22:25], v8, s[12:15], s24 offen
  buffer_load_ushort v26, v9, s[12:15], s24 offen offset:1024
  buffer_load_dwordx4 v[28:31], v8, s[12:15], s25 offen
  buffer_load_ushort v32, v9, s[12:15], s25 offen offset:1024
  buffer_load_dwordx4 v[34:37], v8, s[12:15], s26 offen
  buffer_load_ushort v38, v9, s[12:15], s26 offen offset:1024
  buffer_load_dwordx4 v[40:43], v8, s[12:15], s27 offen
  buffer_load_ushort v44, v9, s[12:15], s27 offen offset:1024
  s_mov_b32 s22, 4608
  buffer_load_dwordx4 v[56:59], v10, s[12:15], s22 offen
  buffer_load_dwordx4 v[60:63], v10, s[12:15], s22 offen offset:16
  buffer_load_dword v64, v11, s[12:15], s22 offen offset:2048
  s_mov_b32 s22, 9216
  buffer_load_dwordx4 v[66:69], v10, s[12:15], s22 offen
  buffer_load_dwordx4 v[70:73], v10, s[12:15], s22 offen offset:16
  buffer_load_dword v74, v11, s[12:15], s22 offen offset:2048
  s_mov_b32 s22, 6912
  buffer_load_dwordx4 v[76:79], v10, s[12:15], s22 offen
  buffer_load_dwordx4 v[80:83], v10, s[12:15], s22 offen offset:16
  buffer_load_dword v84, v11, s[12:15], s22 offen offset:2048
  s_waitcnt vmcnt(15)
  v_lshlrev_b32 v46, 16, v22
  v_and_b32 v47, 0xffff0000, v22
  v_lshlrev_b32 v48, 16, v23
  v_and_b32 v49, 0xffff0000, v23
  v_lshlrev_b32 v50, 16, v24
  v_and_b32 v51, 0xffff0000, v24
  v_lshlrev_b32 v52, 16, v25
  v_and_b32 v53, 0xffff0000, v25
  v_lshlrev_b32 v54, 16, v26
  s_waitcnt vmcnt(13)
  v_lshlrev_b32 v5, 16, v28
  v_and_b32 v6, 0xffff0000, v28
  v_add_f32 v46, v46, v5
  v_add_f32 v47, v47, v6
  v_lshlrev_b32 v5, 16, v29
  v_and_b32 v6, 0xffff0000, v29
  v_add_f32 v48, v48, v5
  v_add_f32 v49, v49, v6
  v_lshlrev_b32 v5, 16, v30
  v_and_b32 v6, 0xffff0000, v30
  v_add_f32 v50, v50, v5
  v_add_f32 v51, v51, v6
  v_lshlrev_b32 v5, 16, v31
  v_and_b32 v6, 0xffff0000, v31
  v_add_f32 v52, v52, v5
  v_add_f32 v53, v53, v6
  v_lshlrev_b32 v5, 16, v32
  v_add_f32 v54, v54, v5
  s_waitcnt vmcnt(11)
  v_lshlrev_b32 v5, 16, v34
  v_and_b32 v6, 0xffff0000, v34
  v_add_f32 v46, v46, v5
  v_add_f32 v47, v47, v6
  v_lshlrev_b32 v5, 16, v35
  v_and_b32 v6, 0xffff0000, v35
  v_add_f32 v48, v48, v5
  v_add_f32 v49, v49, v6
  v_lshlrev_b32 v5, 16, v36
  v_and_b32 v6, 0xffff0000, v36
  v_add_f32 v50, v50, v5
  v_add_f32 v51, v51, v6
  v_lshlrev_b32 v5, 16, v37
  v_and_b32 v6, 0xffff0000, v37
  v_add_f32 v52, v52, v5
  v_add_f32 v53, v53, v6
  v_lshlrev_b32 v5, 16, v38
  v_add_f32 v54, v54, v5
  s_waitcnt vmcnt(9)
  v_lshlrev_b32 v5, 16, v40
  v_and_b32 v6, 0xffff0000, v40
  v_add_f32 v46, v46, v5
  v_add_f32 v47, v47, v6
  v_lshlrev_b32 v5, 16, v41
  v_and_b32 v6, 0xffff0000, v41
  v_add_f32 v48, v48, v5
  v_add_f32 v49, v49, v6
  v_lshlrev_b32 v5, 16, v42
  v_and_b32 v6, 0xffff0000, v42
  v_add_f32 v50, v50, v5
  v_add_f32 v51, v51, v6
  v_lshlrev_b32 v5, 16, v43
  v_and_b32 v6, 0xffff0000, v43
  v_add_f32 v52, v52, v5
  v_add_f32 v53, v53, v6
  v_lshlrev_b32 v5, 16, v44
  v_add_f32 v54, v54, v5
  s_waitcnt vmcnt(6)
  v_lshlrev_b32 v22, 16, v16
  v_and_b32 v23, 0xffff0000, v16
  v_lshlrev_b32 v24, 16, v17
  v_and_b32 v25, 0xffff0000, v17
  v_lshlrev_b32 v26, 16, v18
  v_and_b32 v27, 0xffff0000, v18
  v_lshlrev_b32 v28, 16, v19
  v_and_b32 v29, 0xffff0000, v19
  v_lshlrev_b32 v30, 16, v20
  v_fma_f32 v46, v46, v56, v22
  v_fma_f32 v47, v47, v57, v23
  v_fma_f32 v48, v48, v58, v24
  v_fma_f32 v49, v49, v59, v25
  v_fma_f32 v50, v50, v60, v26
  v_fma_f32 v51, v51, v61, v27
  v_fma_f32 v52, v52, v62, v28
  v_fma_f32 v53, v53, v63, v29
  v_fma_f32 v54, v54, v64, v30
  v_cvt_pk_bf16_f32 v16, v46, v47
  v_cvt_pk_bf16_f32 v17, v48, v49
  v_cvt_pk_bf16_f32 v18, v50, v51
  v_cvt_pk_bf16_f32 v19, v52, v53
  v_cvt_pk_bf16_f32 v20, v54, v54
  buffer_store_dwordx4 v[16:19], v8, s[12:15], s23 offen sc1
  buffer_store_short v20, v9, s[12:15], s23 offen offset:1024 sc1
  v_lshlrev_b32 v46, 16, v16
  v_and_b32 v47, 0xffff0000, v16
  v_lshlrev_b32 v48, 16, v17
  v_and_b32 v49, 0xffff0000, v17
  v_lshlrev_b32 v50, 16, v18
  v_and_b32 v51, 0xffff0000, v18
  v_lshlrev_b32 v52, 16, v19
  v_and_b32 v53, 0xffff0000, v19
  v_lshlrev_b32 v54, 16, v20
  v_add_f32 v5, v46, v47
  v_add_f32 v6, v48, v49
  v_add_f32 v5, v5, v50
  v_add_f32 v6, v6, v51
  v_add_f32 v5, v5, v52
  v_add_f32 v6, v6, v53
  v_add_f32 v5, v5, v54
  v_add_f32 v5, v5, v6
  s_nop 1
  v_add_f32_dpp v5, v5, v5 row_ror:8 row_mask:0xf bank_mask:0xf
  s_nop 1
  v_add_f32_dpp v5, v5, v5 row_ror:4 row_mask:0xf bank_mask:0xf
  s_nop 1
  v_add_f32_dpp v5, v5, v5 row_ror:2 row_mask:0xf bank_mask:0xf
  s_nop 1
  v_add_f32_dpp v5, v5, v5 row_ror:1 row_mask:0xf bank_mask:0xf
  v_mov_b32 v6, v5
  s_nop 1
  v_permlane16_swap_b32 v6, v5
  v_add_f32 v5, v5, v6
  v_mov_b32 v6, v5
  s_nop 1
  v_permlane32_swap_b32 v6, v5
  v_add_f32 v5, v5, v6
  v_mul_f32 v5, s40, v5
  v_sub_f32 v46, v46, v5
  v_sub_f32 v47, v47, v5
  v_sub_f32 v48, v48, v5
  v_sub_f32 v49, v49, v5
  v_sub_f32 v50, v50, v5
  v_sub_f32 v51, v51, v5
  v_sub_f32 v52, v52, v5
  v_sub_f32 v53, v53, v5
  v_sub_f32 v54, v54, v5
  v_mul_f32 v5, v46, v46
  v_mul_f32 v6, v47, v47
  v_fmac_f32 v5, v48, v48
  v_fmac_f32 v6, v49, v49
  v_fmac_f32 v5, v50, v50
  v_fmac_f32 v6, v51, v51
  v_fmac_f32 v5, v52, v52
  v_fmac_f32 v6, v53, v53
  v_fmac_f32 v5, v54, v54
  v_add_f32 v5, v5, v6
  s_nop 1
  v_add_f32_dpp v5, v5, v5 row_ror:8 row_mask:0xf bank_mask:0xf
  s_nop 1
  v_add_f32_dpp v5, v5, v5 row_ror:4 row_mask:0xf bank_mask:0xf
  s_nop 1
  v_add_f32_dpp v5, v5, v5 row_ror:2 row_mask:0xf bank_mask:0xf
  s_nop 1
  v_add_f32_dpp v5, v5, v5 row_ror:1 row_mask:0xf bank_mask:0xf
  v_mov_b32 v6, v5
  s_nop 1
  v_permlane16_swap_b32 v6, v5
  v_add_f32 v5, v5, v6
  v_mov_b32 v6, v5
  s_nop 1
  v_permlane32_swap_b32 v6, v5
  v_add_f32 v5, v5, v6
  v_mov_b32 v6, s41
  v_fmac_f32 v6, s40, v5
  v_rsq_f32 v6, v6
  s_nop 0
  v_mul_f32 v46, v46, v6
  v_mul_f32 v47, v47, v6
  v_mul_f32 v48, v48, v6
  v_mul_f32 v49, v49, v6
  v_mul_f32 v50, v50, v6
  v_mul_f32 v51, v51, v6
  v_mul_f32 v52, v52, v6
  v_mul_f32 v53, v53, v6
  v_mul_f32 v54, v54, v6
  s_waitcnt vmcnt(2)
  v_add_f32 v66, 1.0, v66
  v_add_f32 v67, 1.0, v67
  v_add_f32 v68, 1.0, v68
  v_add_f32 v69, 1.0, v69
  v_add_f32 v70, 1.0, v70
  v_add_f32 v71, 1.0, v71
  v_add_f32 v72, 1.0, v72
  v_add_f32 v73, 1.0, v73
  v_add_f32 v74, 1.0, v74
  v_cvt_pk_bf16_f32 v24, v66, v67
  v_cvt_pk_bf16_f32 v25, v68, v69
  v_cvt_pk_bf16_f32 v26, v70, v71
  v_cvt_pk_bf16_f32 v27, v72, v73
  v_cvt_pk_bf16_f32 v28, v74, v74
  v_lshlrev_b32 v66, 16, v24
  v_and_b32 v67, 0xffff0000, v24
  v_lshlrev_b32 v68, 16, v25
  v_and_b32 v69, 0xffff0000, v25
  v_lshlrev_b32 v70, 16, v26
  v_and_b32 v71, 0xffff0000, v26
  v_lshlrev_b32 v72, 16, v27
  v_and_b32 v73, 0xffff0000, v27
  v_lshlrev_b32 v74, 16, v28
  v_fma_f32 v46, v46, v66, v76
  v_fma_f32 v47, v47, v67, v77
  v_fma_f32 v48, v48, v68, v78
  v_fma_f32 v49, v49, v69, v79
  v_fma_f32 v50, v50, v70, v80
  v_fma_f32 v51, v51, v71, v81
  v_fma_f32 v52, v52, v72, v82
  v_fma_f32 v53, v53, v73, v83
  v_fma_f32 v54, v54, v74, v84
  v_add_f32 v5, v46, v47
  v_add_f32 v6, v48, v49
  v_add_f32 v5, v5, v50
  v_add_f32 v6, v6, v51
  v_add_f32 v5, v5, v52
  v_add_f32 v6, v6, v53
  v_add_f32 v5, v5, v54
  v_add_f32 v5, v5, v6
  s_nop 1
  v_add_f32_dpp v5, v5, v5 row_ror:8 row_mask:0xf bank_mask:0xf
  s_nop 1
  v_add_f32_dpp v5, v5, v5 row_ror:4 row_mask:0xf bank_mask:0xf
  s_nop 1
  v_add_f32_dpp v5, v5, v5 row_ror:2 row_mask:0xf bank_mask:0xf
  s_nop 1
  v_add_f32_dpp v5, v5, v5 row_ror:1 row_mask:0xf bank_mask:0xf
  v_mov_b32 v6, v5
  s_nop 1
  v_permlane16_swap_b32 v6, v5
  v_add_f32 v5, v5, v6
  v_mov_b32 v6, v5
  s_nop 1
  v_permlane32_swap_b32 v6, v5
  v_add_f32 v5, v5, v6
  v_mul_f32 v5, s40, v5
  v_sub_f32 v46, v46, v5
  v_sub_f32 v47, v47, v5
  v_sub_f32 v48, v48, v5
  v_sub_f32 v49, v49, v5
  v_sub_f32 v50, v50, v5
  v_sub_f32 v51, v51, v5
  v_sub_f32 v52, v52, v5
  v_sub_f32 v53, v53, v5
  v_sub_f32 v54, v54, v5
  v_mul_f32 v5, v46, v46
  v_mul_f32 v6, v47, v47
  v_fmac_f32 v5, v48, v48
  v_fmac_f32 v6, v49, v49
  v_fmac_f32 v5, v50, v50
  v_fmac_f32 v6, v51, v51
  v_fmac_f32 v5, v52, v52
  v_fmac_f32 v6, v53, v53
  v_fmac_f32 v5, v54, v54
  v_add_f32 v5, v5, v6
  s_nop 1
  v_add_f32_dpp v5, v5, v5 row_ror:8 row_mask:0xf bank_mask:0xf
  s_nop 1
  v_add_f32_dpp v5, v5, v5 row_ror:4 row_mask:0xf bank_mask:0xf
  s_nop 1
  v_add_f32_dpp v5, v5, v5 row_ror:2 row_mask:0xf bank_mask:0xf
  s_nop 1
  v_add_f32_dpp v5, v5, v5 row_ror:1 row_mask:0xf bank_mask:0xf
  v_mov_b32 v6, v5
  s_nop 1
  v_permlane16_swap_b32 v6, v5
  v_add_f32 v5, v5, v6
  v_mov_b32 v6, v5
  s_nop 1
  v_permlane32_swap_b32 v6, v5
  v_add_f32 v5, v5, v6
  v_mov_b32 v6, s41
  v_fmac_f32 v6, s40, v5
  v_rsq_f32 v6, v6
  s_nop 0
  v_mul_f32 v46, v46, v6
  v_mul_f32 v47, v47, v6
  v_mul_f32 v48, v48, v6
  v_mul_f32 v49, v49, v6
  v_mul_f32 v50, v50, v6
  v_mul_f32 v51, v51, v6
  v_mul_f32 v52, v52, v6
  v_mul_f32 v53, v53, v6
  v_mul_f32 v54, v54, v6
  v_cvt_pk_bf16_f32 v24, v46, v47
  v_cvt_pk_bf16_f32 v25, v48, v49
  v_cvt_pk_bf16_f32 v26, v50, v51
  v_cvt_pk_bf16_f32 v27, v52, v53
  v_cvt_pk_bf16_f32 v28, v54, v54
  s_mul_i32 s30, s20, 1216
  v_add_u32 v5, s30, v8
  v_add_u32 v6, s30, v9
  ds_write_b128 v5, v[24:27]
  ds_write_b16 v6, v28 offset:1024
  v_lshrrev_b32 v5, 4, v0
  v_bfe_u32 v6, v0, 2, 2
  v_mul_u32_u24 v6, 1216, v6
  v_lshl_add_u32 v6, v5, 5, v6
  v_and_b32 v7, 3, v0
  v_lshl_add_u32 v6, v7, 3, v6
  v_lshlrev_b32 v5, 16, v5
  v_and_b32 v7, 15, v0
  v_lshl_add_u32 v5, v7, 4, v5
  s_lshl_b32 s22, s45, 8
  s_add_u32 s22, s22, 4784128
  s_waitcnt lgkmcnt(0)
  s_barrier
  ds_read_b64_tr_b16 v[56:57], v6 offset:0
  ds_read_b64_tr_b16 v[58:59], v6 offset:4864
  s_waitcnt lgkmcnt(0)
  buffer_store_dwordx4 v[56:59], v5, s[12:15], s22 offen sc1
  s_add_u32 s22, s22, 2097152
  s_cmp_lg_u32 s20, 0
  s_cbranch_scc1 L_t_front_kernel_l
  ds_read_b64_tr_b16 v[60:61], v6 offset:1024
  ds_read_b64_tr_b16 v[62:63], v6 offset:5888
  s_waitcnt lgkmcnt(0)
  buffer_store_dwordx4 v[60:63], v5, s[12:15], s22 offen sc1
  s_add_u32 s22, s22, 2097152
L_t_front_kernel_l:
  s_mov_b32 s96, s45
  v_mov_b32 v245, 0
  v_mov_b32 v246, 163328
  s_cmp_lg_u32 s20, 3
  s_cbranch_scc1 L_o23_front_kernel
  s_and_b32 s30, s2, 7
  s_lshl_b32 s30, s30, 2
  s_add_u32 s30, s30, 40
  v_mov_b32 v244, 1
  s_mov_b64 exec, 1
  buffer_atomic_add v244, v245, s[92:95], s30 offen sc0 sc1
  s_waitcnt vmcnt(0)
  ds_write_b32 v246, v244
  s_mov_b64 exec, -1
L_o23_front_kernel:
  s_waitcnt vmcnt(0) lgkmcnt(0)
  s_barrier
  ds_read_b32 v244, v246
  s_cmp_lg_u32 s20, 2
  s_cbranch_scc1 L_o24_front_kernel
  s_lshr_b32 s31, s96, 4
  s_lshl_b32 s30, s31, 7
  s_add_u32 s30, s30, 53376
  v_mov_b32 v250, 1
  s_mov_b64 exec, 1
  buffer_atomic_add v250, v245, s[4:7], s30 offen sc0 sc1
  s_mov_b64 exec, -1
  v_lshlrev_b32 v249, 7, v1
  s_lshl_b32 s31, 1, s31
  s_waitcnt vmcnt(0)
  v_readfirstlane_b32 s30, v250
  s_nop 0
  s_cmp_lg_u32 s30, 15
  s_cbranch_scc1 L_nl_front_kernel
  s_mov_b32 s30, 49280
  v_mov_b32 v250, s31
  s_mov_b64 exec, 255
  buffer_atomic_add v250, v249, s[4:7], s30 offen sc1
  s_mov_b64 exec, -1
L_nl_front_kernel:
L_o24_front_kernel:
  s_load_dwordx2 s[8:9], s[0:1], 56
  s_mov_b32 s10, 0x1200000
  s_mov_b32 s11, 0x00020000
  s_load_dwordx2 s[16:17], s[0:1], 64
  s_mov_b32 s18, 0x2400
  s_mov_b32 s19, 0x00020000
  s_waitcnt lgkmcnt(0)
  v_readfirstlane_b32 s45, v244
  v_mov_b32 v246, 163584
  s_cmp_ge_u32 s45, 27
  s_cbranch_scc1 L_phM2s_front_kernel
  s_and_b32 s30, s2, 7
  s_lshl_b32 s43, s30, 7
  s_add_u32 s43, s43, 49280
  s_cmp_lg_u32 s20, 4
  s_cbranch_scc1 L_o25_front_kernel
  buffer_load_dword v248, v245, s[4:7], s43 offen sc1
L_o25_front_kernel:
  s_mul_i32 s30, s30, 27
  s_add_u32 s30, s30, s45
  s_mul_i32 s31, s30, 171
  s_lshr_b32 s31, s31, 10
  s_mul_i32 s32, s31, 6
  s_sub_u32 s32, s30, s32
  s_mul_i32 s36, s32, 393216
  s_add_u32 s36, s36, 4784128
  s_lshl_b32 s37, s31, 8
  s_mov_b32 s33, s37
  s_mul_i32 s27, s32, 884736
  s_lshl_b32 s30, s31, 12
  s_add_u32 s27, s27, s30
  s_add_u32 s27, s27, 7143424
  s_mov_b32 s96, s31
  s_cmp_ge_u32 s20, 4
  s_cbranch_scc0 L_cons_mlpa
  s_sub_u32 s20, s20, 4
  s_lshl_b32 s23, s20, 10
  s_lshr_b32 s30, s20, 1
  s_and_b32 s31, s20, 1
  s_mul_i32 s30, s30, 65536
  s_lshl_b32 s31, s31, 10
  s_add_u32 s30, s30, s31
  v_lshlrev_b32 v2, 4, v1
  v_add_u32 v2, s30, v2
  s_mov_b32 s50, 0
  s_mul_i32 s30, s50, 131072
  s_lshl_b32 s50, s50, 12
  v_add_u32 v8, s30, v2
  s_mov_b32 s51, 1
  s_mul_i32 s30, s51, 131072
  s_lshl_b32 s51, s51, 12
  v_add_u32 v9, s30, v2
  s_mov_b32 s52, 2
  s_mul_i32 s30, s52, 131072
  s_lshl_b32 s52, s52, 12
  v_add_u32 v10, s30, v2
  s_waitcnt lgkmcnt(0)
  s_lshr_b32 s31, s20, 1
  v_lshrrev_b32 v2, 3, v1
  v_bfe_u32 v3, v2, 2, 1
  v_xor_b32 v3, s31, v3
  v_bfe_u32 v4, v2, 1, 1
  v_lshl_add_u32 v3, v3, 1, v4
  v_bfe_u32 v4, v1, 1, 2
  v_xor_b32 v3, v3, v4
  v_and_b32 v4, 1, v1
  v_lshlrev_b32 v4, 4, v4
  v_lshl_add_u32 v3, v3, 5, v4
  s_mov_b32 s30, 9216
  v_mad_u32_u24 v11, v2, s30, v3
  s_mul_i32 s30, s31, 73728
  s_and_b32 s31, s20, 1
  s_lshl_b32 s31, s31, 7
  s_add_u32 s30, s30, s31
  v_add_u32 v2, s30, v11
  s_mov_b32 s53, 0
  s_mul_i32 s30, s53, 147456
  s_lshl_b32 s53, s53, 12
  s_add_u32 s53, s53, 12288
  v_add_u32 v11, s30, v2
  s_mov_b32 s54, 1
  s_mul_i32 s30, s54, 147456
  s_lshl_b32 s54, s54, 12
  s_add_u32 s54, s54, 12288
  v_add_u32 v12, s30, v2
  s_mov_b32 s55, 2
  s_mul_i32 s30, s55, 147456
  s_lshl_b32 s55, s55, 12
  s_add_u32 s55, s55, 12288
  v_add_u32 v13, s30, v2
  s_mov_b32 s56, 3
  s_mul_i32 s30, s56, 147456
  s_lshl_b32 s56, s56, 12
  s_add_u32 s56, s56, 12288
  v_add_u32 v14, s30, v2
  s_mov_b32 s38, 0
  v_mov_b32 v30, 0
  v_mov_b32 v31, 163584
  s_cmp_lg_u32 s20, 0
  s_cbranch_scc1 L_s1_mlpa
  s_waitcnt vmcnt(0)
  v_readfirstlane_b32 s30, v248
L_s0_mlpa:
  s_nop 0
  s_and_b32 s31, s30, 3
  s_bcnt1_i32_b32 s31, s31
  s_cmp_ge_u32 s31, 2
  s_cbranch_scc1 L_s2_mlpa
  s_add_u32 s100, s100, 1
  s_cmp_gt_u32 s100, 0x20000
  s_cbranch_scc1 L_end_front_kernel
  s_sleep 2
  buffer_load_dword v24, v30, s[4:7], s43 offen sc1
  s_waitcnt vmcnt(0)
  v_readfirstlane_b32 s30, v24
  s_branch L_s0_mlpa
L_s2_mlpa:
  s_nop 0
  v_mov_b32 v29, s30
  ds_write_b32 v31, v29
  s_waitcnt lgkmcnt(0)
L_s1_mlpa:
  s_barrier
  ds_read_b32 v28, v31
  s_waitcnt lgkmcnt(0)
  v_readfirstlane_b32 s39, v28
  s_ff0_i32_b32 s31, s38
  s_bitset1_b32 s38, s31
  s_lshl_b32 s30, s31, 12
  s_add_u32 s21, s36, s30
  s_mul_i32 s30, s31, 1179648
  s_add_u32 s22, s37, s30
  s_add_u32 m0, s23, s50
  s_nop 0
  buffer_load_dwordx4 v8, s[4:7], s21 offen lds
  s_add_u32 m0, s23, s51
  s_nop 0
  buffer_load_dwordx4 v9, s[4:7], s21 offen lds
  s_add_u32 m0, s23, s52
  s_nop 0
  buffer_load_dwordx4 v10, s[4:7], s21 offen lds
  s_add_u32 m0, s23, s53
  s_nop 0
  buffer_load_dwordx4 v11, s[8:11], s22 offen lds
  s_add_u32 m0, s23, s54
  s_nop 0
  buffer_load_dwordx4 v12, s[8:11], s22 offen lds
  s_add_u32 m0, s23, s55
  s_nop 0
  buffer_load_dwordx4 v13, s[8:11], s22 offen lds
  s_add_u32 m0, s23, s56
  s_nop 0
  buffer_load_dwordx4 v14, s[8:11], s22 offen lds
  s_add_u32 s21, s21, 2048
  s_add_u32 s22, s22, 589824
  s_add_u32 s23, s23, 28672
  s_sub_u32 s30, s23, 114688
  s_cmp_ge_u32 s23, 114688
  s_cselect_b32 s23, s30, s23
  s_waitcnt vmcnt(0)
  s_barrier
  s_mov_b32 s28, 31
  s_mov_b32 s29, 2
L_lloop_mlpa:
  s_bitcmp0_b32 s28, 0
  s_cbranch_scc0 L_np_mlpa
  s_cmp_eq_u32 s39, 0xffff
  s_cbranch_scc1 L_nf_mlpa
  s_cmp_lg_u32 s20, 0
  s_cbranch_scc1 L_nf_mlpa
  buffer_load_dword v24, v30, s[4:7], s43 offen sc1
L_nf_mlpa:
  s_ff0_i32_b32 s31, s38
  s_bitset1_b32 s38, s31
  s_lshl_b32 s30, s31, 12
  s_add_u32 s21, s36, s30
  s_mul_i32 s30, s31, 1179648
  s_add_u32 s22, s37, s30
L_np_mlpa:
  s_add_u32 m0, s23, s53
  s_nop 0
  buffer_load_dwordx4 v11, s[8:11], s22 offen lds
  s_add_u32 m0, s23, s54
  s_nop 0
  buffer_load_dwordx4 v12, s[8:11], s22 offen lds
  s_add_u32 m0, s23, s55
  s_nop 0
  buffer_load_dwordx4 v13, s[8:11], s22 offen lds
  s_add_u32 m0, s23, s56
  s_nop 0
  buffer_load_dwordx4 v14, s[8:11], s22 offen lds
  s_add_u32 m0, s23, s50
  s_nop 0
  buffer_load_dwordx4 v8, s[4:7], s21 offen lds
  s_add_u32 m0, s23, s51
  s_nop 0
  buffer_load_dwordx4 v9, s[4:7], s21 offen lds
  s_add_u32 m0, s23, s52
  s_nop 0
  buffer_load_dwordx4 v10, s[4:7], s21 offen lds
  s_add_u32 s21, s21, 2048
  s_add_u32 s22, s22, 589824
  s_add_u32 s23, s23, 28672
  s_sub_u32 s30, s23, 114688
  s_cmp_ge_u32 s23, 114688
  s_cselect_b32 s23, s30, s23
  s_sub_u32 s28, s28, 1
  s_sub_u32 s29, s29, 1
  s_cmp_ge_i32 s29, 0
  s_cbranch_scc1 L_lloop_mlpa
  s_waitcnt vmcnt(14)
  s_cmp_eq_u32 s39, 0xffff
  s_cbranch_scc1 L_pb_mlpa
  s_bitcmp0_b32 s28, 0
  s_cbranch_scc0 L_pb_mlpa
  s_cmp_eq_u32 s28, 0
  s_cbranch_scc1 L_pb_mlpa
  s_cmp_lg_u32 s20, 0
  s_cbranch_scc1 L_rb_mlpa
L_ck_mlpa:
  v_readfirstlane_b32 s30, v24
  s_ff0_i32_b32 s31, s38
  s_bitcmp1_b32 s30, s31
  s_cbranch_scc1 L_pub_mlpa
  s_add_u32 s100, s100, 1
  s_cmp_gt_u32 s100, 0x20000
  s_cbranch_scc1 L_end_front_kernel
  s_sleep 2
  buffer_load_dword v24, v30, s[4:7], s43 offen sc1
  s_waitcnt vmcnt(0)
  s_branch L_ck_mlpa
L_pub_mlpa:
  v_mov_b32 v29, s30
  ds_write_b32 v31, v29
  s_waitcnt lgkmcnt(0)
L_rb_mlpa:
  s_barrier
  ds_read_b32 v28, v31
  s_waitcnt lgkmcnt(0)
  v_readfirstlane_b32 s39, v28
  s_branch L_lloop_mlpa
L_pb_mlpa:
  s_barrier
  s_cmp_lg_u32 s28, 0
  s_cbranch_scc1 L_lloop_mlpa
  s_lshl_b32 s31, s20, 10
  s_add_u32 s27, s27, s31
  v_lshlrev_b32 v2, 4, v1
  v_mov_b32 v3, 0xc0135761
  s_mov_b32 s35, 0xbdd2d3e8
  s_mul_i32 s30, s20, 6144
  v_add_u32 v4, s30, v2
  s_waitcnt vmcnt(7)
  s_barrier
  s_waitcnt vmcnt(0)
  s_barrier
  s_waitcnt vmcnt(0)
  s_barrier
  s_barrier
  ds_read_b128 v[32:35], v4 offset:0
  ds_read_b128 v[36:39], v4 offset:1024
  ds_read_b128 v[40:43], v4 offset:2048
  ds_read_b128 v[44:47], v4 offset:3072
  ds_read_b128 v[48:51], v4 offset:4096
  ds_read_b128 v[52:55], v4 offset:5120
  s_waitcnt lgkmcnt(4)
  v_mul_f32 v56, v32, v32
  v_mul_f32 v57, v33, v33
  v_mul_f32 v58, v34, v34
  v_mul_f32 v59, v35, v35
  v_mul_f32 v60, v36, v36
  v_mul_f32 v61, v37, v37
  v_mul_f32 v62, v38, v38
  v_mul_f32 v63, v39, v39
  v_fma_f32 v56, v56, s35, v3
  v_fma_f32 v57, v57, s35, v3
  v_fma_f32 v58, v58, s35, v3
  v_fma_f32 v59, v59, s35, v3
  v_fma_f32 v60, v60, s35, v3
  v_fma_f32 v61, v61, s35, v3
  v_fma_f32 v62, v62, s35, v3
  v_fma_f32 v63, v63, s35, v3
  v_mul_f32 v56, v32, v56
  v_mul_f32 v57, v33, v57
  v_mul_f32 v58, v34, v58
  v_mul_f32 v59, v35, v59
  v_mul_f32 v60, v36, v60
  v_mul_f32 v61, v37, v61
  v_mul_f32 v62, v38, v62
  v_mul_f32 v63, v39, v63
  v_exp_f32 v56, v56
  v_exp_f32 v57, v57
  v_exp_f32 v58, v58
  v_exp_f32 v59, v59
  v_exp_f32 v60, v60
  v_exp_f32 v61, v61
  v_exp_f32 v62, v62
  v_exp_f32 v63, v63
  v_add_f32 v56, 1.0, v56
  v_add_f32 v57, 1.0, v57
  v_add_f32 v58, 1.0, v58
  v_add_f32 v59, 1.0, v59
  v_add_f32 v60, 1.0, v60
  v_add_f32 v61, 1.0, v61
  v_add_f32 v62, 1.0, v62
  v_add_f32 v63, 1.0, v63
  v_rcp_f32 v56, v56
  v_rcp_f32 v57, v57
  v_rcp_f32 v58, v58
  v_rcp_f32 v59, v59
  v_rcp_f32 v60, v60
  v_rcp_f32 v61, v61
  v_rcp_f32 v62, v62
  v_rcp_f32 v63, v63
  v_mul_f32 v56, v32, v56
  v_mul_f32 v57, v33, v57
  v_mul_f32 v58, v34, v58
  v_mul_f32 v59, v35, v59
  v_mul_f32 v60, v36, v60
  v_mul_f32 v61, v37, v61
  v_mul_f32 v62, v38, v62
  v_mul_f32 v63, v39, v63
  v_cvt_pk_bf16_f32 v32, v56, v57
  v_cvt_pk_bf16_f32 v33, v58, v59
  v_cvt_pk_bf16_f32 v34, v60, v61
  v_cvt_pk_bf16_f32 v35, v62, v63
  s_add_u32 s30, s27, 442368
  buffer_store_dwordx4 v[32:35], v2, s[12:15], s30 offen sc1
  s_waitcnt lgkmcnt(2)
  v_mul_f32 v64, v40, v40
  v_mul_f32 v65, v41, v41
  v_mul_f32 v66, v42, v42
  v_mul_f32 v67, v43, v43
  v_mul_f32 v68, v44, v44
  v_mul_f32 v69, v45, v45
  v_mul_f32 v70, v46, v46
  v_mul_f32 v71, v47, v47
  v_fma_f32 v64, v64, s35, v3
  v_fma_f32 v65, v65, s35, v3
  v_fma_f32 v66, v66, s35, v3
  v_fma_f32 v67, v67, s35, v3
  v_fma_f32 v68, v68, s35, v3
  v_fma_f32 v69, v69, s35, v3
  v_fma_f32 v70, v70, s35, v3
  v_fma_f32 v71, v71, s35, v3
  v_mul_f32 v64, v40, v64
  v_mul_f32 v65, v41, v65
  v_mul_f32 v66, v42, v66
  v_mul_f32 v67, v43, v67
  v_mul_f32 v68, v44, v68
  v_mul_f32 v69, v45, v69
  v_mul_f32 v70, v46, v70
  v_mul_f32 v71, v47, v71
  v_exp_f32 v64, v64
  v_exp_f32 v65, v65
  v_exp_f32 v66, v66
  v_exp_f32 v67, v67
  v_exp_f32 v68, v68
  v_exp_f32 v69, v69
  v_exp_f32 v70, v70
  v_exp_f32 v71, v71
  v_add_f32 v64, 1.0, v64
  v_add_f32 v65, 1.0, v65
  v_add_f32 v66, 1.0, v66
  v_add_f32 v67, 1.0, v67
  v_add_f32 v68, 1.0, v68
  v_add_f32 v69, 1.0, v69
  v_add_f32 v70, 1.0, v70
  v_add_f32 v71, 1.0, v71
  v_rcp_f32 v64, v64
  v_rcp_f32 v65, v65
  v_rcp_f32 v66, v66
  v_rcp_f32 v67, v67
  v_rcp_f32 v68, v68
  v_rcp_f32 v69, v69
  v_rcp_f32 v70, v70
  v_rcp_f32 v71, v71
  v_mul_f32 v64, v40, v64
  v_mul_f32 v65, v41, v65
  v_mul_f32 v66, v42, v66
  v_mul_f32 v67, v43, v67
  v_mul_f32 v68, v44, v68
  v_mul_f32 v69, v45, v69
  v_mul_f32 v70, v46, v70
  v_mul_f32 v71, v47, v71
  v_cvt_pk_bf16_f32 v40, v64, v65
  v_cvt_pk_bf16_f32 v41, v66, v67
  v_cvt_pk_bf16_f32 v42, v68, v69
  v_cvt_pk_bf16_f32 v43, v70, v71
  s_add_u32 s30, s27, 589824
  buffer_store_dwordx4 v[40:43], v2, s[12:15], s30 offen sc1
  s_waitcnt lgkmcnt(0)
  v_mul_f32 v56, v48, v48
  v_mul_f32 v57, v49, v49
  v_mul_f32 v58, v50, v50
  v_mul_f32 v59, v51, v51
  v_mul_f32 v60, v52, v52
  v_mul_f32 v61, v53, v53
  v_mul_f32 v62, v54, v54
  v_mul_f32 v63, v55, v55
  v_fma_f32 v56, v56, s35, v3
  v_fma_f32 v57, v57, s35, v3
  v_fma_f32 v58, v58, s35, v3
  v_fma_f32 v59, v59, s35, v3
  v_fma_f32 v60, v60, s35, v3
  v_fma_f32 v61, v61, s35, v3
  v_fma_f32 v62, v62, s35, v3
  v_fma_f32 v63, v63, s35, v3
  v_mul_f32 v56, v48, v56
  v_mul_f32 v57, v49, v57
  v_mul_f32 v58, v50, v58
  v_mul_f32 v59, v51, v59
  v_mul_f32 v60, v52, v60
  v_mul_f32 v61, v53, v61
  v_mul_f32 v62, v54, v62
  v_mul_f32 v63, v55, v63
  v_exp_f32 v56, v56
  v_exp_f32 v57, v57
  v_exp_f32 v58, v58
  v_exp_f32 v59, v59
  v_exp_f32 v60, v60
  v_exp_f32 v61, v61
  v_exp_f32 v62, v62
  v_exp_f32 v63, v63
  v_add_f32 v56, 1.0, v56
  v_add_f32 v57, 1.0, v57
  v_add_f32 v58, 1.0, v58
  v_add_f32 v59, 1.0, v59
  v_add_f32 v60, 1.0, v60
  v_add_f32 v61, 1.0, v61
  v_add_f32 v62, 1.0, v62
  v_add_f32 v63, 1.0, v63
  v_rcp_f32 v56, v56
  v_rcp_f32 v57, v57
  v_rcp_f32 v58, v58
  v_rcp_f32 v59, v59
  v_rcp_f32 v60, v60
  v_rcp_f32 v61, v61
  v_rcp_f32 v62, v62
  v_rcp_f32 v63, v63
  v_mul_f32 v56, v48, v56
  v_mul_f32 v57, v49, v57
  v_mul_f32 v58, v50, v58
  v_mul_f32 v59, v51, v59
  v_mul_f32 v60, v52, v60
  v_mul_f32 v61, v53, v61
  v_mul_f32 v62, v54, v62
  v_mul_f32 v63, v55, v63
  v_cvt_pk_bf16_f32 v48, v56, v57
  v_cvt_pk_bf16_f32 v49, v58, v59
  v_cvt_pk_bf16_f32 v50, v60, v61
  v_cvt_pk_bf16_f32 v51, v62, v63
  s_add_u32 s30, s27, 737280
  buffer_store_dwordx4 v[48:51], v2, s[12:15], s30 offen sc1
  s_add_u32 s20, s20, 4
  s_branch L_phM2_front_kernel
L_cons_mlpa:
  s_and_b32 s28, s20, 0
  s_lshr_b32 s29, s20, 0
  s_lshl_b32 s30, s29, 6
  s_add_u32 s33, s33, s30
  v_lshrrev_b32 v3, 4, v1
  v_lshlrev_b32 v3, 3, v3
  s_waitcnt lgkmcnt(0)
  buffer_load_dwordx2 v[16:17], v3, s[16:19], s33 offen offset:0
  buffer_load_dwordx2 v[18:19], v3, s[16:19], s33 offen offset:32
  s_mul_i32 s30, s28, 12288
  v_lshlrev_b32 v2, 4, v1
  v_add_u32 v6, s30, v2
  v_lshrrev_b32 v2, 4, v1
  v_bfe_u32 v3, v1, 2, 2
  v_lshl_add_u32 v3, v2, 3, v3
  v_lshrrev_b32 v2, 1, v3
  v_xor_b32 v2, v2, v3
  v_bfe_u32 v2, v2, 2, 1
  v_bfe_u32 v4, v3, 1, 1
  v_lshl_add_u32 v2, v2, 1, v4
  v_lshrrev_b32 v4, 3, v3
  v_mul_u32_u24 v4, 2048, v4
  v_and_b32 v3, 7, v3
  v_lshl_add_u32 v4, v3, 7, v4
  v_and_b32 v3, 3, v1
  v_lshl_add_u32 v4, v3, 3, v4
  v_xor_b32 v3, 0, v2
  v_lshl_add_u32 v7, v3, 5, v4
  v_xor_b32 v3, 1, v2
  v_lshl_add_u32 v8, v3, 5, v4
  v_xor_b32 v3, 2, v2
  v_lshl_add_u32 v9, v3, 5, v4
  v_xor_b32 v3, 3, v2
  v_lshl_add_u32 v10, v3, 5, v4
  s_lshr_b32 s30, s29, 1
  s_lshl_b32 s30, s30, 10
  s_add_u32 s30, s30, 12288
  s_and_b32 s31, s29, 1
  s_lshl_b32 s31, s31, 6
  v_xor_b32 v7, s31, v7
  v_add_u32 v7, s30, v7
  v_xor_b32 v8, s31, v8
  v_add_u32 v8, s30, v8
  v_xor_b32 v9, s31, v9
  v_add_u32 v9, s30, v9
  v_xor_b32 v10, s31, v10
  v_add_u32 v10, s30, v10
  s_mov_b32 s24, 0
  s_waitcnt vmcnt(0)
  v_lshlrev_b32 v112, 16, v16
  v_and_b32 v113, 0xffff0000, v16
  v_lshlrev_b32 v114, 16, v17
  v_and_b32 v115, 0xffff0000, v17
  v_lshlrev_b32 v116, 16, v16
  v_and_b32 v117, 0xffff0000, v16
  v_lshlrev_b32 v118, 16, v17
  v_and_b32 v119, 0xffff0000, v17
  v_lshlrev_b32 v120, 16, v16
  v_and_b32 v121, 0xffff0000, v16
  v_lshlrev_b32 v122, 16, v17
  v_and_b32 v123, 0xffff0000, v17
  v_lshlrev_b32 v124, 16, v16
  v_and_b32 v125, 0xffff0000, v16
  v_lshlrev_b32 v126, 16, v17
  v_and_b32 v127, 0xffff0000, v17
  v_lshlrev_b32 v128, 16, v16
  v_and_b32 v129, 0xffff0000, v16
  v_lshlrev_b32 v130, 16, v17
  v_and_b32 v131, 0xffff0000, v17
  v_lshlrev_b32 v132, 16, v16
  v_and_b32 v133, 0xffff0000, v16
  v_lshlrev_b32 v134, 16, v17
  v_and_b32 v135, 0xffff0000, v17
  v_lshlrev_b32 v136, 16, v18
  v_and_b32 v137, 0xffff0000, v18
  v_lshlrev_b32 v138, 16, v19
  v_and_b32 v139, 0xffff0000, v19
  v_lshlrev_b32 v140, 16, v18
  v_and_b32 v141, 0xffff0000, v18
  v_lshlrev_b32 v142, 16, v19
  v_and_b32 v143, 0xffff0000, v19
  v_lshlrev_b32 v144, 16, v18
  v_and_b32 v145, 0xffff0000, v18
  v_lshlrev_b32 v146, 16, v19
  v_and_b32 v147, 0xffff0000, v19
  v_lshlrev_b32 v148, 16, v18
  v_and_b32 v149, 0xffff0000, v18
  v_lshlrev_b32 v150, 16, v19
  v_and_b32 v151, 0xffff0000, v19
  v_lshlrev_b32 v152, 16, v18
  v_and_b32 v153, 0xffff0000, v18
  v_lshlrev_b32 v154, 16, v19
  v_and_b32 v155, 0xffff0000, v19
  v_lshlrev_b32 v156, 16, v18
  v_and_b32 v157, 0xffff0000, v18
  v_lshlrev_b32 v158, 16, v19
  v_and_b32 v159, 0xffff0000, v19
  v_add_u32 v11, s24, v6
  v_add_u32 v12, s24, v7
  v_add_u32 v13, s24, v8
  v_add_u32 v14, s24, v9
  v_add_u32 v15, s24, v10
  s_barrier
  s_barrier
  ds_read_b64_tr_b16 v[48:49], v12 offset:0
  ds_read_b64_tr_b16 v[50:51], v14 offset:512
  ds_read_b64_tr_b16 v[52:53], v12 offset:8192
  ds_read_b64_tr_b16 v[54:55], v14 offset:8704
  ds_read_b64_tr_b16 v[56:57], v13 offset:0
  ds_read_b64_tr_b16 v[58:59], v15 offset:512
  ds_read_b64_tr_b16 v[60:61], v13 offset:8192
  ds_read_b64_tr_b16 v[62:63], v15 offset:8704
  ds_read_b128 v[80:83], v11 offset:0
  ds_read_b128 v[84:87], v11 offset:1024
  ds_read_b128 v[88:91], v11 offset:2048
  ds_read_b128 v[92:95], v11 offset:3072
  ds_read_b128 v[96:99], v11 offset:4096
  ds_read_b128 v[100:103], v11 offset:5120
  s_mov_b32 s25, 16
.p2align 3
L_loop_mlpa:
  s_waitcnt lgkmcnt(4)
  v_mfma_f32_16x16x32_bf16 v[112:115], v[48:51], v[80:83], v[112:115]
  ds_read_b128 v[104:107], v11 offset:6144
  v_mfma_f32_16x16x32_bf16 v[112:115], v[52:55], v[84:87], v[112:115]
  ds_read_b128 v[108:111], v11 offset:7168
  v_mfma_f32_16x16x32_bf16 v[136:139], v[56:59], v[80:83], v[136:139]
  v_mfma_f32_16x16x32_bf16 v[136:139], v[60:63], v[84:87], v[136:139]
  s_waitcnt lgkmcnt(4)
  v_mfma_f32_16x16x32_bf16 v[116:119], v[48:51], v[88:91], v[116:119]
  ds_read_b128 v[80:83], v11 offset:8192
  v_mfma_f32_16x16x32_bf16 v[116:119], v[52:55], v[92:95], v[116:119]
  ds_read_b128 v[84:87], v11 offset:9216
  v_mfma_f32_16x16x32_bf16 v[140:143], v[56:59], v[88:91], v[140:143]
  v_mfma_f32_16x16x32_bf16 v[140:143], v[60:63], v[92:95], v[140:143]
  s_waitcnt lgkmcnt(4)
  v_mfma_f32_16x16x32_bf16 v[120:123], v[48:51], v[96:99], v[120:123]
  ds_read_b128 v[88:91], v11 offset:10240
  v_mfma_f32_16x16x32_bf16 v[120:123], v[52:55], v[100:103], v[120:123]
  ds_read_b128 v[92:95], v11 offset:11264
  v_mfma_f32_16x16x32_bf16 v[144:147], v[56:59], v[96:99], v[144:147]
  v_mfma_f32_16x16x32_bf16 v[144:147], v[60:63], v[100:103], v[144:147]
  s_waitcnt lgkmcnt(4)
  v_mfma_f32_16x16x32_bf16 v[124:127], v[48:51], v[104:107], v[124:127]
  s_add_u32 s24, s24, 28672
  s_cmp_eq_u32 s24, 114688
  s_cselect_b32 s24, 0, s24
  v_add_u32 v11, s24, v6
  v_mfma_f32_16x16x32_bf16 v[124:127], v[52:55], v[108:111], v[124:127]
  v_add_u32 v12, s24, v7
  v_add_u32 v13, s24, v8
  v_add_u32 v14, s24, v9
  v_add_u32 v15, s24, v10
  v_mfma_f32_16x16x32_bf16 v[148:151], v[56:59], v[104:107], v[148:151]
  s_waitcnt lgkmcnt(0)
  s_barrier
  v_mfma_f32_16x16x32_bf16 v[148:151], v[60:63], v[108:111], v[148:151]
  ds_read_b64_tr_b16 v[64:65], v12 offset:0
  ds_read_b64_tr_b16 v[66:67], v14 offset:512
  v_mfma_f32_16x16x32_bf16 v[128:131], v[48:51], v[80:83], v[128:131]
  ds_read_b64_tr_b16 v[68:69], v12 offset:8192
  ds_read_b64_tr_b16 v[70:71], v14 offset:8704
  v_mfma_f32_16x16x32_bf16 v[128:131], v[52:55], v[84:87], v[128:131]
  ds_read_b64_tr_b16 v[72:73], v13 offset:0
  ds_read_b64_tr_b16 v[74:75], v15 offset:512
  v_mfma_f32_16x16x32_bf16 v[152:155], v[56:59], v[80:83], v[152:155]
  ds_read_b64_tr_b16 v[76:77], v13 offset:8192
  ds_read_b64_tr_b16 v[78:79], v15 offset:8704
  v_mfma_f32_16x16x32_bf16 v[152:155], v[60:63], v[84:87], v[152:155]
  ds_read_b128 v[96:99], v11 offset:0
  ds_read_b128 v[100:103], v11 offset:1024
  v_mfma_f32_16x16x32_bf16 v[132:135], v[48:51], v[88:91], v[132:135]
  ds_read_b128 v[104:107], v11 offset:2048
  ds_read_b128 v[108:111], v11 offset:3072
  v_mfma_f32_16x16x32_bf16 v[132:135], v[52:55], v[92:95], v[132:135]
  ds_read_b128 v[80:83], v11 offset:4096
  ds_read_b128 v[84:87], v11 offset:5120
  v_mfma_f32_16x16x32_bf16 v[156:159], v[56:59], v[88:91], v[156:159]
  v_mfma_f32_16x16x32_bf16 v[156:159], v[60:63], v[92:95], v[156:159]
  s_waitcnt lgkmcnt(4)
  v_mfma_f32_16x16x32_bf16 v[112:115], v[64:67], v[96:99], v[112:115]
  ds_read_b128 v[88:91], v11 offset:6144
  v_mfma_f32_16x16x32_bf16 v[112:115], v[68:71], v[100:103], v[112:115]
  ds_read_b128 v[92:95], v11 offset:7168
  v_mfma_f32_16x16x32_bf16 v[136:139], v[72:75], v[96:99], v[136:139]
  v_mfma_f32_16x16x32_bf16 v[136:139], v[76:79], v[100:103], v[136:139]
  s_waitcnt lgkmcnt(4)
  v_mfma_f32_16x16x32_bf16 v[116:119], v[64:67], v[104:107], v[116:119]
  ds_read_b128 v[96:99], v11 offset:8192
  v_mfma_f32_16x16x32_bf16 v[116:119], v[68:71], v[108:111], v[116:119]
  ds_read_b128 v[100:103], v11 offset:9216
  v_mfma_f32_16x16x32_bf16 v[140:143], v[72:75], v[104:107], v[140:143]
  v_mfma_f32_16x16x32_bf16 v[140:143], v[76:79], v[108:111], v[140:143]
  s_waitcnt lgkmcnt(4)
  v_mfma_f32_16x16x32_bf16 v[120:123], v[64:67], v[80:83], v[120:123]
  ds_read_b128 v[104:107], v11 offset:10240
  v_mfma_f32_16x16x32_bf16 v[120:123], v[68:71], v[84:87], v[120:123]
  ds_read_b128 v[108:111], v11 offset:11264
  v_mfma_f32_16x16x32_bf16 v[144:147], v[72:75], v[80:83], v[144:147]
  v_mfma_f32_16x16x32_bf16 v[144:147], v[76:79], v[84:87], v[144:147]
  s_waitcnt lgkmcnt(4)
  v_mfma_f32_16x16x32_bf16 v[124:127], v[64:67], v[88:91], v[124:127]
  s_add_u32 s24, s24, 28672
  s_cmp_eq_u32 s24, 114688
  s_cselect_b32 s24, 0, s24
  v_add_u32 v11, s24, v6
  v_mfma_f32_16x16x32_bf16 v[124:127], v[68:71], v[92:95], v[124:127]
  v_add_u32 v12, s24, v7
  v_add_u32 v13, s24, v8
  v_add_u32 v14, s24, v9
  v_add_u32 v15, s24, v10
  v_mfma_f32_16x16x32_bf16 v[148:151], v[72:75], v[88:91], v[148:151]
  s_waitcnt lgkmcnt(0)
  s_barrier
  v_mfma_f32_16x16x32_bf16 v[148:151], v[76:79], v[92:95], v[148:151]
  ds_read_b64_tr_b16 v[48:49], v12 offset:0
  ds_read_b64_tr_b16 v[50:51], v14 offset:512
  v_mfma_f32_16x16x32_bf16 v[128:131], v[64:67], v[96:99], v[128:131]
  ds_read_b64_tr_b16 v[52:53], v12 offset:8192
  ds_read_b64_tr_b16 v[54:55], v14 offset:8704
  v_mfma_f32_16x16x32_bf16 v[128:131], v[68:71], v[100:103], v[128:131]
  ds_read_b64_tr_b16 v[56:57], v13 offset:0
  ds_read_b64_tr_b16 v[58:59], v15 offset:512
  v_mfma_f32_16x16x32_bf16 v[152:155], v[72:75], v[96:99], v[152:155]
  ds_read_b64_tr_b16 v[60:61], v13 offset:8192
  ds_read_b64_tr_b16 v[62:63], v15 offset:8704
  v_mfma_f32_16x16x32_bf16 v[152:155], v[76:79], v[100:103], v[152:155]
  ds_read_b128 v[80:83], v11 offset:0
  ds_read_b128 v[84:87], v11 offset:1024
  v_mfma_f32_16x16x32_bf16 v[132:135], v[64:67], v[104:107], v[132:135]
  ds_read_b128 v[88:91], v11 offset:2048
  ds_read_b128 v[92:95], v11 offset:3072
  v_mfma_f32_16x16x32_bf16 v[132:135], v[68:71], v[108:111], v[132:135]
  ds_read_b128 v[96:99], v11 offset:4096
  ds_read_b128 v[100:103], v11 offset:5120
  v_mfma_f32_16x16x32_bf16 v[156:159], v[72:75], v[104:107], v[156:159]
  v_mfma_f32_16x16x32_bf16 v[156:159], v[76:79], v[108:111], v[156:159]
  s_sub_u32 s25, s25, 1
  s_cmp_lg_u32 s25, 0
  s_cbranch_scc1 L_loop_mlpa
  s_waitcnt lgkmcnt(0)
  s_lshl_b32 s31, s29, 10
  s_add_u32 s27, s27, s31
  v_lshlrev_b32 v2, 4, v1
  v_mov_b32 v3, 0xc0135761
  s_mov_b32 s35, 0xbdd2d3e8
  s_mul_i32 s30, s29, 6144
  v_add_u32 v4, s30, v2
  ds_write_b128 v4, v[124:127] offset:0
  ds_write_b128 v4, v[148:151] offset:1024
  ds_write_b128 v4, v[128:131] offset:2048
  ds_write_b128 v4, v[152:155] offset:3072
  ds_write_b128 v4, v[132:135] offset:4096
  ds_write_b128 v4, v[156:159] offset:5120
  s_waitcnt lgkmcnt(0)
  s_barrier
  v_mul_f32 v16, v112, v112
  v_mul_f32 v17, v113, v113
  v_mul_f32 v18, v114, v114
  v_mul_f32 v19, v115, v115
  v_mul_f32 v20, v136, v136
  v_mul_f32 v21, v137, v137
  v_mul_f32 v22, v138, v138
  v_mul_f32 v23, v139, v139
  v_fma_f32 v16, v16, s35, v3
  v_fma_f32 v17, v17, s35, v3
  v_fma_f32 v18, v18, s35, v3
  v_fma_f32 v19, v19, s35, v3
  v_fma_f32 v20, v20, s35, v3
  v_fma_f32 v21, v21, s35, v3
  v_fma_f32 v22, v22, s35, v3
  v_fma_f32 v23, v23, s35, v3
  v_mul_f32 v16, v112, v16
  v_mul_f32 v17, v113, v17
  v_mul_f32 v18, v114, v18
  v_mul_f32 v19, v115, v19
  v_mul_f32 v20, v136, v20
  v_mul_f32 v21, v137, v21
  v_mul_f32 v22, v138, v22
  v_mul_f32 v23, v139, v23
  v_exp_f32 v16, v16
  v_exp_f32 v17, v17
  v_exp_f32 v18, v18
  v_exp_f32 v19, v19
  v_exp_f32 v20, v20
  v_exp_f32 v21, v21
  v_exp_f32 v22, v22
  v_exp_f32 v23, v23
  v_add_f32 v16, 1.0, v16
  v_add_f32 v17, 1.0, v17
  v_add_f32 v18, 1.0, v18
  v_add_f32 v19, 1.0, v19
  v_add_f32 v20, 1.0, v20
  v_add_f32 v21, 1.0, v21
  v_add_f32 v22, 1.0, v22
  v_add_f32 v23, 1.0, v23
  v_rcp_f32 v16, v16
  v_rcp_f32 v17, v17
  v_rcp_f32 v18, v18
  v_rcp_f32 v19, v19
  v_rcp_f32 v20, v20
  v_rcp_f32 v21, v21
  v_rcp_f32 v22, v22
  v_rcp_f32 v23, v23
  v_mul_f32 v16, v112, v16
  v_mul_f32 v17, v113, v17
  v_mul_f32 v18, v114, v18
  v_mul_f32 v19, v115, v19
  v_mul_f32 v20, v136, v20
  v_mul_f32 v21, v137, v21
  v_mul_f32 v22, v138, v22
  v_mul_f32 v23, v139, v23
  v_cvt_pk_bf16_f32 v112, v16, v17
  v_cvt_pk_bf16_f32 v113, v18, v19
  v_cvt_pk_bf16_f32 v114, v20, v21
  v_cvt_pk_bf16_f32 v115, v22, v23
  s_add_u32 s30, s27, 0
  buffer_store_dwordx4 v[112:115], v2, s[12:15], s30 offen sc1
  v_mul_f32 v24, v116, v116
  v_mul_f32 v25, v117, v117
  v_mul_f32 v26, v118, v118
  v_mul_f32 v27, v119, v119
  v_mul_f32 v28, v140, v140
  v_mul_f32 v29, v141, v141
  v_mul_f32 v30, v142, v142
  v_mul_f32 v31, v143, v143
  v_fma_f32 v24, v24, s35, v3
  v_fma_f32 v25, v25, s35, v3
  v_fma_f32 v26, v26, s35, v3
  v_fma_f32 v27, v27, s35, v3
  v_fma_f32 v28, v28, s35, v3
  v_fma_f32 v29, v29, s35, v3
  v_fma_f32 v30, v30, s35, v3
  v_fma_f32 v31, v31, s35, v3
  v_mul_f32 v24, v116, v24
  v_mul_f32 v25, v117, v25
  v_mul_f32 v26, v118, v26
  v_mul_f32 v27, v119, v27
  v_mul_f32 v28, v140, v28
  v_mul_f32 v29, v141, v29
  v_mul_f32 v30, v142, v30
  v_mul_f32 v31, v143, v31
  v_exp_f32 v24, v24
  v_exp_f32 v25, v25
  v_exp_f32 v26, v26
  v_exp_f32 v27, v27
  v_exp_f32 v28, v28
  v_exp_f32 v29, v29
  v_exp_f32 v30, v30
  v_exp_f32 v31, v31
  v_add_f32 v24, 1.0, v24
  v_add_f32 v25, 1.0, v25
  v_add_f32 v26, 1.0, v26
  v_add_f32 v27, 1.0, v27
  v_add_f32 v28, 1.0, v28
  v_add_f32 v29, 1.0, v29
  v_add_f32 v30, 1.0, v30
  v_add_f32 v31, 1.0, v31
  v_rcp_f32 v24, v24
  v_rcp_f32 v25, v25
  v_rcp_f32 v26, v26
  v_rcp_f32 v27, v27
  v_rcp_f32 v28, v28
  v_rcp_f32 v29, v29
  v_rcp_f32 v30, v30
  v_rcp_f32 v31, v31
  v_mul_f32 v24, v116, v24
  v_mul_f32 v25, v117, v25
  v_mul_f32 v26, v118, v26
  v_mul_f32 v27, v119, v27
  v_mul_f32 v28, v140, v28
  v_mul_f32 v29, v141, v29
  v_mul_f32 v30, v142, v30
  v_mul_f32 v31, v143, v31
  v_cvt_pk_bf16_f32 v116, v24, v25
  v_cvt_pk_bf16_f32 v117, v26, v27
  v_cvt_pk_bf16_f32 v118, v28, v29
  v_cvt_pk_bf16_f32 v119, v30, v31
  s_add_u32 s30, s27, 147456
  buffer_store_dwordx4 v[116:119], v2, s[12:15], s30 offen sc1
  v_mul_f32 v16, v120, v120
  v_mul_f32 v17, v121, v121
  v_mul_f32 v18, v122, v122
  v_mul_f32 v19, v123, v123
  v_mul_f32 v20, v144, v144
  v_mul_f32 v21, v145, v145
  v_mul_f32 v22, v146, v146
  v_mul_f32 v23, v147, v147
  v_fma_f32 v16, v16, s35, v3
  v_fma_f32 v17, v17, s35, v3
  v_fma_f32 v18, v18, s35, v3
  v_fma_f32 v19, v19, s35, v3
  v_fma_f32 v20, v20, s35, v3
  v_fma_f32 v21, v21, s35, v3
  v_fma_f32 v22, v22, s35, v3
  v_fma_f32 v23, v23, s35, v3
  v_mul_f32 v16, v120, v16
  v_mul_f32 v17, v121, v17
  v_mul_f32 v18, v122, v18
  v_mul_f32 v19, v123, v19
  v_mul_f32 v20, v144, v20
  v_mul_f32 v21, v145, v21
  v_mul_f32 v22, v146, v22
  v_mul_f32 v23, v147, v23
  v_exp_f32 v16, v16
  v_exp_f32 v17, v17
  v_exp_f32 v18, v18
  v_exp_f32 v19, v19
  v_exp_f32 v20, v20
  v_exp_f32 v21, v21
  v_exp_f32 v22, v22
  v_exp_f32 v23, v23
  v_add_f32 v16, 1.0, v16
  v_add_f32 v17, 1.0, v17
  v_add_f32 v18, 1.0, v18
  v_add_f32 v19, 1.0, v19
  v_add_f32 v20, 1.0, v20
  v_add_f32 v21, 1.0, v21
  v_add_f32 v22, 1.0, v22
  v_add_f32 v23, 1.0, v23
  v_rcp_f32 v16, v16
  v_rcp_f32 v17, v17
  v_rcp_f32 v18, v18
  v_rcp_f32 v19, v19
  v_rcp_f32 v20, v20
  v_rcp_f32 v21, v21
  v_rcp_f32 v22, v22
  v_rcp_f32 v23, v23
  v_mul_f32 v16, v120, v16
  v_mul_f32 v17, v121, v17
  v_mul_f32 v18, v122, v18
  v_mul_f32 v19, v123, v19
  v_mul_f32 v20, v144, v20
  v_mul_f32 v21, v145, v21
  v_mul_f32 v22, v146, v22
  v_mul_f32 v23, v147, v23
  v_cvt_pk_bf16_f32 v120, v16, v17
  v_cvt_pk_bf16_f32 v121, v18, v19
  v_cvt_pk_bf16_f32 v122, v20, v21
  v_cvt_pk_bf16_f32 v123, v22, v23
  s_add_u32 s30, s27, 294912
  buffer_store_dwordx4 v[120:123], v2, s[12:15], s30 offen sc1
  s_branch L_phM2_front_kernel
L_phM2s_front_kernel:
  s_mov_b32 s96, -1
L_phM2_front_kernel:
  s_load_dwordx2 s[8:9], s[0:1], 72
  s_mov_b32 s10, 0x1200000
  s_mov_b32 s11, 0x00020000
  v_mov_b32 v245, 0
  v_mov_b32 v246, 163584
  s_and_b32 s30, s2, 7
  s_lshl_b32 s43, s30, 7
  s_add_u32 s43, s43, 50304
  s_lshr_b32 s31, s2, 3
  s_lshr_b32 s32, s31, 2
  s_and_b32 s33, s31, 3
  s_and_b32 s31, s30, 1
  s_lshl_b32 s31, s31, 3
  s_add_u32 s32, s32, s31
  s_lshr_b32 s30, s30, 1
  s_mul_i32 s36, s33, 1327104
  s_mul_i32 s31, s30, 36864
  s_add_u32 s36, s36, s31
  s_add_u32 s36, s36, 7143424
  s_mul_i32 s37, s30, 4718592
  s_lshl_b32 s31, s32, 8
  s_add_u32 s37, s37, s31
  s_mul_i32 s27, s30, 2359296
  s_mul_i32 s31, s32, 36864
  s_add_u32 s27, s27, s31
  s_mul_i32 s31, s33, 589824
  s_add_u32 s27, s27, s31
  s_add_u32 s27, s27, 117440512
  s_lshl_b32 s97, s32, 7
  s_add_u32 s97, s97, 51328
  s_waitcnt vmcnt(0) lgkmcnt(0)
  s_barrier
  s_cmp_lg_u32 s20, 2
  s_cbranch_scc1 L_o26_front_kernel
  s_cmp_lt_i32 s96, 0
  s_cbranch_scc1 L_nsu_front_kernel
  s_mul_i32 s30, s96, 57
  s_lshr_b32 s30, s30, 9
  s_mul_i32 s31, s30, 9
  s_sub_u32 s31, s96, s31
  s_lshl_b32 s30, s30, 8
  s_and_b32 s25, s31, 12
  s_add_u32 s30, s30, s25
  s_add_u32 s30, s30, 50304
  s_and_b32 s31, s31, 3
  s_lshl_b32 s31, s31, 3
  s_lshl_b32 s31, 1, s31
  v_lshlrev_b32 v249, 7, v1
  v_mov_b32 v250, s31
  s_mov_b64 exec, 3
  buffer_atomic_add v250, v249, s[4:7], s30 offen sc1
  s_mov_b64 exec, -1
L_nsu_front_kernel:
L_o26_front_kernel:
  s_cmp_lg_u32 s20, 4
  s_cbranch_scc1 L_o27_front_kernel
  buffer_load_dwordx4 v[248:251], v245, s[4:7], s43 offen sc1
L_o27_front_kernel:
  s_cmp_ge_u32 s20, 4
  s_cbranch_scc0 L_cons_mlpb
  s_sub_u32 s20, s20, 4
  s_lshl_b32 s23, s20, 10
  s_lshr_b32 s30, s20, 1
  s_and_b32 s31, s20, 1
  s_mul_i32 s30, s30, 147456
  s_lshl_b32 s31, s31, 10
  s_add_u32 s30, s30, s31
  v_lshlrev_b32 v2, 4, v1
  v_add_u32 v2, s30, v2
  s_mov_b32 s50, 0
  s_mul_i32 s30, s50, 294912
  s_lshl_b32 s50, s50, 12
  v_add_u32 v8, s30, v2
  s_mov_b32 s51, 1
  s_mul_i32 s30, s51, 294912
  s_lshl_b32 s51, s51, 12
  v_add_u32 v9, s30, v2
  s_mov_b32 s52, 2
  s_mul_i32 s30, s52, 294912
  s_lshl_b32 s52, s52, 12
  v_add_u32 v10, s30, v2
  s_mov_b32 s53, 3
  s_mul_i32 s30, s53, 294912
  s_lshl_b32 s53, s53, 12
  v_add_u32 v11, s30, v2
  s_mov_b32 s54, 4
  s_mul_i32 s30, s54, 294912
  s_lshl_b32 s54, s54, 12
  s_cmp_lt_u32 s20, 2
  s_cselect_b32 s30, s30, 2130706432
  v_add_u32 v12, s30, v2
  s_waitcnt lgkmcnt(0)
  s_lshr_b32 s31, s20, 1
  v_lshrrev_b32 v2, 3, v1
  v_bfe_u32 v3, v2, 2, 1
  v_xor_b32 v3, s31, v3
  v_bfe_u32 v4, v2, 1, 1
  v_lshl_add_u32 v3, v3, 1, v4
  v_bfe_u32 v4, v1, 1, 2
  v_xor_b32 v3, v3, v4
  v_and_b32 v4, 1, v1
  v_lshlrev_b32 v4, 4, v4
  v_lshl_add_u32 v3, v3, 5, v4
  s_mov_b32 s30, 4096
  v_mad_u32_u24 v13, v2, s30, v3
  s_mul_i32 s30, s31, 32768
  s_and_b32 s31, s20, 1
  s_lshl_b32 s31, s31, 7
  s_add_u32 s30, s30, s31
  v_add_u32 v2, s30, v13
  s_mov_b32 s55, 0
  s_mul_i32 s30, s55, 65536
  s_lshl_b32 s55, s55, 12
  s_add_u32 s55, s55, 20480
  v_add_u32 v13, s30, v2
  s_mov_b32 s56, 1
  s_mul_i32 s30, s56, 65536
  s_lshl_b32 s56, s56, 12
  s_add_u32 s56, s56, 20480
  v_add_u32 v14, s30, v2
  s_mov_b32 s57, 2
  s_mul_i32 s30, s57, 65536
  s_lshl_b32 s57, s57, 12
  s_add_u32 s57, s57, 20480
  v_add_u32 v15, s30, v2
  s_mov_b32 s58, 3
  s_mul_i32 s30, s58, 65536
  s_lshl_b32 s58, s58, 12
  s_add_u32 s58, s58, 20480
  v_add_u32 v16, s30, v2
  s_mov_b32 s38, 0
  v_mov_b32 v30, 0
  v_mov_b32 v31, 163584
  s_cmp_lg_u32 s20, 0
  s_cbranch_scc1 L_s1_mlpb
  s_waitcnt vmcnt(0)
  v_readfirstlane_b32 s31, v248
  s_nop 0
  s_add_u32 s31, s31, 0x02020202
  s_lshr_b32 s31, s31, 3
  s_and_b32 s31, s31, 0x01010101
  s_mul_i32 s31, s31, 0x01020408
  s_lshr_b32 s31, s31, 24
  s_mov_b32 s30, s31
  v_readfirstlane_b32 s31, v249
  s_nop 0
  s_add_u32 s31, s31, 0x02020202
  s_lshr_b32 s31, s31, 3
  s_and_b32 s31, s31, 0x01010101
  s_mul_i32 s31, s31, 0x01020408
  s_lshr_b32 s31, s31, 24
  s_lshl_b32 s31, s31, 4
  s_or_b32 s30, s30, s31
  v_readfirstlane_b32 s31, v250
  s_nop 0
  s_add_u32 s31, s31, 0x02020202
  s_lshr_b32 s31, s31, 3
  s_and_b32 s31, s31, 0x01010101
  s_mul_i32 s31, s31, 0x01020408
  s_lshr_b32 s31, s31, 24
  s_lshl_b32 s31, s31, 8
  s_or_b32 s30, s30, s31
L_s0_mlpb:
  s_and_b32 s31, s30, 3
  s_bcnt1_i32_b32 s31, s31
  s_cmp_ge_u32 s31, 2
  s_cbranch_scc1 L_s2_mlpb
  s_add_u32 s100, s100, 1
  s_cmp_gt_u32 s100, 0x20000
  s_cbranch_scc1 L_end_front_kernel
  s_sleep 2
  buffer_load_dwordx4 v[24:27], v30, s[4:7], s43 offen sc1
  s_waitcnt vmcnt(0)
  v_readfirstlane_b32 s31, v24
  s_nop 0
  s_add_u32 s31, s31, 0x02020202
  s_lshr_b32 s31, s31, 3
  s_and_b32 s31, s31, 0x01010101
  s_mul_i32 s31, s31, 0x01020408
  s_lshr_b32 s31, s31, 24
  s_mov_b32 s30, s31
  v_readfirstlane_b32 s31, v25
  s_nop 0
  s_add_u32 s31, s31, 0x02020202
  s_lshr_b32 s31, s31, 3
  s_and_b32 s31, s31, 0x01010101
  s_mul_i32 s31, s31, 0x01020408
  s_lshr_b32 s31, s31, 24
  s_lshl_b32 s31, s31, 4
  s_or_b32 s30, s30, s31
  v_readfirstlane_b32 s31, v26
  s_nop 0
  s_add_u32 s31, s31, 0x02020202
  s_lshr_b32 s31, s31, 3
  s_and_b32 s31, s31, 0x01010101
  s_mul_i32 s31, s31, 0x01020408
  s_lshr_b32 s31, s31, 24
  s_lshl_b32 s31, s31, 8
  s_or_b32 s30, s30, s31
  s_branch L_s0_mlpb
L_s2_mlpb:
  v_mov_b32 v29, s30
  ds_write_b32 v31, v29
  s_waitcnt lgkmcnt(0)
L_s1_mlpb:
  s_barrier
  ds_read_b32 v28, v31
  s_waitcnt lgkmcnt(0)
  v_readfirstlane_b32 s39, v28
  s_ff0_i32_b32 s31, s38
  s_bitset1_b32 s38, s31
  s_lshl_b32 s30, s31, 12
  s_add_u32 s21, s36, s30
  s_mul_i32 s30, s31, 524288
  s_add_u32 s22, s37, s30
  s_add_u32 m0, s23, s50
  s_nop 0
  buffer_load_dwordx4 v8, s[4:7], s21 offen lds
  s_add_u32 m0, s23, s51
  s_nop 0
  buffer_load_dwordx4 v9, s[4:7], s21 offen lds
  s_add_u32 m0, s23, s52
  s_nop 0
  buffer_load_dwordx4 v10, s[4:7], s21 offen lds
  s_add_u32 m0, s23, s53
  s_nop 0
  buffer_load_dwordx4 v11, s[4:7], s21 offen lds
  s_add_u32 m0, s23, s54
  s_nop 0
  buffer_load_dwordx4 v12, s[4:7], s21 offen lds
  s_add_u32 m0, s23, s55
  s_nop 0
  buffer_load_dwordx4 v13, s[8:11], s22 offen lds
  s_add_u32 m0, s23, s56
  s_nop 0
  buffer_load_dwordx4 v14, s[8:11], s22 offen lds
  s_add_u32 m0, s23, s57
  s_nop 0
  buffer_load_dwordx4 v15, s[8:11], s22 offen lds
  s_add_u32 m0, s23, s58
  s_nop 0
  buffer_load_dwordx4 v16, s[8:11], s22 offen lds
  s_add_u32 s21, s21, 2048
  s_add_u32 s22, s22, 262144
  s_add_u32 s23, s23, 36864
  s_sub_u32 s30, s23, 110592
  s_cmp_ge_u32 s23, 110592
  s_cselect_b32 s23, s30, s23
  s_waitcnt vmcnt(0)
  s_barrier
  s_mov_b32 s28, 17
  s_mov_b32 s29, 1
L_lloop_mlpb:
  s_bitcmp0_b32 s28, 0
  s_cbranch_scc0 L_np_mlpb
  s_cmp_eq_u32 s39, 0x1ff
  s_cbranch_scc1 L_nf_mlpb
  s_cmp_lg_u32 s20, 0
  s_cbranch_scc1 L_nf_mlpb
  buffer_load_dwordx4 v[24:27], v30, s[4:7], s43 offen sc1
L_nf_mlpb:
  s_ff0_i32_b32 s31, s38
  s_bitset1_b32 s38, s31
  s_lshl_b32 s30, s31, 12
  s_add_u32 s21, s36, s30
  s_mul_i32 s30, s31, 524288
  s_add_u32 s22, s37, s30
L_np_mlpb:
  s_add_u32 m0, s23, s55
  s_nop 0
  buffer_load_dwordx4 v13, s[8:11], s22 offen lds
  s_add_u32 m0, s23, s56
  s_nop 0
  buffer_load_dwordx4 v14, s[8:11], s22 offen lds
  s_add_u32 m0, s23, s57
  s_nop 0
  buffer_load_dwordx4 v15, s[8:11], s22 offen lds
  s_add_u32 m0, s23, s58
  s_nop 0
  buffer_load_dwordx4 v16, s[8:11], s22 offen lds
  s_add_u32 m0, s23, s50
  s_nop 0
  buffer_load_dwordx4 v8, s[4:7], s21 offen lds
  s_add_u32 m0, s23, s51
  s_nop 0
  buffer_load_dwordx4 v9, s[4:7], s21 offen lds
  s_add_u32 m0, s23, s52
  s_nop 0
  buffer_load_dwordx4 v10, s[4:7], s21 offen lds
  s_add_u32 m0, s23, s53
  s_nop 0
  buffer_load_dwordx4 v11, s[4:7], s21 offen lds
  s_add_u32 m0, s23, s54
  s_nop 0
  buffer_load_dwordx4 v12, s[4:7], s21 offen lds
  s_add_u32 s21, s21, 2048
  s_add_u32 s22, s22, 262144
  s_add_u32 s23, s23, 36864
  s_sub_u32 s30, s23, 110592
  s_cmp_ge_u32 s23, 110592
  s_cselect_b32 s23, s30, s23
  s_sub_u32 s28, s28, 1
  s_sub_u32 s29, s29, 1
  s_cmp_ge_i32 s29, 0
  s_cbranch_scc1 L_lloop_mlpb
  s_waitcnt vmcnt(9)
  s_cmp_eq_u32 s39, 0x1ff
  s_cbranch_scc1 L_pb_mlpb
  s_bitcmp0_b32 s28, 0
  s_cbranch_scc0 L_pb_mlpb
  s_cmp_eq_u32 s28, 0
  s_cbranch_scc1 L_pb_mlpb
  s_cmp_lg_u32 s20, 0
  s_cbranch_scc1 L_rb_mlpb
L_ck_mlpb:
  v_readfirstlane_b32 s31, v24
  s_nop 0
  s_add_u32 s31, s31, 0x02020202
  s_lshr_b32 s31, s31, 3
  s_and_b32 s31, s31, 0x01010101
  s_mul_i32 s31, s31, 0x01020408
  s_lshr_b32 s31, s31, 24
  s_mov_b32 s30, s31
  v_readfirstlane_b32 s31, v25
  s_nop 0
  s_add_u32 s31, s31, 0x02020202
  s_lshr_b32 s31, s31, 3
  s_and_b32 s31, s31, 0x01010101
  s_mul_i32 s31, s31, 0x01020408
  s_lshr_b32 s31, s31, 24
  s_lshl_b32 s31, s31, 4
  s_or_b32 s30, s30, s31
  v_readfirstlane_b32 s31, v26
  s_nop 0
  s_add_u32 s31, s31, 0x02020202
  s_lshr_b32 s31, s31, 3
  s_and_b32 s31, s31, 0x01010101
  s_mul_i32 s31, s31, 0x01020408
  s_lshr_b32 s31, s31, 24
  s_lshl_b32 s31, s31, 8
  s_or_b32 s30, s30, s31
  s_ff0_i32_b32 s31, s38
  s_bitcmp1_b32 s30, s31
  s_cbranch_scc1 L_pub_mlpb
  s_add_u32 s100, s100, 1
  s_cmp_gt_u32 s100, 0x20000
  s_cbranch_scc1 L_end_front_kernel
  s_sleep 2
  buffer_load_dwordx4 v[24:27], v30, s[4:7], s43 offen sc1
  s_waitcnt vmcnt(0)
  s_branch L_ck_mlpb
L_pub_mlpb:
  v_mov_b32 v29, s30
  ds_write_b32 v31, v29
  s_waitcnt lgkmcnt(0)
L_rb_mlpb:
  s_barrier
  ds_read_b32 v28, v31
  s_waitcnt lgkmcnt(0)
  v_readfirstlane_b32 s39, v28
  s_branch L_lloop_mlpb
L_pb_mlpb:
  s_barrier
  s_cmp_lg_u32 s28, 0
  s_cbranch_scc1 L_lloop_mlpb
  s_mov_b32 s34, 0
  s_lshl_b32 s30, s20, 6
  s_add_u32 s30, s30, 256
  v_add_u32 v32, s30, v1
  s_movk_i32 s30, 3641
  s_movk_i32 s31, 1152
  v_add_u32 v40, 1536, v32
  v_mul_u32_u24 v35, s30, v40
  v_lshrrev_b32 v35, 16, v35
  v_mul_u32_u24 v3, 18, v35
  v_sub_u32 v3, v40, v3
  v_lshlrev_b32 v3, 4, v3
  v_lshlrev_b32 v40, 4, v40
  v_mul_u32_u24 v35, 304, v35
  v_add3_u32 v35, v35, v3, s34
  v_add_u32 v39, 1024, v32
  v_mul_u32_u24 v34, s30, v39
  v_lshrrev_b32 v34, 16, v34
  v_mul_u32_u24 v3, 18, v34
  v_sub_u32 v3, v39, v3
  v_lshlrev_b32 v3, 4, v3
  v_lshlrev_b32 v39, 4, v39
  v_mul_u32_u24 v34, 304, v34
  v_add3_u32 v34, v34, v3, s34
  v_add_u32 v38, 512, v32
  v_mul_u32_u24 v33, s30, v38
  v_lshrrev_b32 v33, 16, v33
  v_mul_u32_u24 v3, 18, v33
  v_sub_u32 v3, v38, v3
  v_lshlrev_b32 v3, 4, v3
  v_lshlrev_b32 v38, 4, v38
  v_mul_u32_u24 v33, 304, v33
  v_add3_u32 v33, v33, v3, s34
  v_mov_b32 v37, v32
  v_mul_u32_u24 v32, s30, v37
  v_lshrrev_b32 v32, 16, v32
  v_mul_u32_u24 v3, 18, v32
  v_sub_u32 v3, v37, v3
  v_lshlrev_b32 v3, 4, v3
  v_lshlrev_b32 v37, 4, v37
  v_mul_u32_u24 v32, 304, v32
  v_add3_u32 v32, v32, v3, s34
  s_waitcnt vmcnt(0)
  s_barrier
  s_waitcnt vmcnt(0)
  s_barrier
  s_barrier
  ds_read_b128 v[48:51], v32
  ds_read_b128 v[52:55], v33
  ds_read_b128 v[56:59], v34
  ds_read_b128 v[60:63], v35
  s_waitcnt lgkmcnt(3)
  buffer_store_dwordx4 v[48:51], v37, s[12:15], s27 offen sc1
  s_waitcnt lgkmcnt(2)
  buffer_store_dwordx4 v[52:55], v38, s[12:15], s27 offen sc1
  s_waitcnt lgkmcnt(1)
  buffer_store_dwordx4 v[56:59], v39, s[12:15], s27 offen sc1
  s_waitcnt lgkmcnt(0)
  buffer_store_dwordx4 v[60:63], v40, s[12:15], s27 offen sc1
  s_add_u32 s20, s20, 4
  s_branch L_phF_front_kernel
L_cons_mlpb:
  s_and_b32 s28, s20, 0
  s_lshr_b32 s29, s20, 0
  s_mul_i32 s30, s28, 18432
  v_lshlrev_b32 v2, 4, v1
  v_add_u32 v6, s30, v2
  v_lshrrev_b32 v2, 4, v1
  v_bfe_u32 v3, v1, 2, 2
  v_lshl_add_u32 v3, v2, 2, v3
  v_lshrrev_b32 v2, 1, v3
  v_xor_b32 v2, v2, v3
  v_bfe_u32 v2, v2, 2, 1
  v_bfe_u32 v4, v3, 1, 1
  v_lshl_add_u32 v2, v2, 1, v4
  v_lshrrev_b32 v4, 3, v3
  v_mul_u32_u24 v4, 2048, v4
  v_and_b32 v3, 7, v3
  v_lshl_add_u32 v4, v3, 7, v4
  v_and_b32 v3, 3, v1
  v_lshl_add_u32 v4, v3, 3, v4
  v_xor_b32 v3, 0, v2
  v_lshl_add_u32 v7, v3, 5, v4
  v_xor_b32 v3, 1, v2
  v_lshl_add_u32 v8, v3, 5, v4
  v_xor_b32 v3, 2, v2
  v_lshl_add_u32 v9, v3, 5, v4
  v_xor_b32 v3, 3, v2
  v_lshl_add_u32 v10, v3, 5, v4
  s_lshr_b32 s30, s29, 1
  s_lshl_b32 s30, s30, 10
  s_add_u32 s30, s30, 20480
  s_and_b32 s31, s29, 1
  s_lshl_b32 s31, s31, 6
  v_xor_b32 v7, s31, v7
  v_add_u32 v7, s30, v7
  v_xor_b32 v8, s31, v8
  v_add_u32 v8, s30, v8
  v_xor_b32 v9, s31, v9
  v_add_u32 v9, s30, v9
  v_xor_b32 v10, s31, v10
  v_add_u32 v10, s30, v10
  s_mov_b32 s24, 0
  s_mov_b32 s34, 0
  s_lshl_b32 s30, s20, 6
  v_add_u32 v36, s30, v1
  s_movk_i32 s30, 3641
  s_movk_i32 s31, 1152
  v_add_u32 v45, 2048, v36
  v_mul_u32_u24 v40, s30, v45
  v_lshrrev_b32 v40, 16, v40
  v_mul_u32_u24 v3, 18, v40
  v_sub_u32 v3, v45, v3
  v_lshlrev_b32 v3, 4, v3
  v_lshlrev_b32 v45, 4, v45
  v_mul_u32_u24 v40, 304, v40
  v_add3_u32 v40, v40, v3, s34
  v_add_u32 v44, 1536, v36
  v_mul_u32_u24 v39, s30, v44
  v_lshrrev_b32 v39, 16, v39
  v_mul_u32_u24 v3, 18, v39
  v_sub_u32 v3, v44, v3
  v_lshlrev_b32 v3, 4, v3
  v_lshlrev_b32 v44, 4, v44
  v_mul_u32_u24 v39, 304, v39
  v_add3_u32 v39, v39, v3, s34
  v_add_u32 v43, 1024, v36
  v_mul_u32_u24 v38, s30, v43
  v_lshrrev_b32 v38, 16, v38
  v_mul_u32_u24 v3, 18, v38
  v_sub_u32 v3, v43, v3
  v_lshlrev_b32 v3, 4, v3
  v_lshlrev_b32 v43, 4, v43
  v_mul_u32_u24 v38, 304, v38
  v_add3_u32 v38, v38, v3, s34
  v_add_u32 v42, 512, v36
  v_mul_u32_u24 v37, s30, v42
  v_lshrrev_b32 v37, 16, v37
  v_mul_u32_u24 v3, 18, v37
  v_sub_u32 v3, v42, v3
  v_lshlrev_b32 v3, 4, v3
  v_lshlrev_b32 v42, 4, v42
  v_mul_u32_u24 v37, 304, v37
  v_add3_u32 v37, v37, v3, s34
  v_mov_b32 v41, v36
  v_mul_u32_u24 v36, s30, v41
  v_lshrrev_b32 v36, 16, v36
  v_mul_u32_u24 v3, 18, v36
  v_sub_u32 v3, v41, v3
  v_lshlrev_b32 v3, 4, v3
  v_lshlrev_b32 v41, 4, v41
  v_mul_u32_u24 v36, 304, v36
  v_add3_u32 v36, v36, v3, s34
  v_mov_b32 v16, 0
  v_mov_b32 v17, 0
  v_mov_b32 v18, 0
  v_mov_b32 v19, 0
  s_nop 1
  v_mfma_f32_32x32x16_bf16 v[128:143], v[16:19], v[16:19], 0
  v_mfma_f32_32x32x16_bf16 v[144:159], v[16:19], v[16:19], 0
  v_mfma_f32_32x32x16_bf16 v[160:175], v[16:19], v[16:19], 0
  v_mfma_f32_32x32x16_bf16 v[176:191], v[16:19], v[16:19], 0
  v_mfma_f32_16x16x32_bf16 v[192:195], v[16:19], v[16:19], 0
  v_mfma_f32_16x16x32_bf16 v[196:199], v[16:19], v[16:19], 0
  v_add_u32 v11, s24, v6
  v_add_u32 v12, s24, v7
  v_add_u32 v13, s24, v8
  v_add_u32 v14, s24, v9
  v_add_u32 v15, s24, v10
  s_barrier
  s_barrier
  ds_read_b64_tr_b16 v[48:49], v12 offset:0
  ds_read_b64_tr_b16 v[50:51], v12 offset:4096
  ds_read_b64_tr_b16 v[52:53], v12 offset:8192
  ds_read_b64_tr_b16 v[54:55], v12 offset:12288
  ds_read_b64_tr_b16 v[56:57], v13 offset:0
  ds_read_b64_tr_b16 v[58:59], v13 offset:4096
  ds_read_b64_tr_b16 v[60:61], v13 offset:8192
  ds_read_b64_tr_b16 v[62:63], v13 offset:12288
  ds_read_b128 v[80:83], v11 offset:0
  ds_read_b128 v[84:87], v11 offset:1024
  ds_read_b128 v[88:91], v11 offset:2048
  ds_read_b128 v[92:95], v11 offset:3072
  ds_read_b128 v[96:99], v11 offset:4096
  ds_read_b128 v[100:103], v11 offset:5120
  s_mov_b32 s25, 9
.p2align 3
L_loop_mlpb:
  s_waitcnt lgkmcnt(4)
  v_mfma_f32_16x16x32_bf16 v[128:131], v[80:83], v[48:51], v[128:131]
  ds_read_b128 v[104:107], v11 offset:6144
  v_mfma_f32_16x16x32_bf16 v[128:131], v[84:87], v[52:55], v[128:131]
  ds_read_b128 v[108:111], v11 offset:7168
  v_mfma_f32_16x16x32_bf16 v[164:167], v[80:83], v[56:59], v[164:167]
  v_mfma_f32_16x16x32_bf16 v[164:167], v[84:87], v[60:63], v[164:167]
  s_waitcnt lgkmcnt(4)
  v_mfma_f32_16x16x32_bf16 v[132:135], v[88:91], v[48:51], v[132:135]
  ds_read_b128 v[112:115], v11 offset:8192
  v_mfma_f32_16x16x32_bf16 v[132:135], v[92:95], v[52:55], v[132:135]
  ds_read_b128 v[116:119], v11 offset:9216
  v_mfma_f32_16x16x32_bf16 v[168:171], v[88:91], v[56:59], v[168:171]
  v_mfma_f32_16x16x32_bf16 v[168:171], v[92:95], v[60:63], v[168:171]
  s_waitcnt lgkmcnt(4)
  v_mfma_f32_16x16x32_bf16 v[136:139], v[96:99], v[48:51], v[136:139]
  ds_read_b128 v[120:123], v11 offset:10240
  v_mfma_f32_16x16x32_bf16 v[136:139], v[100:103], v[52:55], v[136:139]
  ds_read_b128 v[124:127], v11 offset:11264
  v_mfma_f32_16x16x32_bf16 v[172:175], v[96:99], v[56:59], v[172:175]
  v_mfma_f32_16x16x32_bf16 v[172:175], v[100:103], v[60:63], v[172:175]
  s_waitcnt lgkmcnt(4)
  v_mfma_f32_16x16x32_bf16 v[140:143], v[104:107], v[48:51], v[140:143]
  ds_read_b128 v[80:83], v11 offset:12288
  v_mfma_f32_16x16x32_bf16 v[140:143], v[108:111], v[52:55], v[140:143]
  ds_read_b128 v[84:87], v11 offset:13312
  v_mfma_f32_16x16x32_bf16 v[176:179], v[104:107], v[56:59], v[176:179]
  v_mfma_f32_16x16x32_bf16 v[176:179], v[108:111], v[60:63], v[176:179]
  s_waitcnt lgkmcnt(4)
  v_mfma_f32_16x16x32_bf16 v[144:147], v[112:115], v[48:51], v[144:147]
  ds_read_b128 v[88:91], v11 offset:14336
  v_mfma_f32_16x16x32_bf16 v[144:147], v[116:119], v[52:55], v[144:147]
  ds_read_b128 v[92:95], v11 offset:15360
  v_mfma_f32_16x16x32_bf16 v[180:183], v[112:115], v[56:59], v[180:183]
  v_mfma_f32_16x16x32_bf16 v[180:183], v[116:119], v[60:63], v[180:183]
  s_waitcnt lgkmcnt(4)
  v_mfma_f32_16x16x32_bf16 v[148:151], v[120:123], v[48:51], v[148:151]
  ds_read_b128 v[96:99], v11 offset:16384
  v_mfma_f32_16x16x32_bf16 v[148:151], v[124:127], v[52:55], v[148:151]
  ds_read_b128 v[100:103], v11 offset:17408
  v_mfma_f32_16x16x32_bf16 v[184:187], v[120:123], v[56:59], v[184:187]
  v_mfma_f32_16x16x32_bf16 v[184:187], v[124:127], v[60:63], v[184:187]
  s_waitcnt lgkmcnt(4)
  v_mfma_f32_16x16x32_bf16 v[152:155], v[80:83], v[48:51], v[152:155]
  s_add_u32 s24, s24, 36864
  s_cmp_eq_u32 s24, 110592
  s_cselect_b32 s24, 0, s24
  v_add_u32 v11, s24, v6
  v_mfma_f32_16x16x32_bf16 v[152:155], v[84:87], v[52:55], v[152:155]
  v_add_u32 v12, s24, v7
  v_add_u32 v13, s24, v8
  v_add_u32 v14, s24, v9
  v_add_u32 v15, s24, v10
  v_mfma_f32_16x16x32_bf16 v[188:191], v[80:83], v[56:59], v[188:191]
  s_waitcnt lgkmcnt(0)
  s_barrier
  v_mfma_f32_16x16x32_bf16 v[188:191], v[84:87], v[60:63], v[188:191]
  ds_read_b64_tr_b16 v[64:65], v12 offset:0
  ds_read_b64_tr_b16 v[66:67], v12 offset:4096
  v_mfma_f32_16x16x32_bf16 v[156:159], v[88:91], v[48:51], v[156:159]
  ds_read_b64_tr_b16 v[68:69], v12 offset:8192
  ds_read_b64_tr_b16 v[70:71], v12 offset:12288
  v_mfma_f32_16x16x32_bf16 v[156:159], v[92:95], v[52:55], v[156:159]
  ds_read_b64_tr_b16 v[72:73], v13 offset:0
  ds_read_b64_tr_b16 v[74:75], v13 offset:4096
  v_mfma_f32_16x16x32_bf16 v[192:195], v[88:91], v[56:59], v[192:195]
  ds_read_b64_tr_b16 v[76:77], v13 offset:8192
  ds_read_b64_tr_b16 v[78:79], v13 offset:12288
  v_mfma_f32_16x16x32_bf16 v[192:195], v[92:95], v[60:63], v[192:195]
  ds_read_b128 v[104:107], v11 offset:0
  ds_read_b128 v[108:111], v11 offset:1024
  v_mfma_f32_16x16x32_bf16 v[160:163], v[96:99], v[48:51], v[160:163]
  ds_read_b128 v[112:115], v11 offset:2048
  ds_read_b128 v[116:119], v11 offset:3072
  v_mfma_f32_16x16x32_bf16 v[160:163], v[100:103], v[52:55], v[160:163]
  ds_read_b128 v[120:123], v11 offset:4096
  ds_read_b128 v[124:127], v11 offset:5120
  v_mfma_f32_16x16x32_bf16 v[196:199], v[96:99], v[56:59], v[196:199]
  v_mfma_f32_16x16x32_bf16 v[196:199], v[100:103], v[60:63], v[196:199]
  s_waitcnt lgkmcnt(4)
  v_mfma_f32_16x16x32_bf16 v[128:131], v[104:107], v[64:67], v[128:131]
  ds_read_b128 v[80:83], v11 offset:6144
  v_mfma_f32_16x16x32_bf16 v[128:131], v[108:111], v[68:71], v[128:131]
  ds_read_b128 v[84:87], v11 offset:7168
  v_mfma_f32_16x16x32_bf16 v[164:167], v[104:107], v[72:75], v[164:167]
  v_mfma_f32_16x16x32_bf16 v[164:167], v[108:111], v[76:79], v[164:167]
  s_waitcnt lgkmcnt(4)
  v_mfma_f32_16x16x32_bf16 v[132:135], v[112:115], v[64:67], v[132:135]
  ds_read_b128 v[88:91], v11 offset:8192
  v_mfma_f32_16x16x32_bf16 v[132:135], v[116:119], v[68:71], v[132:135]
  ds_read_b128 v[92:95], v11 offset:9216
  v_mfma_f32_16x16x32_bf16 v[168:171], v[112:115], v[72:75], v[168:171]
  v_mfma_f32_16x16x32_bf16 v[168:171], v[116:119], v[76:79], v[168:171]
  s_waitcnt lgkmcnt(4)
  v_mfma_f32_16x16x32_bf16 v[136:139], v[120:123], v[64:67], v[136:139]
  ds_read_b128 v[96:99], v11 offset:10240
  v_mfma_f32_16x16x32_bf16 v[136:139], v[124:127], v[68:71], v[136:139]
  ds_read_b128 v[100:103], v11 offset:11264
  v_mfma_f32_16x16x32_bf16 v[172:175], v[120:123], v[72:75], v[172:175]
  v_mfma_f32_16x16x32_bf16 v[172:175], v[124:127], v[76:79], v[172:175]
  s_waitcnt lgkmcnt(4)
  v_mfma_f32_16x16x32_bf16 v[140:143], v[80:83], v[64:67], v[140:143]
  ds_read_b128 v[104:107], v11 offset:12288
  v_mfma_f32_16x16x32_bf16 v[140:143], v[84:87], v[68:71], v[140:143]
  ds_read_b128 v[108:111], v11 offset:13312
  v_mfma_f32_16x16x32_bf16 v[176:179], v[80:83], v[72:75], v[176:179]
  v_mfma_f32_16x16x32_bf16 v[176:179], v[84:87], v[76:79], v[176:179]
  s_waitcnt lgkmcnt(4)
  v_mfma_f32_16x16x32_bf16 v[144:147], v[88:91], v[64:67], v[144:147]
  ds_read_b128 v[112:115], v11 offset:14336
  v_mfma_f32_16x16x32_bf16 v[144:147], v[92:95], v[68:71], v[144:147]
  ds_read_b128 v[116:119], v11 offset:15360
  v_mfma_f32_16x16x32_bf16 v[180:183], v[88:91], v[72:75], v[180:183]
  v_mfma_f32_16x16x32_bf16 v[180:183], v[92:95], v[76:79], v[180:183]
  s_waitcnt lgkmcnt(4)
  v_mfma_f32_16x16x32_bf16 v[148:151], v[96:99], v[64:67], v[148:151]
  ds_read_b128 v[120:123], v11 offset:16384
  v_mfma_f32_16x16x32_bf16 v[148:151], v[100:103], v[68:71], v[148:151]
  ds_read_b128 v[124:127], v11 offset:17408
  v_mfma_f32_16x16x32_bf16 v[184:187], v[96:99], v[72:75], v[184:187]
  v_mfma_f32_16x16x32_bf16 v[184:187], v[100:103], v[76:79], v[184:187]
  s_waitcnt lgkmcnt(4)
  v_mfma_f32_16x16x32_bf16 v[152:155], v[104:107], v[64:67], v[152:155]
  s_add_u32 s24, s24, 36864
  s_cmp_eq_u32 s24, 110592
  s_cselect_b32 s24, 0, s24
  v_add_u32 v11, s24, v6
  v_mfma_f32_16x16x32_bf16 v[152:155], v[108:111], v[68:71], v[152:155]
  v_add_u32 v12, s24, v7
  v_add_u32 v13, s24, v8
  v_add_u32 v14, s24, v9
  v_add_u32 v15, s24, v10
  v_mfma_f32_16x16x32_bf16 v[188:191], v[104:107], v[72:75], v[188:191]
  s_waitcnt lgkmcnt(0)
  s_barrier
  v_mfma_f32_16x16x32_bf16 v[188:191], v[108:111], v[76:79], v[188:191]
  ds_read_b64_tr_b16 v[48:49], v12 offset:0
  ds_read_b64_tr_b16 v[50:51], v12 offset:4096
  v_mfma_f32_16x16x32_bf16 v[156:159], v[112:115], v[64:67], v[156:159]
  ds_read_b64_tr_b16 v[52:53], v12 offset:8192
  ds_read_b64_tr_b16 v[54:55], v12 offset:12288
  v_mfma_f32_16x16x32_bf16 v[156:159], v[116:119], v[68:71], v[156:159]
  ds_read_b64_tr_b16 v[56:57], v13 offset:0
  ds_read_b64_tr_b16 v[58:59], v13 offset:4096
  v_mfma_f32_16x16x32_bf16 v[192:195], v[112:115], v[72:75], v[192:195]
  ds_read_b64_tr_b16 v[60:61], v13 offset:8192
  ds_read_b64_tr_b16 v[62:63], v13 offset:12288
  v_mfma_f32_16x16x32_bf16 v[192:195], v[116:119], v[76:79], v[192:195]
  ds_read_b128 v[80:83], v11 offset:0
  ds_read_b128 v[84:87], v11 offset:1024
  v_mfma_f32_16x16x32_bf16 v[160:163], v[120:123], v[64:67], v[160:163]
  ds_read_b128 v[88:91], v11 offset:2048
  ds_read_b128 v[92:95], v11 offset:3072
  v_mfma_f32_16x16x32_bf16 v[160:163], v[124:127], v[68:71], v[160:163]
  ds_read_b128 v[96:99], v11 offset:4096
  ds_read_b128 v[100:103], v11 offset:5120
  v_mfma_f32_16x16x32_bf16 v[196:199], v[120:123], v[72:75], v[196:199]
  v_mfma_f32_16x16x32_bf16 v[196:199], v[124:127], v[76:79], v[196:199]
  s_sub_u32 s25, s25, 1
  s_cmp_lg_u32 s25, 0
  s_cbranch_scc1 L_loop_mlpb
  s_waitcnt lgkmcnt(0)
  s_mul_i32 s30, s29, 9728
  s_mul_i32 s31, s28, 288
  s_add_u32 s30, s30, s31
  s_add_u32 s30, s30, 0
  v_and_b32 v2, 15, v1
  v_mul_u32_u24 v2, 304, v2
  v_lshrrev_b32 v3, 4, v1
  v_lshl_add_u32 v2, v3, 3, v2
  v_add_u32 v2, s30, v2
  v_cvt_pk_bf16_f32 v16, v128, v129
  v_cvt_pk_bf16_f32 v17, v130, v131
  ds_write_b64 v2, v[16:17] offset:0
  v_cvt_pk_bf16_f32 v18, v164, v165
  v_cvt_pk_bf16_f32 v19, v166, v167
  ds_write_b64 v2, v[18:19] offset:4864
  v_cvt_pk_bf16_f32 v20, v132, v133
  v_cvt_pk_bf16_f32 v21, v134, v135
  ds_write_b64 v2, v[20:21] offset:32
  v_cvt_pk_bf16_f32 v22, v168, v169
  v_cvt_pk_bf16_f32 v23, v170, v171
  ds_write_b64 v2, v[22:23] offset:4896
  v_cvt_pk_bf16_f32 v16, v136, v137
  v_cvt_pk_bf16_f32 v17, v138, v139
  ds_write_b64 v2, v[16:17] offset:64
  v_cvt_pk_bf16_f32 v18, v172, v173
  v_cvt_pk_bf16_f32 v19, v174, v175
  ds_write_b64 v2, v[18:19] offset:4928
  v_cvt_pk_bf16_f32 v20, v140, v141
  v_cvt_pk_bf16_f32 v21, v142, v143
  ds_write_b64 v2, v[20:21] offset:96
  v_cvt_pk_bf16_f32 v22, v176, v177
  v_cvt_pk_bf16_f32 v23, v178, v179
  ds_write_b64 v2, v[22:23] offset:4960
  v_cvt_pk_bf16_f32 v16, v144, v145
  v_cvt_pk_bf16_f32 v17, v146, v147
  ds_write_b64 v2, v[16:17] offset:128
  v_cvt_pk_bf16_f32 v18, v180, v181
  v_cvt_pk_bf16_f32 v19, v182, v183
  ds_write_b64 v2, v[18:19] offset:4992
  v_cvt_pk_bf16_f32 v20, v148, v149
  v_cvt_pk_bf16_f32 v21, v150, v151
  ds_write_b64 v2, v[20:21] offset:160
  v_cvt_pk_bf16_f32 v22, v184, v185
  v_cvt_pk_bf16_f32 v23, v186, v187
  ds_write_b64 v2, v[22:23] offset:5024
  v_cvt_pk_bf16_f32 v16, v152, v153
  v_cvt_pk_bf16_f32 v17, v154, v155
  ds_write_b64 v2, v[16:17] offset:192
  v_cvt_pk_bf16_f32 v18, v188, v189
  v_cvt_pk_bf16_f32 v19, v190, v191
  ds_write_b64 v2, v[18:19] offset:5056
  v_cvt_pk_bf16_f32 v20, v156, v157
  v_cvt_pk_bf16_f32 v21, v158, v159
  ds_write_b64 v2, v[20:21] offset:224
  v_cvt_pk_bf16_f32 v22, v192, v193
  v_cvt_pk_bf16_f32 v23, v194, v195
  ds_write_b64 v2, v[22:23] offset:5088
  v_cvt_pk_bf16_f32 v16, v160, v161
  v_cvt_pk_bf16_f32 v17, v162, v163
  ds_write_b64 v2, v[16:17] offset:256
  v_cvt_pk_bf16_f32 v18, v196, v197
  v_cvt_pk_bf16_f32 v19, v198, v199
  ds_write_b64 v2, v[18:19] offset:5120
  s_waitcnt lgkmcnt(0)
  s_barrier
  ds_read_b128 v[128:131], v36
  ds_read_b128 v[132:135], v37
  ds_read_b128 v[136:139], v38
  ds_read_b128 v[140:143], v39
  ds_read_b128 v[144:147], v40
  s_waitcnt lgkmcnt(4)
  buffer_store_dwordx4 v[128:131], v41, s[12:15], s27 offen sc1
  s_waitcnt lgkmcnt(3)
  buffer_store_dwordx4 v[132:135], v42, s[12:15], s27 offen sc1
  s_waitcnt lgkmcnt(2)
  buffer_store_dwordx4 v[136:139], v43, s[12:15], s27 offen sc1
  s_waitcnt lgkmcnt(1)
  buffer_store_dwordx4 v[140:143], v44, s[12:15], s27 offen sc1
  s_waitcnt lgkmcnt(0)
  buffer_store_dwordx4 v[144:147], v45, s[12:15], s27 offen sc1
  s_branch L_phF_front_kernel
L_phF_front_kernel:
  v_mov_b32 v245, 0
  s_waitcnt vmcnt(0)
  s_barrier
  s_cmp_lg_u32 s20, 2
  s_cbranch_scc1 L_o28_front_kernel
  v_mov_b32 v250, 1
  s_mov_b64 exec, 1
  buffer_atomic_add v250, v245, s[4:7], s97 offen sc1
  s_mov_b64 exec, -1
L_o28_front_kernel:
  s_lshl_b32 s45, s32, 4
  s_bfe_u32 s30, s2, 0x20001
  s_lshl_b32 s30, s30, 2
  s_add_u32 s45, s45, s30
  s_add_u32 s45, s45, s33
  s_load_dwordx2 s[16:17], s[0:1], 104
  s_mov_b32 s18, 0x240000
  s_mov_b32 s19, 0x00020000
  s_load_dwordx2 s[8:9], s[0:1], 80
  s_mov_b32 s10, 0x1000
  s_mov_b32 s11, 0x00020000
  v_lshrrev_b32 v3, 6, v0
  v_and_b32 v2, 63, v0
  v_readfirstlane_b32 s20, v3
  v_lshlrev_b32 v8, 4, v2
  v_lshlrev_b32 v9, 1, v2
  v_lshlrev_b32 v10, 5, v2
  v_lshlrev_b32 v11, 2, v2
  s_lshl_b32 s29, s45, 3
  s_add_u32 s29, s29, s20
  s_mul_i32 s21, s29, 1152
  s_mov_b32 s40, 0x3ae38e39
  s_mov_b32 s41, 0x3727c5ac
  s_movk_i32 s30, 3641
  s_mov_b32 s31, 589536
  v_mul_u32_u24 v6, s30, v2
  v_lshrrev_b32 v6, 16, v6
  v_mul_lo_u32 v6, v6, s31
  v_add_u32 v12, v6, v8
  v_add_u32 v13, 1769632, v9
  s_mul_i32 s28, s29, 288
  s_add_u32 s24, s28, 117440512
  s_add_u32 s25, s28, 119799808
  s_add_u32 s26, s28, 122159104
  s_add_u32 s27, s28, 124518400
  s_lshl_b32 s29, s29, 1
  s_add_u32 s23, s21, 2424832
  s_waitcnt lgkmcnt(0)
  v_mov_b32 v7, 0
  buffer_load_ushort v7, v7, s[8:11], s29 offen
  s_mov_b32 s22, 11520
  buffer_load_dwordx4 v[56:59], v10, s[12:15], s22 offen
  buffer_load_dwordx4 v[60:63], v10, s[12:15], s22 offen offset:16
  buffer_load_dword v64, v11, s[12:15], s22 offen offset:2048
  buffer_load_dwordx4 v[16:19], v8, s[12:15], s23 offen
  buffer_load_ushort v20, v9, s[12:15], s23 offen offset:1024
  s_cmp_lg_u32 s20, 4
  s_cbranch_scc1 L_o29_front_kernel
  buffer_load_dword v248, v245, s[4:7], s97 offen sc1
L_wcf0_front_kernel:
  s_waitcnt vmcnt(0)
  v_readfirstlane_b32 s30, v248
  s_nop 0
  s_cmp_ge_u32 s30, 16
  s_cbranch_scc1 L_wof0_front_kernel
  s_add_u32 s100, s100, 1
  s_cmp_gt_u32 s100, 0x20000
  s_cbranch_scc1 L_end_front_kernel
  s_sleep 2
  buffer_load_dword v248, v245, s[4:7], s97 offen sc1
  s_branch L_wcf0_front_kernel
L_wof0_front_kernel:
L_o29_front_kernel:
  s_barrier
  buffer_load_dwordx4 v[22:25], v12, s[12:15], s24 offen
  buffer_load_ushort v26, v13, s[12:15], s24 offen offset:0
  buffer_load_dwordx4 v[28:31], v12, s[12:15], s25 offen
  buffer_load_ushort v32, v13, s[12:15], s25 offen offset:0
  buffer_load_dwordx4 v[34:37], v12, s[12:15], s26 offen
  buffer_load_ushort v38, v13, s[12:15], s26 offen offset:0
  buffer_load_dwordx4 v[40:43], v12, s[12:15], s27 offen
  buffer_load_ushort v44, v13, s[12:15], s27 offen offset:0
  s_waitcnt vmcnt(6)
  v_lshlrev_b32 v46, 16, v22
  v_and_b32 v47, 0xffff0000, v22
  v_lshlrev_b32 v48, 16, v23
  v_and_b32 v49, 0xffff0000, v23
  v_lshlrev_b32 v50, 16, v24
  v_and_b32 v51, 0xffff0000, v24
  v_lshlrev_b32 v52, 16, v25
  v_and_b32 v53, 0xffff0000, v25
  v_lshlrev_b32 v54, 16, v26
  s_waitcnt vmcnt(4)
  v_lshlrev_b32 v5, 16, v28
  v_and_b32 v6, 0xffff0000, v28
  v_add_f32 v46, v46, v5
  v_add_f32 v47, v47, v6
  v_lshlrev_b32 v5, 16, v29
  v_and_b32 v6, 0xffff0000, v29
  v_add_f32 v48, v48, v5
  v_add_f32 v49, v49, v6
  v_lshlrev_b32 v5, 16, v30
  v_and_b32 v6, 0xffff0000, v30
  v_add_f32 v50, v50, v5
  v_add_f32 v51, v51, v6
  v_lshlrev_b32 v5, 16, v31
  v_and_b32 v6, 0xffff0000, v31
  v_add_f32 v52, v52, v5
  v_add_f32 v53, v53, v6
  v_lshlrev_b32 v5, 16, v32
  v_add_f32 v54, v54, v5
  s_waitcnt vmcnt(2)
  v_lshlrev_b32 v5, 16, v34
  v_and_b32 v6, 0xffff0000, v34
  v_add_f32 v46, v46, v5
  v_add_f32 v47, v47, v6
  v_lshlrev_b32 v5, 16, v35
  v_and_b32 v6, 0xffff0000, v35
  v_add_f32 v48, v48, v5
  v_add_f32 v49, v49, v6
  v_lshlrev_b32 v5, 16, v36
  v_and_b32 v6, 0xffff0000, v36
  v_add_f32 v50, v50, v5
  v_add_f32 v51, v51, v6
  v_lshlrev_b32 v5, 16, v37
  v_and_b32 v6, 0xffff0000, v37
  v_add_f32 v52, v52, v5
  v_add_f32 v53, v53, v6
  v_lshlrev_b32 v5, 16, v38
  v_add_f32 v54, v54, v5
  s_waitcnt vmcnt(0)
  v_lshlrev_b32 v5, 16, v40
  v_and_b32 v6, 0xffff0000, v40
  v_add_f32 v46, v46, v5
  v_add_f32 v47, v47, v6
  v_lshlrev_b32 v5, 16, v41
  v_and_b32 v6, 0xffff0000, v41
  v_add_f32 v48, v48, v5
  v_add_f32 v49, v49, v6
  v_lshlrev_b32 v5, 16, v42
  v_and_b32 v6, 0xffff0000, v42
  v_add_f32 v50, v50, v5
  v_add_f32 v51, v51, v6
  v_lshlrev_b32 v5, 16, v43
  v_and_b32 v6, 0xffff0000, v43
  v_add_f32 v52, v52, v5
  v_add_f32 v53, v53, v6
  v_lshlrev_b32 v5, 16, v44
  v_add_f32 v54, v54, v5
  v_lshlrev_b32 v7, 16, v7
  v_add_f32 v46, v46, v7
  v_add_f32 v47, v47, v7
  v_add_f32 v48, v48, v7
  v_add_f32 v49, v49, v7
  v_add_f32 v50, v50, v7
  v_add_f32 v51, v51, v7
  v_add_f32 v52, v52, v7
  v_add_f32 v53, v53, v7
  v_add_f32 v54, v54, v7
  s_waitcnt vmcnt(0)
  v_lshlrev_b32 v22, 16, v16
  v_and_b32 v23, 0xffff0000, v16
  v_lshlrev_b32 v24, 16, v17
  v_and_b32 v25, 0xffff0000, v17
  v_lshlrev_b32 v26, 16, v18
  v_and_b32 v27, 0xffff0000, v18
  v_lshlrev_b32 v28, 16, v19
  v_and_b32 v29, 0xffff0000, v19
  v_lshlrev_b32 v30, 16, v20
  v_fma_f32 v46, v46, v56, v22
  v_fma_f32 v47, v47, v57, v23
  v_fma_f32 v48, v48, v58, v24
  v_fma_f32 v49, v49, v59, v25
  v_fma_f32 v50, v50, v60, v26
  v_fma_f32 v51, v51, v61, v27
  v_fma_f32 v52, v52, v62, v28
  v_fma_f32 v53, v53, v63, v29
  v_fma_f32 v54, v54, v64, v30
  v_cvt_pk_bf16_f32 v16, v46, v47
  v_cvt_pk_bf16_f32 v17, v48, v49
  v_cvt_pk_bf16_f32 v18, v50, v51
  v_cvt_pk_bf16_f32 v19, v52, v53
  v_cvt_pk_bf16_f32 v20, v54, v54
  buffer_store_dwordx4 v[16:19], v8, s[16:19], s21 offen sc1
  buffer_store_short v20, v9, s[16:19], s21 offen offset:1024 sc1
  s_endpgm
L_end_front_kernel:
  s_endpgm
L_text_end:
.section .rodata,"a"
.p2align 6
.amdhsa_kernel front_kernel
  .amdhsa_next_free_vgpr 256
  .amdhsa_next_free_sgpr 102
  .amdhsa_accum_offset 256
  .amdhsa_group_segment_fixed_size 0
  .amdhsa_kernarg_size 128
  .amdhsa_user_sgpr_count 2
  .amdhsa_user_sgpr_kernarg_segment_ptr 1
  .amdhsa_system_sgpr_workgroup_id_x 1
.end_amdhsa_kernel
```
